```python
import torch

def _softmax(x, axis=-1):
    return torch.softmax(x, dim=axis)
def _gelu(x):
    return torch.nn.functional.gelu(x, approximate="tanh")
def _silu(x):
    return torch.nn.functional.silu(x)
def _sigmoid(x):
    return torch.sigmoid(x)
def _layernorm(x, axis=-1, eps=1e-5):
    m = x.mean(dim=axis, keepdim=True)
    v = x.var(dim=axis, keepdim=True, unbiased=False)
    return (x - m) / torch.sqrt(v + eps)
def _scatter_add(tgt, idx, src, axis=0):
    return tgt.clone().index_add_(axis, idx, src)
def _segment_sum(src, seg, n):
    out = torch.zeros((n,) + src.shape[1:], dtype=src.dtype)
    return out.index_add_(0, seg, src)
def _pad(x, pw):
    flat = tuple(v for pair in reversed(pw) for v in pair)
    return torch.nn.functional.pad(x, flat)

kernel_name = 'recurrent_scan__spectral_gfnet__geglu_ffn__prompt'

def setup_inputs():

    _w = (lambda a: (lambda t: t.to(torch.bfloat16) if t.is_floating_point() else t)(torch.as_tensor(a)))
    def _A_setup():
        B, S, D = 1, 2048, 512
        Df = D // 2 + 1
        return {
            "x": _w((lambda *s: torch.randn(*s, dtype=torch.bfloat16) * 0.05)(B, S, D)),
            "w_r": _w((lambda *s: torch.randn(*s, dtype=torch.bfloat16) * 0.1)(S, Df) * 0.02),
            "w_i": _w((lambda *s: torch.randn(*s, dtype=torch.bfloat16) * 0.1)(S, Df) * 0.02),
        }
    _A_in = _A_setup()

    def _B_setup():
        B, S, D, F = 1, 2048, 512, 1792
        return {
            "x": _w((lambda *s: torch.randn(*s, dtype=torch.bfloat16) * 0.05)(B, S, D)),
            "w_gate": _w((lambda *s: torch.randn(*s, dtype=torch.bfloat16) * 0.05)(D, F)),
            "w_up": _w((lambda *s: torch.randn(*s, dtype=torch.bfloat16) * 0.05)(D, F)),
            "w_down": _w((lambda *s: torch.randn(*s, dtype=torch.bfloat16) * 0.05)(F, D)),
        }
    _B_in = _B_setup()

    return {
        "A_x": _A_in["x"],
        "A_w_r": _A_in["w_r"],
        "A_w_i": _A_in["w_i"],
        "B_x": _B_in["x"],
        "B_w_gate": _B_in["w_gate"],
        "B_w_up": _B_in["w_up"],
        "B_w_down": _B_in["w_down"],
    }

def reference(A_x, A_w_r, A_w_i, B_x, B_w_gate, B_w_up, B_w_down):
    def _A_ref(x, w_r, w_i):
        B, S, D = x.shape
        X = (lambda x, axes=(-2,-1): torch.fft.rfft2(x.float(), dim=axes))(x, axes=(-2, -1))
        W = w_r + 1j * w_i
        X = X * W
        y = (lambda x, s, axes=(-2,-1): torch.fft.irfft2(x, s=s, dim=axes).to(torch.bfloat16))(X, (S, D), axes=(-2, -1))
        return y

    def _B_ref(x, w_gate, w_up, w_down):
        return (_gelu(x @ w_gate) * (x @ w_up)) @ w_down

    x = A_x
    xn = _layernorm(x, axis=-1)
    s = _A_ref(xn, A_w_r, A_w_i)
    g = _silu(_B_ref(xn, B_w_gate, B_w_up, B_w_down))
    return x + s * g
```

```asm
; @launch grid=(256,1,1) block=(256,1,1) lds=163840
.amdgcn_target "amdgcn-amd-amdhsa--gfx950"
.text
.globl recurrent_scan__spectral_gfnet__geglu_ffn__prompt_kernel
.p2align 8
.type recurrent_scan__spectral_gfnet__geglu_ffn__prompt_kernel,@function
recurrent_scan__spectral_gfnet__geglu_ffn__prompt_kernel:
    s_cmp_ge_u32 s2, 256
    s_cbranch_scc1 L_end
    s_load_dwordx2 s[4:5], s[0:1], 0
    s_load_dwordx2 s[8:9], s[0:1], 32
    s_load_dwordx2 s[12:13], s[0:1], 40
    s_load_dwordx2 s[28:29], s[0:1], 72
    s_load_dwordx2 s[16:17], s[0:1], 48
    s_load_dwordx2 s[20:21], s[0:1], 8
    s_load_dwordx2 s[24:25], s[0:1], 16
    s_load_dwordx2 s[32:33], s[0:1], 56
    s_load_dwordx2 s[36:37], s[0:1], 64
    s_getpc_b64 s[48:49]
L_pc:
    s_sub_u32 s48, s48, L_pc-recurrent_scan__spectral_gfnet__geglu_ffn__prompt_kernel
    s_subb_u32 s49, s49, 0
    s_mov_b32 s50, L_code_end-recurrent_scan__spectral_gfnet__geglu_ffn__prompt_kernel
    s_mov_b32 s51, 131072
    s_lshr_b32 s78, s2, 3
    v_lshlrev_b32 v38, 12, v0
    s_lshl_b32 s57, s78, 7
    buffer_load_dword v39, v38, s[48:51], s57 offen
    v_lshrrev_b32 v28, 6, v0
    v_and_b32 v1, 63, v0
    v_readfirstlane_b32 s52, v28
    s_and_b32 s55, s2, 7
    s_and_b32 s56, s78, 7
    s_lshr_b32 s93, s78, 3
    s_lshr_b32 s77, s55, 1
    s_and_b32 s55, s55, 1
    s_lshl_b32 s76, s55, 3
    s_add_u32 s76, s76, s56
    s_lshl_b32 s54, s93, 1
    s_lshl_b32 s79, s55, 4
    s_lshl_b32 s57, s77, 2
    s_add_u32 s79, s79, s57
    s_and_b32 s57, s78, 3
    s_add_u32 s79, s79, s57
    s_mul_i32 s53, s52, 40960
    s_lshr_b32 s56, s52, 1
    s_lshl_b32 s58, s76, 1
    s_add_u32 s58, s58, s56
    s_and_b32 s56, s52, 1
    s_lshl_b32 s68, s58, 10
    s_lshl_b32 s69, s56, 20
    s_add_u32 s68, s68, s69
    v_lshrrev_b32 v28, 3, v1
    v_and_b32 v29, 7, v1
    v_lshrrev_b32 v30, 4, v1
    v_xor_b32 v30, v30, v29
    v_lshlrev_b32 v30, 4, v30
    v_lshl_add_u32 v32, v28, 15, v30
    v_xor_b32_e64 v33, 64, v32
    v_add_u32 v33, 261120, v33
    v_add_u32 v34, 522240, v32
    v_add_u32 v35, 522240, v33
    s_mov_b32 s6, 2097152
    s_mov_b32 s7, 131072
    s_mov_b32 s10, 1835008
    s_mov_b32 s11, 131072
    s_mov_b32 s14, 1837056
    s_mov_b32 s15, 131072
    s_mov_b32 s30, 20971520
    s_mov_b32 s31, 131072
    s_mov_b32 s18, 1835008
    s_mov_b32 s19, 131072
    s_mov_b32 s22, 1052672
    s_mov_b32 s23, 131072
    s_mov_b32 s26, 1052672
    s_mov_b32 s27, 131072
    s_mov_b32 s34, 2097152
    s_mov_b32 s35, 131072
    s_mov_b32 s38, 256
    s_mov_b32 s39, 131072
    v_mov_b32 v36, 2147483648
    v_cmp_eq_u32 vcc, 0, v0
    v_mov_b32 v37, 0
    s_nop 0
    v_cndmask_b32 v3, v36, v37, vcc
    v_cmp_eq_u32 vcc, 0, v1
    v_mov_b32 v5, 1
    s_nop 0
    v_cndmask_b32 v4, v36, v37, vcc
    s_or_b32 s57, s2, s52
    s_cmp_eq_u32 s57, 0
    s_cselect_b32 s57, 0, 2147483648
    v_lshlrev_b32_e64 v38, 8, v1
    v_or_b32 v38, s57, v38
    s_add_u32 s57, s54, 0
    s_and_b32 s57, s57, 7
    s_mul_i32 s60, s57, 229376
    s_add_u32 s57, s54, 1
    s_and_b32 s57, s57, 7
    s_mul_i32 s61, s57, 229376
    s_add_u32 s57, s54, 2
    s_and_b32 s57, s57, 7
    s_mul_i32 s62, s57, 229376
    s_add_u32 s57, s54, 3
    s_and_b32 s57, s57, 7
    s_mul_i32 s63, s57, 229376
    s_add_u32 s57, s54, 4
    s_and_b32 s57, s57, 7
    s_mul_i32 s64, s57, 229376
    s_add_u32 s57, s54, 5
    s_and_b32 s57, s57, 7
    s_mul_i32 s65, s57, 229376
    s_add_u32 s57, s54, 6
    s_and_b32 s57, s57, 7
    s_mul_i32 s66, s57, 229376
    s_add_u32 s57, s54, 7
    s_and_b32 s57, s57, 7
    s_mul_i32 s67, s57, 229376
    s_add_u32 s59, s54, 0
    s_and_b32 s59, s59, 7
    s_lshl_b32 s59, s59, 7
    s_add_u32 m0, s53, 8192
    s_add_u32 s59, s59, s68
    s_waitcnt lgkmcnt(0)
    buffer_store_dword v37, v38, s[28:31], 0 offen sc1
    s_mov_b32 s57, 16384
    buffer_store_dword v37, v38, s[28:31], s57 offen sc1
    s_mov_b32 s57, 32768
    buffer_store_dword v37, v38, s[28:31], s57 offen sc1
    buffer_load_dwordx4 v32, s[4:7], s59 offen lds
    buffer_load_dwordx4 v33, s[4:7], s59 offen offset:1024 lds
    buffer_load_dwordx4 v34, s[4:7], s59 offen offset:2048 lds
    buffer_load_dwordx4 v35, s[4:7], s59 offen offset:3072 lds
    s_add_u32 s59, s54, 1
    s_and_b32 s59, s59, 7
    s_lshl_b32 s59, s59, 7
    s_add_u32 m0, s53, 12288
    s_add_u32 s59, s59, s68
    buffer_load_dwordx4 v32, s[4:7], s59 offen lds
    buffer_load_dwordx4 v33, s[4:7], s59 offen offset:1024 lds
    buffer_load_dwordx4 v34, s[4:7], s59 offen offset:2048 lds
    buffer_load_dwordx4 v35, s[4:7], s59 offen offset:3072 lds
    s_sub_u32 s12, s12, 2048
    s_subb_u32 s13, s13, 0
    s_getpc_b64 s[40:41]
    s_add_u32 s40, s40, dft_tab@rel32@lo+4
    s_addc_u32 s41, s41, dft_tab@rel32@hi+12
    s_mov_b32 s42, 530432
    s_mov_b32 s43, 131072
    s_sub_u32 s44, s40, 1920
    s_subb_u32 s45, s41, 0
    s_mov_b32 s46, 526208
    s_mov_b32 s47, 131072
    s_lshl_b32 s57, s2, 2
    s_add_u32 s57, s57, s52
    s_and_b32 s70, s57, 1
    s_mul_i32 s70, s70, 1536
    s_lshr_b32 s71, s57, 1
    s_mul_i32 s71, s71, 3584
    s_add_u32 s70, s70, s71
    v_lshlrev_b32 v38, 8, v1
    v_cmp_gt_u32 vcc, 6, v1
    s_add_u32 s71, s70, 2048
    s_lshl_b32 s57, s57, 9
    v_cndmask_b32 v31, v36, v38, vcc
    v_cmp_gt_u32 vcc, 4, v1
    v_lshlrev_b32 v38, 7, v1
    buffer_load_dword v56, v31, s[8:11], s70 offen
    buffer_load_dword v57, v31, s[12:15], s71 offen
    v_cndmask_b32 v31, v36, v38, vcc
    buffer_load_dword v58, v31, s[40:43], s57 offen
    s_lshl_b32 s69, s58, 1
    s_add_u32 s69, s69, s56
    s_add_u32 s48, s69, 32
    s_lshl_b32 s48, s48, 8
    s_mul_i32 s69, s69, 115712
    s_add_u32 s69, s69, 1048576
    s_lshl_b32 s58, s58, 8
    s_lshl_b32 s56, s56, 7
    s_add_u32 s71, s58, s56
    s_add_u32 s71, s71, 9437184
    s_lshr_b32 s80, s78, 2
    v_lshrrev_b32 v30, 2, v1
    v_and_b32 v30, 4, v30
    v_xor_b32 v30, v30, v29
    v_lshlrev_b32_e64 v30, 4, v30
    v_lshlrev_b32 v2, 4, v1
    s_cmp_ge_u32 s93, 3
    s_cbranch_scc1 L_dft
    s_lshl_b32 s55, s52, 4
    v_add_u32 v31, s55, v28
    s_mul_i32 s56, s77, 3
    s_add_u32 s56, s56, s93
    s_lshl_b32 s56, s56, 1
    s_add_u32 s56, s56, 1
    s_lshl_b32 s57, s56, 7
    v_mul_u32_u24 v31, 3584, v31
    v_add3_u32 v18, v31, v30, s57
    v_add_u32 v19, 27648, v18
    v_subrev_u32 v16, 128, v18
    v_subrev_u32 v17, 128, v19
    s_lshl_b32 s57, s56, 12
    s_add_u32 s70, s69, s57
    s_sub_u32 s69, s70, 4096
    s_lshl_b32 s57, s80, 7
    v_lshl_add_u32 v20, v28, 10, v30
    v_add_u32 v20, s57, v20
    v_add_u32 v21, 7168, v20
    v_add_u32 v22, 14336, v20
    v_add_u32 v23, 21504, v20
    v_lshrrev_b32_e64 v36, 5, v1
    v_mul_u32_u24 v36, 8, v36
    s_waitcnt vmcnt(14)
    v_bfe_u32 v39, v1, 2, 2
    v_add_u32 v36, v36, v39
    v_lshlrev_b32 v36, 7, v36
    v_bfe_u32 v37, v1, 4, 1
    v_lshlrev_b32 v37, 5, v37
    v_and_b32 v38, 3, v1
    v_lshlrev_b32_e64 v38, 3, v38
    v_add3_u32 v36, v36, v37, v38
    v_bfe_u32 v39, v1, 3, 1
    v_lshl_add_u32 v36, v39, 6, v36
    v_add_u32 v8, 0, v36
    v_xor_b32 v9, 64, v8
    v_add_u32 v10, 40960, v36
    v_xor_b32_e64 v11, 64, v10
    v_add_u32 v12, 81920, v36
    v_xor_b32_e64 v13, 64, v12
    v_add_u32 v14, 122880, v36
    v_xor_b32 v15, 64, v14
    s_and_b32 s55, s78, 3
    s_lshl_b32 s55, s55, 2
    s_add_u32 s55, s55, s52
    s_lshl_b32 s55, s55, 4
    v_and_b32 v36, 15, v1
    v_add_u32_e64 v37, s55, v36
    v_mov_b32 v38, 256
    v_cmp_eq_u32 vcc, 0, v37
    v_lshrrev_b32 v39, 4, v1
    s_nop 0
    v_cndmask_b32 v37, v37, v38, vcc
    v_mul_u32_u24 v40, 2056, v39
    v_lshl_add_u32 v40, v37, 1, v40
    v_mul_u32_u24 v41, 8448, v36
    v_lshl_add_u32 v41, v39, 4, v41
    s_lshr_b32 s56, s2, 5
    s_lshl_b32 s56, s56, 3
    s_and_b32 s57, s2, 7
    s_add_u32 s56, s56, s57
    s_mul_i32 s72, s56, 16448
    s_add_u32 s73, s72, 8224
    s_mul_i32 s74, s55, 8448
    s_lshl_b32 s57, s56, 7
    s_add_u32 s74, s74, s57
    s_add_u32 s74, s74, 12582912
    s_lshr_b32 s56, s56, 4
    s_and_b32 s55, s78, 3
    s_lshl_b32 s55, s55, 2
    s_add_u32 s55, s55, s56
    s_add_u32 s55, s55, 16
    s_lshl_b32 s75, s55, 8
    s_mul_i32 s92, s2, 8448
    s_mov_b32 s81, 1065369472
    s_mov_b32 s82, 4294901760
    v_mov_b32 v6, 0xc0135761
    v_and_b32_e64 v36, 31, v1
    v_bfe_u32 v37, v1, 1, 3
    v_lshrrev_b32 v38, 5, v1
    v_xor_b32 v37, v37, v38
    v_lshlrev_b32_e64 v37, 4, v37
    v_lshl_add_u32 v36, v36, 7, v37
    v_add_u32 v44, s53, v36
    v_xor_b32 v45, 32, v44
    v_xor_b32_e64 v46, 64, v44
    v_xor_b32 v47, 96, v44
    v_mov_b32 v48, 0
    v_mov_b32 v49, 0
    v_mov_b32 v50, 0
    v_mov_b32 v51, 0
    v_mov_b32 v52, 0
    v_mov_b32 v53, 0
    v_mov_b32 v54, 0
    v_mov_b32 v55, 0
    v_and_b32 v72, 15, v1
    v_lshrrev_b32 v73, 4, v1
    s_lshl_b32 s55, s52, 4
    v_add_u32 v74, s55, v72
    v_cvt_f32_u32 v74, v74
    v_cvt_f32_u32 v80, v72
    v_mul_f32 v75, 0x3c800000, v74
    v_lshrrev_b32 v79, 1, v73
    v_lshlrev_b32 v79, 4, v79
    v_and_b32_e64 v77, 1, v73
    v_lshl_add_u32 v79, v77, 2, v79
    v_cvt_f32_u32 v79, v79
    v_mul_f32 v77, v79, v75
    v_fmamk_f32 v64, v75, 0x00000000, v77
    v_fmamk_f32 v65, v75, 0x3f800000, v77
    v_fmamk_f32 v66, v75, 0x40000000, v77
    v_fmamk_f32 v67, v75, 0x40400000, v77
    v_cos_f32 v68, v64
    v_cos_f32 v69, v65
    v_cos_f32 v70, v66
    v_cos_f32 v71, v67
    v_sin_f32 v64, v64
    v_sin_f32 v65, v65
    v_sin_f32 v66, v66
    v_sin_f32 v67, v67
    v_cvt_pk_bf16_f32 v68, v68, v69
    v_cvt_pk_bf16_f32 v70, v70, v71
    v_cvt_pk_bf16_f32 v64, v64, v65
    v_cvt_pk_bf16_f32 v66, v66, v67
    v_accvgpr_write_b32 a96, v68
    v_xor_b32 v65, 2147516416, v64
    v_accvgpr_write_b32 a97, v70
    v_xor_b32 v67, 2147516416, v66
    v_accvgpr_write_b32 a104, v64
    v_accvgpr_write_b32 a112, v65
    v_accvgpr_write_b32 a105, v66
    v_accvgpr_write_b32 a113, v67
    v_fmamk_f32 v64, v75, 0x41000000, v77
    v_fmamk_f32 v65, v75, 0x41100000, v77
    v_fmamk_f32 v66, v75, 0x41200000, v77
    v_fmamk_f32 v67, v75, 0x41300000, v77
    v_cos_f32 v68, v64
    v_cos_f32 v69, v65
    v_cos_f32 v70, v66
    v_cos_f32 v71, v67
    v_sin_f32 v64, v64
    v_sin_f32 v65, v65
    v_sin_f32 v66, v66
    v_sin_f32 v67, v67
    v_cvt_pk_bf16_f32 v68, v68, v69
    v_cvt_pk_bf16_f32 v70, v70, v71
    v_cvt_pk_bf16_f32 v64, v64, v65
    v_cvt_pk_bf16_f32 v66, v66, v67
    v_accvgpr_write_b32 a98, v68
    v_xor_b32 v65, 2147516416, v64
    v_accvgpr_write_b32 a99, v70
    v_xor_b32 v67, 2147516416, v66
    v_accvgpr_write_b32 a106, v64
    v_accvgpr_write_b32 a114, v65
    v_accvgpr_write_b32 a107, v66
    v_accvgpr_write_b32 a115, v67
    v_fmamk_f32 v64, v75, 0x42000000, v77
    v_fmamk_f32 v65, v75, 0x42040000, v77
    v_fmamk_f32 v66, v75, 0x42080000, v77
    v_fmamk_f32 v67, v75, 0x420c0000, v77
    v_cos_f32 v68, v64
    v_cos_f32 v69, v65
    v_cos_f32 v70, v66
    v_cos_f32 v71, v67
    v_sin_f32 v64, v64
    v_sin_f32 v65, v65
    v_sin_f32 v66, v66
    v_sin_f32 v67, v67
    v_cvt_pk_bf16_f32 v68, v68, v69
    v_cvt_pk_bf16_f32 v70, v70, v71
    v_cvt_pk_bf16_f32 v64, v64, v65
    v_cvt_pk_bf16_f32 v66, v66, v67
    v_accvgpr_write_b32 a100, v68
    v_xor_b32 v65, 2147516416, v64
    v_accvgpr_write_b32 a101, v70
    v_xor_b32 v67, 2147516416, v66
    v_accvgpr_write_b32 a108, v64
    v_accvgpr_write_b32 a116, v65
    v_accvgpr_write_b32 a109, v66
    v_accvgpr_write_b32 a117, v67
    v_fmamk_f32 v64, v75, 0x42200000, v77
    v_fmamk_f32 v65, v75, 0x42240000, v77
    v_fmamk_f32 v66, v75, 0x42280000, v77
    v_fmamk_f32 v67, v75, 0x422c0000, v77
    v_cos_f32 v68, v64
    v_cos_f32 v69, v65
    v_cos_f32 v70, v66
    v_cos_f32 v71, v67
    v_sin_f32 v64, v64
    v_sin_f32 v65, v65
    v_sin_f32 v66, v66
    v_sin_f32 v67, v67
    v_cvt_pk_bf16_f32 v68, v68, v69
    v_cvt_pk_bf16_f32 v70, v70, v71
    v_cvt_pk_bf16_f32 v64, v64, v65
    v_cvt_pk_bf16_f32 v66, v66, v67
    v_accvgpr_write_b32 a102, v68
    v_xor_b32 v65, 2147516416, v64
    v_accvgpr_write_b32 a103, v70
    v_xor_b32 v67, 2147516416, v66
    v_accvgpr_write_b32 a110, v64
    v_accvgpr_write_b32 a118, v65
    v_accvgpr_write_b32 a111, v66
    v_accvgpr_write_b32 a119, v67
    v_lshlrev_b32 v81, 2, v73
    v_cvt_f32_u32 v81, v81
    v_mul_f32 v75, 0x3a000000, v74
    v_mul_f32_e64 v77, v81, v75
    v_fmamk_f32 v64, v75, 0x00000000, v77
    v_fmamk_f32 v65, v75, 0x3f800000, v77
    v_fmamk_f32 v66, v75, 0x40000000, v77
    v_fmamk_f32 v67, v75, 0x40400000, v77
    v_cos_f32 v68, v64
    v_cos_f32 v69, v65
    v_cos_f32 v70, v66
    v_cos_f32 v71, v67
    v_sin_f32 v64, v64
    v_sin_f32 v65, v65
    v_sin_f32 v66, v66
    v_sin_f32 v67, v67
    v_accvgpr_write_b32 a144, v68
    v_accvgpr_write_b32 a145, v69
    v_accvgpr_write_b32 a146, v70
    v_accvgpr_write_b32 a147, v71
    v_accvgpr_write_b32 a152, v64
    v_accvgpr_write_b32 a153, v65
    v_accvgpr_write_b32 a154, v66
    v_accvgpr_write_b32 a155, v67
    v_fmamk_f32 v64, v75, 0x41800000, v77
    v_fmamk_f32 v65, v75, 0x41880000, v77
    v_fmamk_f32 v66, v75, 0x41900000, v77
    v_fmamk_f32 v67, v75, 0x41980000, v77
    v_cos_f32 v68, v64
    v_cos_f32 v69, v65
    v_cos_f32 v70, v66
    v_cos_f32 v71, v67
    v_sin_f32 v64, v64
    v_sin_f32 v65, v65
    v_sin_f32 v66, v66
    v_sin_f32 v67, v67
    v_accvgpr_write_b32 a148, v68
    v_accvgpr_write_b32 a149, v69
    v_accvgpr_write_b32 a150, v70
    v_accvgpr_write_b32 a151, v71
    v_accvgpr_write_b32 a156, v64
    v_accvgpr_write_b32 a157, v65
    v_accvgpr_write_b32 a158, v66
    v_accvgpr_write_b32 a159, v67
    v_cvt_f32_u32 v79, s55
    v_add_f32 v79, v79, v81
    v_mul_f32 v75, 0x3a000000, v80
    v_add_f32 v76, 0x3c000000, v75
    v_mul_f32 v77, v79, v75
    v_mul_f32 v78, v79, v76
    v_fmamk_f32 v64, v75, 0x00000000, v77
    v_fmamk_f32 v65, v75, 0x3f800000, v77
    v_fmamk_f32 v66, v75, 0x40000000, v77
    v_fmamk_f32 v67, v75, 0x40400000, v77
    v_cos_f32 v68, v64
    v_cos_f32 v69, v65
    v_cos_f32 v70, v66
    v_cos_f32 v71, v67
    v_sin_f32 v64, v64
    v_sin_f32 v65, v65
    v_sin_f32 v66, v66
    v_sin_f32 v67, v67
    v_mul_f32 v68, 0x36000000, v68
    v_mul_f32 v69, 0x36000000, v69
    v_mul_f32 v70, 0x36000000, v70
    v_mul_f32 v71, 0x36000000, v71
    v_mul_f32 v64, 0x36000000, v64
    v_mul_f32 v65, 0x36000000, v65
    v_mul_f32 v66, 0x36000000, v66
    v_mul_f32 v67, 0x36000000, v67
    v_accvgpr_write_b32 a160, v68
    v_accvgpr_write_b32 a161, v69
    v_accvgpr_write_b32 a162, v70
    v_accvgpr_write_b32 a163, v71
    v_accvgpr_write_b32 a168, v64
    v_accvgpr_write_b32 a169, v65
    v_accvgpr_write_b32 a170, v66
    v_accvgpr_write_b32 a171, v67
    v_fmamk_f32 v64, v76, 0x00000000, v78
    v_fmamk_f32 v65, v76, 0x3f800000, v78
    v_fmamk_f32 v66, v76, 0x40000000, v78
    v_fmamk_f32 v67, v76, 0x40400000, v78
    v_cos_f32 v68, v64
    v_cos_f32 v69, v65
    v_cos_f32 v70, v66
    v_cos_f32 v71, v67
    v_sin_f32 v64, v64
    v_sin_f32 v65, v65
    v_sin_f32 v66, v66
    v_sin_f32 v67, v67
    v_mul_f32 v68, 0x36000000, v68
    v_mul_f32 v69, 0x36000000, v69
    v_mul_f32 v70, 0x36000000, v70
    v_mul_f32 v71, 0x36000000, v71
    v_mul_f32 v64, 0x36000000, v64
    v_mul_f32 v65, 0x36000000, v65
    v_mul_f32 v66, 0x36000000, v66
    v_mul_f32 v67, 0x36000000, v67
    v_accvgpr_write_b32 a164, v68
    v_accvgpr_write_b32 a165, v69
    v_accvgpr_write_b32 a166, v70
    v_accvgpr_write_b32 a167, v71
    v_accvgpr_write_b32 a172, v64
    v_accvgpr_write_b32 a173, v65
    v_accvgpr_write_b32 a174, v66
    v_accvgpr_write_b32 a175, v67
    s_and_b32 s58, s78, 3
    s_mul_i32 s57, s52, 3
    s_add_u32 s57, s57, s80
    s_add_u32 s57, s57, s58
    s_add_u32 s55, s57, 0
    s_cmp_ge_u32 s55, 12
    s_cselect_b32 s56, 12, 0
    s_sub_u32 s55, s55, s56
    s_lshl_b32 s84, s55, 1
    s_add_u32 s55, s57, 1
    s_cmp_ge_u32 s55, 12
    s_cselect_b32 s56, 12, 0
    s_sub_u32 s55, s55, s56
    s_lshl_b32 s85, s55, 1
    s_add_u32 s55, s57, 2
    s_cmp_ge_u32 s55, 12
    s_cselect_b32 s56, 12, 0
    s_sub_u32 s55, s55, s56
    s_lshl_b32 s86, s55, 1
    s_lshl_b32 s55, s52, 2
    s_lshl_b32 s56, s80, 1
    s_add_u32 s55, s55, s56
    s_add_u32 s58, s58, s55
    s_add_u32 s55, s58, 0
    s_and_b32 s55, s55, 15
    s_lshl_b32 s56, s55, 1
    s_add_u32 s56, s56, 1
    s_add_u32 s57, s55, 12
    s_cmp_lt_u32 s55, 12
    s_cselect_b32 s87, s56, s57
    s_add_u32 s55, s58, 1
    s_and_b32 s55, s55, 15
    s_lshl_b32 s56, s55, 1
    s_add_u32 s56, s56, 1
    s_add_u32 s57, s55, 12
    s_cmp_lt_u32 s55, 12
    s_cselect_b32 s88, s56, s57
    s_add_u32 s55, s58, 2
    s_and_b32 s55, s55, 15
    s_lshl_b32 s56, s55, 1
    s_add_u32 s56, s56, 1
    s_add_u32 s57, s55, 12
    s_cmp_lt_u32 s55, 12
    s_cselect_b32 s89, s56, s57
    s_add_u32 s55, s58, 3
    s_and_b32 s55, s55, 15
    s_lshl_b32 s56, s55, 1
    s_add_u32 s56, s56, 1
    s_add_u32 s57, s55, 12
    s_cmp_lt_u32 s55, 12
    s_cselect_b32 s90, s56, s57
    v_lshrrev_b32 v81, 4, v1
    v_and_b32 v80, 15, v1
    s_lshl_b32 s55, s52, 3
    v_add_u32 v82, s55, v81
    v_add_u32 v83, 0, v82
    v_and_b32 v83, 15, v83
    v_xor_b32 v83, v83, v80
    v_lshlrev_b32_e64 v83, 4, v83
    v_lshl_add_u32 v83, v82, 8, v83
    v_accvgpr_write_b32 a176, v83
    v_add_u32 v83, 4, v82
    v_and_b32 v83, 15, v83
    v_xor_b32 v83, v83, v80
    v_lshlrev_b32 v83, 4, v83
    v_lshl_add_u32 v83, v82, 8, v83
    v_accvgpr_write_b32 a177, v83
    s_lshl_b32 s55, s52, 6
    v_lshrrev_b32 v83, 1, v81
    v_mul_u32_u24 v83, 40960, v83
    v_and_b32_e64 v84, 1, v81
    v_lshl_add_u32 v83, v84, 10, v83
    v_lshl_add_u32 v83, v80, 2, v83
    v_add_u32 v83, 32768, v83
    v_add_u32_e64 v83, s55, v83
    v_accvgpr_write_b32 a178, v83
    v_lshlrev_b32_e64 v83, 8, v80
    v_lshl_add_u32 v83, v81, 4, v83
    v_add_u32_e64 v83, s55, v83
    v_accvgpr_write_b32 a181, v83
    v_lshrrev_b32_e64 v83, 3, v80
    v_mul_u32_u24 v83, 40960, v83
    v_and_b32_e64 v84, 7, v80
    v_lshl_add_u32 v83, v84, 8, v83
    v_and_b32 v84, 2, v81
    v_add_u32 v84, v84, v81
    v_xor_b32_e64 v84, v84, v80
    v_lshl_add_u32 v83, v84, 4, v83
    v_add_u32 v83, 36864, v83
    v_accvgpr_write_b32 a179, v83
    s_lshl_b32 s55, s52, 9
    s_add_u32 s55, s55, 38912
    v_and_b32 v83, 1, v81
    v_lshlrev_b32_e64 v83, 8, v83
    v_lshl_add_u32 v83, v80, 4, v83
    v_lshrrev_b32_e64 v84, 1, v81
    v_lshl_add_u32 v83, v84, 3, v83
    v_add_u32_e64 v83, s55, v83
    v_accvgpr_write_b32 a180, v83
    v_lshrrev_b32 v86, 5, v1
    v_mul_u32_u24 v86, 4, v86
    v_bfe_u32 v89, v1, 2, 2
    v_add_u32 v86, v86, v89
    v_lshlrev_b32 v86, 7, v86
    v_bfe_u32 v87, v1, 4, 1
    v_lshlrev_b32 v87, 5, v87
    v_and_b32 v88, 1, v1
    v_lshlrev_b32 v88, 4, v88
    v_and_b32 v89, 2, v1
    v_lshl_add_u32 v88, v89, 2, v88
    v_add3_u32 v86, v86, v87, v88
    v_bfe_u32 v89, v1, 3, 1
    v_lshl_add_u32 v86, v89, 6, v86
    s_and_b32 s55, s52, 1
    s_lshl_b32 s56, s55, 6
    v_xor_b32 v86, s56, v86
    v_add_u32 v86, s53, v86
    v_accvgpr_write_b32 a182, v86
    s_lshr_b32 s56, s52, 1
    s_mul_i32 s58, s56, 115712
    v_add_u32 v83, s58, v2
    s_add_u32 s59, s54, 2
    s_and_b32 s59, s59, 7
    s_lshl_b32 s59, s59, 7
    s_add_u32 m0, s53, 16384
    s_add_u32 s59, s59, s68
    buffer_load_dwordx4 v32, s[4:7], s59 offen lds
    v_accvgpr_write_b32 a185, v83
    s_sub_u32 s58, 115712, s58
    v_add_u32_e64 v83, s58, v2
    v_accvgpr_write_b32 a186, v83
    s_mul_i32 s91, s79, 231424
    s_add_u32 s91, s91, 1048576
    v_lshrrev_b32_e64 v82, 5, v1
    v_bfe_u32 v83, v1, 2, 2
    v_lshl_add_u32 v84, v82, 2, v83
    buffer_load_dwordx4 v33, s[4:7], s59 offen offset:1024 lds
    v_lshlrev_b32_e64 v84, 8, v84
    v_bfe_u32 v85, v1, 4, 1
    v_lshl_add_u32 v84, v85, 6, v84
    v_and_b32_e64 v85, 3, v1
    v_lshl_add_u32 v84, v85, 4, v84
    v_and_b32 v85, 1, v83
    v_xor_b32 v85, s56, v85
    v_lshl_add_u32 v84, v85, 7, v84
    v_add_u32_e64 v84, s53, v84
    v_accvgpr_write_b32 a183, v84
    buffer_load_dwordx4 v34, s[4:7], s59 offen offset:2048 lds
    v_and_b32 v84, 1, v81
    v_lshlrev_b32 v84, 3, v84
    v_xor_b32_e64 v84, v84, v80
    v_mul_u32_u24 v83, 8448, v81
    v_lshl_add_u32 v83, v84, 4, v83
    v_accvgpr_write_b32 a184, v83
    s_mul_i32 s93, s52, 540672
    s_lshl_b32 s58, s79, 8
    s_add_u32 s93, s93, s58
    buffer_load_dwordx4 v35, s[4:7], s59 offen offset:3072 lds
    s_add_u32 s93, s93, 15728640
    v_and_b32 v83, 19, v1
    v_and_b32 v84, 4, v1
    v_lshl_add_u32 v83, v84, 1, v83
    v_bfe_u32 v84, v1, 3, 1
    v_lshl_add_u32 v83, v84, 2, v83
    s_lshl_b32 s58, s80, 1
    s_add_u32 s58, s58, s55
    s_lshl_b32 s58, s58, 5
    v_add_u32 v83, s58, v83
    s_add_u32 s59, s54, 3
    s_and_b32 s59, s59, 7
    s_lshl_b32 s59, s59, 7
    s_add_u32 m0, s53, 20480
    s_add_u32 s59, s59, s68
    buffer_load_dwordx4 v32, s[4:7], s59 offen lds
    v_xor_b32 v84, 32, v83
    s_lshl_b32 s83, s52, 6
    v_lshl_add_u32 v85, v82, 2, s83
    v_cmp_eq_u32 vcc, 0, v85
    v_cvt_f32_u32 v85, v85
    v_cvt_f32_u32_e64 v83, v83
    v_mul_f32 v83, 0x3b000000, v83
    v_accvgpr_write_b32 a187, v83
    v_mul_f32_e64 v86, v85, v83
    buffer_load_dwordx4 v33, s[4:7], s59 offen offset:1024 lds
    v_mul_f32 v87, 0x43800000, v83
    v_accvgpr_write_b32 a189, v86
    v_cndmask_b32 v87, v86, v87, vcc
    v_accvgpr_write_b32 a191, v87
    v_cvt_f32_u32 v84, v84
    v_mul_f32 v84, 0x3b000000, v84
    v_accvgpr_write_b32 a188, v84
    v_mul_f32_e64 v86, v85, v84
    v_mul_f32 v87, 0x43800000, v84
    v_accvgpr_write_b32 a190, v86
    buffer_load_dwordx4 v34, s[4:7], s59 offen offset:2048 lds
    v_cndmask_b32 v87, v86, v87, vcc
    v_accvgpr_write_b32 a192, v87
    v_and_b32 v83, 31, v1
    v_lshlrev_b32_e64 v83, 15, v83
    v_lshl_add_u32 v83, v82, 4, v83
    s_lshl_b32 s56, s56, 20
    s_lshl_b32 s58, s58, 1
    s_add_u32 s56, s56, s58
    s_lshl_b32 s58, s79, 10
    buffer_load_dwordx4 v35, s[4:7], s59 offen offset:3072 lds
    s_add_u32 s56, s56, s58
    v_add_u32_e64 v83, s56, v83
    v_accvgpr_write_b32 a193, v83
    s_and_b32 s56, s52, 2
    s_mul_i32 s56, s56, 40960
    s_add_u32 s56, s56, 36864
    v_bfe_u32 v83, v1, 4, 1
    v_mul_u32_u24 v83, 40960, v83
    v_lshl_add_u32 v83, v80, 7, v83
    s_add_u32 s59, s54, 4
    s_and_b32 s59, s59, 7
    s_lshl_b32 s59, s59, 7
    s_add_u32 m0, s53, 24576
    s_add_u32 s59, s59, s68
    buffer_load_dwordx4 v32, s[4:7], s59 offen lds
    s_lshl_b32 s55, s55, 2
    v_bfe_u32 v84, v1, 1, 3
    v_xor_b32 v84, v84, v82
    v_xor_b32_e64 v84, s55, v84
    v_lshl_add_u32 v83, v84, 4, v83
    v_add_u32_e64 v83, s56, v83
    v_accvgpr_write_b32 a195, v83
    s_lshr_b32 s55, s2, 6
    s_lshl_b32 s55, s55, 2
    v_and_b32_e64 v83, 3, v1
    buffer_load_dwordx4 v33, s[4:7], s59 offen offset:1024 lds
    v_and_b32_e64 v84, 4, v1
    v_lshl_add_u32 v83, v84, 2, v83
    v_add_u32 v83, s55, v83
    s_lshl_b32 s51, s79, 1
    s_add_u32 s51, s51, 32
    s_lshl_b32 s51, s51, 8
    v_lshlrev_b32_e64 v83, 8, v83
    v_accvgpr_write_b32 a194, v83
    s_lshl_b32 s0, s2, 2
    buffer_load_dwordx4 v34, s[4:7], s59 offen offset:2048 lds
    s_add_u32 s0, s0, s52
    v_mov_b32 v60, 2147483648
    s_and_b32 s1, s0, 1
    s_lshl_b32 s1, s1, 3
    v_add_u32_e64 v61, s1, v1
    v_lshl_or_b32 v62, v61, 1, 1
    v_add_u32_e64 v63, 12, v61
    v_cmp_gt_u32 vcc, 12, v61
    s_lshr_b32 s1, s0, 1
    s_mul_i32 s1, s1, 3584
    buffer_load_dwordx4 v35, s[4:7], s59 offen offset:3072 lds
    s_add_u32 s49, s1, 2048
    v_cndmask_b32 v62, v63, v62, vcc
    v_cmp_gt_u32 vcc, 8, v1
    v_lshlrev_b32 v62, 7, v62
    v_lshlrev_b32 v61, 7, v1
    v_cndmask_b32 v62, v60, v62, vcc
    v_cmp_gt_u32 vcc, 14, v1
    s_mul_i32 s50, s0, 1792
    s_nop 0
    v_cndmask_b32 v63, v60, v61, vcc
    s_waitcnt vmcnt(19)
    ds_read_b128 v[128:131], v44 offset:8192
    ds_read_b128 v[132:135], v45 offset:8192
    ds_read_b128 v[136:139], v46 offset:8192
    ds_read_b128 v[140:143], v47 offset:8192
    s_cmp_eq_u32 s2, 0
    s_cselect_b32 s57, 0, 4096
    buffer_store_dword v5, v3, s[36:39], s57 offen sc1
    s_add_u32 s59, s54, 5
    s_and_b32 s59, s59, 7
    s_lshl_b32 s59, s59, 7
    s_add_u32 m0, s53, 28672
    s_add_u32 s59, s59, s68
    buffer_load_dwordx4 v32, s[4:7], s59 offen lds
    buffer_load_dwordx4 v33, s[4:7], s59 offen offset:1024 lds
    buffer_load_dwordx4 v34, s[4:7], s59 offen offset:2048 lds
    buffer_load_dwordx4 v35, s[4:7], s59 offen offset:3072 lds
    s_waitcnt vmcnt(20)
    ds_read_b128 v[144:147], v44 offset:12288
    ds_read_b128 v[148:151], v45 offset:12288
    ds_read_b128 v[152:155], v46 offset:12288
    ds_read_b128 v[156:159], v47 offset:12288
    s_add_u32 s59, s54, 6
    s_and_b32 s59, s59, 7
    s_lshl_b32 s59, s59, 7
    s_add_u32 m0, s53, 32768
    s_add_u32 s59, s59, s68
    buffer_load_dwordx4 v32, s[4:7], s59 offen lds
    s_waitcnt lgkmcnt(7)
    v_dot2c_f32_bf16 v48, s81, v128
    v_dot2c_f32_bf16 v52, v128, v128
    v_dot2c_f32_bf16 v49, s81, v129
    v_dot2c_f32_bf16 v53, v129, v129
    v_dot2c_f32_bf16 v50, s81, v130
    v_dot2c_f32_bf16 v54, v130, v130
    v_dot2c_f32_bf16 v51, s81, v131
    v_dot2c_f32_bf16 v55, v131, v131
    buffer_load_dwordx4 v33, s[4:7], s59 offen offset:1024 lds
    s_waitcnt lgkmcnt(6)
    v_dot2c_f32_bf16 v48, s81, v132
    v_dot2c_f32_bf16 v52, v132, v132
    v_dot2c_f32_bf16 v49, s81, v133
    v_dot2c_f32_bf16 v53, v133, v133
    v_dot2c_f32_bf16 v50, s81, v134
    v_dot2c_f32_bf16 v54, v134, v134
    v_dot2c_f32_bf16 v51, s81, v135
    v_dot2c_f32_bf16 v55, v135, v135
    buffer_load_dwordx4 v34, s[4:7], s59 offen offset:2048 lds
    s_waitcnt lgkmcnt(5)
    v_dot2c_f32_bf16 v48, s81, v136
    v_dot2c_f32_bf16 v52, v136, v136
    v_dot2c_f32_bf16 v49, s81, v137
    v_dot2c_f32_bf16 v53, v137, v137
    v_dot2c_f32_bf16 v50, s81, v138
    v_dot2c_f32_bf16 v54, v138, v138
    v_dot2c_f32_bf16 v51, s81, v139
    v_dot2c_f32_bf16 v55, v139, v139
    buffer_load_dwordx4 v35, s[4:7], s59 offen offset:3072 lds
    s_waitcnt lgkmcnt(4)
    v_dot2c_f32_bf16 v48, s81, v140
    v_dot2c_f32_bf16 v52, v140, v140
    v_dot2c_f32_bf16 v49, s81, v141
    v_dot2c_f32_bf16 v53, v141, v141
    v_dot2c_f32_bf16 v50, s81, v142
    v_dot2c_f32_bf16 v54, v142, v142
    v_dot2c_f32_bf16 v51, s81, v143
    v_dot2c_f32_bf16 v55, v143, v143
    s_waitcnt vmcnt(17)
    ds_read_b128 v[160:163], v44 offset:16384
    ds_read_b128 v[164:167], v45 offset:16384
    ds_read_b128 v[168:171], v46 offset:16384
    ds_read_b128 v[172:175], v47 offset:16384
    s_add_u32 s59, s54, 7
    s_and_b32 s59, s59, 7
    s_lshl_b32 s59, s59, 7
    s_add_u32 m0, s53, 36864
    s_add_u32 s59, s59, s68
    buffer_load_dwordx4 v32, s[4:7], s59 offen lds
    s_waitcnt lgkmcnt(7)
    v_dot2c_f32_bf16 v48, s81, v144
    v_dot2c_f32_bf16 v52, v144, v144
    v_dot2c_f32_bf16 v49, s81, v145
    v_dot2c_f32_bf16 v53, v145, v145
    v_dot2c_f32_bf16 v50, s81, v146
    v_dot2c_f32_bf16 v54, v146, v146
    v_dot2c_f32_bf16 v51, s81, v147
    v_dot2c_f32_bf16 v55, v147, v147
    buffer_load_dwordx4 v33, s[4:7], s59 offen offset:1024 lds
    s_waitcnt lgkmcnt(6)
    v_dot2c_f32_bf16 v48, s81, v148
    v_dot2c_f32_bf16 v52, v148, v148
    v_dot2c_f32_bf16 v49, s81, v149
    v_dot2c_f32_bf16 v53, v149, v149
    v_dot2c_f32_bf16 v50, s81, v150
    v_dot2c_f32_bf16 v54, v150, v150
    v_dot2c_f32_bf16 v51, s81, v151
    v_dot2c_f32_bf16 v55, v151, v151
    buffer_load_dwordx4 v34, s[4:7], s59 offen offset:2048 lds
    s_waitcnt lgkmcnt(5)
    v_dot2c_f32_bf16 v48, s81, v152
    v_dot2c_f32_bf16 v52, v152, v152
    v_dot2c_f32_bf16 v49, s81, v153
    v_dot2c_f32_bf16 v53, v153, v153
    v_dot2c_f32_bf16 v50, s81, v154
    v_dot2c_f32_bf16 v54, v154, v154
    v_dot2c_f32_bf16 v51, s81, v155
    v_dot2c_f32_bf16 v55, v155, v155
    buffer_load_dwordx4 v35, s[4:7], s59 offen offset:3072 lds
    s_waitcnt lgkmcnt(4)
    v_dot2c_f32_bf16 v48, s81, v156
    v_dot2c_f32_bf16 v52, v156, v156
    v_dot2c_f32_bf16 v49, s81, v157
    v_dot2c_f32_bf16 v53, v157, v157
    v_dot2c_f32_bf16 v50, s81, v158
    v_dot2c_f32_bf16 v54, v158, v158
    v_dot2c_f32_bf16 v51, s81, v159
    v_dot2c_f32_bf16 v55, v159, v159
    s_waitcnt vmcnt(17)
    ds_read_b128 v[176:179], v44 offset:20480
    ds_read_b128 v[180:183], v45 offset:20480
    ds_read_b128 v[184:187], v46 offset:20480
    ds_read_b128 v[188:191], v47 offset:20480
    s_add_u32 m0, s53, 0
    s_nop 0
    buffer_load_dwordx4 v16, s[8:11], s60 offen lds
    s_waitcnt lgkmcnt(7)
    v_dot2c_f32_bf16 v48, s81, v160
    v_dot2c_f32_bf16 v52, v160, v160
    v_dot2c_f32_bf16 v49, s81, v161
    v_dot2c_f32_bf16 v53, v161, v161
    v_dot2c_f32_bf16 v50, s81, v162
    v_dot2c_f32_bf16 v54, v162, v162
    v_dot2c_f32_bf16 v51, s81, v163
    v_dot2c_f32_bf16 v55, v163, v163
    buffer_load_dwordx4 v17, s[8:11], s60 offen offset:1024 lds
    s_waitcnt lgkmcnt(6)
    v_dot2c_f32_bf16 v48, s81, v164
    v_dot2c_f32_bf16 v52, v164, v164
    v_dot2c_f32_bf16 v49, s81, v165
    v_dot2c_f32_bf16 v53, v165, v165
    v_dot2c_f32_bf16 v50, s81, v166
    v_dot2c_f32_bf16 v54, v166, v166
    v_dot2c_f32_bf16 v51, s81, v167
    v_dot2c_f32_bf16 v55, v167, v167
    buffer_load_dwordx4 v16, s[12:15], s60 offen offset:2048 lds
    s_waitcnt lgkmcnt(5)
    v_dot2c_f32_bf16 v48, s81, v168
    v_dot2c_f32_bf16 v52, v168, v168
    v_dot2c_f32_bf16 v49, s81, v169
    v_dot2c_f32_bf16 v53, v169, v169
    v_dot2c_f32_bf16 v50, s81, v170
    v_dot2c_f32_bf16 v54, v170, v170
    v_dot2c_f32_bf16 v51, s81, v171
    v_dot2c_f32_bf16 v55, v171, v171
    buffer_load_dwordx4 v17, s[12:15], s60 offen offset:3072 lds
    s_waitcnt lgkmcnt(4)
    v_dot2c_f32_bf16 v48, s81, v172
    v_dot2c_f32_bf16 v52, v172, v172
    v_dot2c_f32_bf16 v49, s81, v173
    v_dot2c_f32_bf16 v53, v173, v173
    v_dot2c_f32_bf16 v50, s81, v174
    v_dot2c_f32_bf16 v54, v174, v174
    v_dot2c_f32_bf16 v51, s81, v175
    v_dot2c_f32_bf16 v55, v175, v175
    s_waitcnt vmcnt(17)
    ds_read_b128 v[192:195], v44 offset:24576
    ds_read_b128 v[196:199], v45 offset:24576
    ds_read_b128 v[200:203], v46 offset:24576
    ds_read_b128 v[204:207], v47 offset:24576
    s_add_u32 m0, s53, 4096
    s_nop 0
    buffer_load_dwordx4 v16, s[8:11], s61 offen lds
    s_waitcnt lgkmcnt(7)
    v_dot2c_f32_bf16 v48, s81, v176
    v_dot2c_f32_bf16 v52, v176, v176
    v_dot2c_f32_bf16 v49, s81, v177
    v_dot2c_f32_bf16 v53, v177, v177
    v_dot2c_f32_bf16 v50, s81, v178
    v_dot2c_f32_bf16 v54, v178, v178
    v_dot2c_f32_bf16 v51, s81, v179
    v_dot2c_f32_bf16 v55, v179, v179
    buffer_load_dwordx4 v17, s[8:11], s61 offen offset:1024 lds
    s_waitcnt lgkmcnt(6)
    v_dot2c_f32_bf16 v48, s81, v180
    v_dot2c_f32_bf16 v52, v180, v180
    v_dot2c_f32_bf16 v49, s81, v181
    v_dot2c_f32_bf16 v53, v181, v181
    v_dot2c_f32_bf16 v50, s81, v182
    v_dot2c_f32_bf16 v54, v182, v182
    v_dot2c_f32_bf16 v51, s81, v183
    v_dot2c_f32_bf16 v55, v183, v183
    buffer_load_dwordx4 v16, s[12:15], s61 offen offset:2048 lds
    s_waitcnt lgkmcnt(5)
    v_dot2c_f32_bf16 v48, s81, v184
    v_dot2c_f32_bf16 v52, v184, v184
    v_dot2c_f32_bf16 v49, s81, v185
    v_dot2c_f32_bf16 v53, v185, v185
    v_dot2c_f32_bf16 v50, s81, v186
    v_dot2c_f32_bf16 v54, v186, v186
    v_dot2c_f32_bf16 v51, s81, v187
    v_dot2c_f32_bf16 v55, v187, v187
    buffer_load_dwordx4 v17, s[12:15], s61 offen offset:3072 lds
    s_waitcnt lgkmcnt(4)
    v_dot2c_f32_bf16 v48, s81, v188
    v_dot2c_f32_bf16 v52, v188, v188
    v_dot2c_f32_bf16 v49, s81, v189
    v_dot2c_f32_bf16 v53, v189, v189
    v_dot2c_f32_bf16 v50, s81, v190
    v_dot2c_f32_bf16 v54, v190, v190
    v_dot2c_f32_bf16 v51, s81, v191
    v_dot2c_f32_bf16 v55, v191, v191
    s_waitcnt vmcnt(16)
    ds_read_b128 v[208:211], v44 offset:28672
    ds_read_b128 v[212:215], v45 offset:28672
    ds_read_b128 v[216:219], v46 offset:28672
    ds_read_b128 v[220:223], v47 offset:28672
    s_add_u32 m0, s53, 8192
    s_nop 0
    buffer_load_dwordx4 v16, s[8:11], s62 offen lds
    s_waitcnt lgkmcnt(7)
    v_dot2c_f32_bf16 v48, s81, v192
    v_dot2c_f32_bf16 v52, v192, v192
    v_dot2c_f32_bf16 v49, s81, v193
    v_dot2c_f32_bf16 v53, v193, v193
    v_dot2c_f32_bf16 v50, s81, v194
    v_dot2c_f32_bf16 v54, v194, v194
    v_dot2c_f32_bf16 v51, s81, v195
    v_dot2c_f32_bf16 v55, v195, v195
    buffer_load_dwordx4 v17, s[8:11], s62 offen offset:1024 lds
    s_waitcnt lgkmcnt(6)
    v_dot2c_f32_bf16 v48, s81, v196
    v_dot2c_f32_bf16 v52, v196, v196
    v_dot2c_f32_bf16 v49, s81, v197
    v_dot2c_f32_bf16 v53, v197, v197
    v_dot2c_f32_bf16 v50, s81, v198
    v_dot2c_f32_bf16 v54, v198, v198
    v_dot2c_f32_bf16 v51, s81, v199
    v_dot2c_f32_bf16 v55, v199, v199
    buffer_load_dwordx4 v16, s[12:15], s62 offen offset:2048 lds
    s_waitcnt lgkmcnt(5)
    v_dot2c_f32_bf16 v48, s81, v200
    v_dot2c_f32_bf16 v52, v200, v200
    v_dot2c_f32_bf16 v49, s81, v201
    v_dot2c_f32_bf16 v53, v201, v201
    v_dot2c_f32_bf16 v50, s81, v202
    v_dot2c_f32_bf16 v54, v202, v202
    v_dot2c_f32_bf16 v51, s81, v203
    v_dot2c_f32_bf16 v55, v203, v203
    buffer_load_dwordx4 v17, s[12:15], s62 offen offset:3072 lds
    s_waitcnt lgkmcnt(4)
    v_dot2c_f32_bf16 v48, s81, v204
    v_dot2c_f32_bf16 v52, v204, v204
    v_dot2c_f32_bf16 v49, s81, v205
    v_dot2c_f32_bf16 v53, v205, v205
    v_dot2c_f32_bf16 v50, s81, v206
    v_dot2c_f32_bf16 v54, v206, v206
    v_dot2c_f32_bf16 v51, s81, v207
    v_dot2c_f32_bf16 v55, v207, v207
    s_waitcnt vmcnt(16)
    ds_read_b128 v[224:227], v44 offset:32768
    ds_read_b128 v[228:231], v45 offset:32768
    ds_read_b128 v[232:235], v46 offset:32768
    ds_read_b128 v[236:239], v47 offset:32768
    s_add_u32 m0, s53, 12288
    s_nop 0
    buffer_load_dwordx4 v16, s[8:11], s63 offen lds
    s_waitcnt lgkmcnt(7)
    v_dot2c_f32_bf16 v48, s81, v208
    v_dot2c_f32_bf16 v52, v208, v208
    v_dot2c_f32_bf16 v49, s81, v209
    v_dot2c_f32_bf16 v53, v209, v209
    v_dot2c_f32_bf16 v50, s81, v210
    v_dot2c_f32_bf16 v54, v210, v210
    v_dot2c_f32_bf16 v51, s81, v211
    v_dot2c_f32_bf16 v55, v211, v211
    buffer_load_dwordx4 v17, s[8:11], s63 offen offset:1024 lds
    s_waitcnt lgkmcnt(6)
    v_dot2c_f32_bf16 v48, s81, v212
    v_dot2c_f32_bf16 v52, v212, v212
    v_dot2c_f32_bf16 v49, s81, v213
    v_dot2c_f32_bf16 v53, v213, v213
    v_dot2c_f32_bf16 v50, s81, v214
    v_dot2c_f32_bf16 v54, v214, v214
    v_dot2c_f32_bf16 v51, s81, v215
    v_dot2c_f32_bf16 v55, v215, v215
    buffer_load_dwordx4 v16, s[12:15], s63 offen offset:2048 lds
    s_waitcnt lgkmcnt(5)
    v_dot2c_f32_bf16 v48, s81, v216
    v_dot2c_f32_bf16 v52, v216, v216
    v_dot2c_f32_bf16 v49, s81, v217
    v_dot2c_f32_bf16 v53, v217, v217
    v_dot2c_f32_bf16 v50, s81, v218
    v_dot2c_f32_bf16 v54, v218, v218
    v_dot2c_f32_bf16 v51, s81, v219
    v_dot2c_f32_bf16 v55, v219, v219
    buffer_load_dwordx4 v17, s[12:15], s63 offen offset:3072 lds
    s_waitcnt lgkmcnt(4)
    v_dot2c_f32_bf16 v48, s81, v220
    v_dot2c_f32_bf16 v52, v220, v220
    v_dot2c_f32_bf16 v49, s81, v221
    v_dot2c_f32_bf16 v53, v221, v221
    v_dot2c_f32_bf16 v50, s81, v222
    v_dot2c_f32_bf16 v54, v222, v222
    v_dot2c_f32_bf16 v51, s81, v223
    v_dot2c_f32_bf16 v55, v223, v223
    s_waitcnt vmcnt(16)
    ds_read_b128 v[240:243], v44 offset:36864
    ds_read_b128 v[244:247], v45 offset:36864
    ds_read_b128 v[248:251], v46 offset:36864
    ds_read_b128 v[252:255], v47 offset:36864
    s_waitcnt lgkmcnt(7)
    v_dot2c_f32_bf16 v48, s81, v224
    v_dot2c_f32_bf16 v52, v224, v224
    v_dot2c_f32_bf16 v49, s81, v225
    v_dot2c_f32_bf16 v53, v225, v225
    v_dot2c_f32_bf16 v50, s81, v226
    v_dot2c_f32_bf16 v54, v226, v226
    v_dot2c_f32_bf16 v51, s81, v227
    v_dot2c_f32_bf16 v55, v227, v227
    s_waitcnt lgkmcnt(6)
    v_dot2c_f32_bf16 v48, s81, v228
    v_dot2c_f32_bf16 v52, v228, v228
    v_dot2c_f32_bf16 v49, s81, v229
    v_dot2c_f32_bf16 v53, v229, v229
    v_dot2c_f32_bf16 v50, s81, v230
    v_dot2c_f32_bf16 v54, v230, v230
    v_dot2c_f32_bf16 v51, s81, v231
    v_dot2c_f32_bf16 v55, v231, v231
    s_waitcnt lgkmcnt(5)
    v_dot2c_f32_bf16 v48, s81, v232
    v_dot2c_f32_bf16 v52, v232, v232
    v_dot2c_f32_bf16 v49, s81, v233
    v_dot2c_f32_bf16 v53, v233, v233
    v_dot2c_f32_bf16 v50, s81, v234
    v_dot2c_f32_bf16 v54, v234, v234
    v_dot2c_f32_bf16 v51, s81, v235
    v_dot2c_f32_bf16 v55, v235, v235
    s_waitcnt lgkmcnt(4)
    v_dot2c_f32_bf16 v48, s81, v236
    v_dot2c_f32_bf16 v52, v236, v236
    v_dot2c_f32_bf16 v49, s81, v237
    v_dot2c_f32_bf16 v53, v237, v237
    v_dot2c_f32_bf16 v50, s81, v238
    v_dot2c_f32_bf16 v54, v238, v238
    v_dot2c_f32_bf16 v51, s81, v239
    v_dot2c_f32_bf16 v55, v239, v239
    s_add_u32 m0, s53, 16384
    s_nop 0
    buffer_load_dwordx4 v16, s[8:11], s64 offen lds
    s_waitcnt lgkmcnt(3)
    v_dot2c_f32_bf16 v48, s81, v240
    v_dot2c_f32_bf16 v52, v240, v240
    v_dot2c_f32_bf16 v49, s81, v241
    v_dot2c_f32_bf16 v53, v241, v241
    v_dot2c_f32_bf16 v50, s81, v242
    v_dot2c_f32_bf16 v54, v242, v242
    v_dot2c_f32_bf16 v51, s81, v243
    v_dot2c_f32_bf16 v55, v243, v243
    buffer_load_dwordx4 v17, s[8:11], s64 offen offset:1024 lds
    s_waitcnt lgkmcnt(2)
    v_dot2c_f32_bf16 v48, s81, v244
    v_dot2c_f32_bf16 v52, v244, v244
    v_dot2c_f32_bf16 v49, s81, v245
    v_dot2c_f32_bf16 v53, v245, v245
    v_dot2c_f32_bf16 v50, s81, v246
    v_dot2c_f32_bf16 v54, v246, v246
    v_dot2c_f32_bf16 v51, s81, v247
    v_dot2c_f32_bf16 v55, v247, v247
    buffer_load_dwordx4 v16, s[12:15], s64 offen offset:2048 lds
    s_waitcnt lgkmcnt(1)
    v_dot2c_f32_bf16 v48, s81, v248
    v_dot2c_f32_bf16 v52, v248, v248
    v_dot2c_f32_bf16 v49, s81, v249
    v_dot2c_f32_bf16 v53, v249, v249
    v_dot2c_f32_bf16 v50, s81, v250
    v_dot2c_f32_bf16 v54, v250, v250
    v_dot2c_f32_bf16 v51, s81, v251
    v_dot2c_f32_bf16 v55, v251, v251
    buffer_load_dwordx4 v17, s[12:15], s64 offen offset:3072 lds
    s_waitcnt lgkmcnt(0)
    v_dot2c_f32_bf16 v48, s81, v252
    v_dot2c_f32_bf16 v52, v252, v252
    v_dot2c_f32_bf16 v49, s81, v253
    v_dot2c_f32_bf16 v53, v253, v253
    v_dot2c_f32_bf16 v50, s81, v254
    v_dot2c_f32_bf16 v54, v254, v254
    v_dot2c_f32_bf16 v51, s81, v255
    v_dot2c_f32_bf16 v55, v255, v255
    v_add_f32 v48, v48, v49
    s_nop 0
    v_add_f32 v50, v50, v51
    v_add_f32 v52, v52, v53
    v_add_f32 v54, v54, v55
    v_add_f32 v48, v48, v50
    v_add_f32 v52, v52, v54
    v_mov_b32 v49, v48
    v_mov_b32 v53, v52
    s_nop 0
    v_permlane32_swap_b32 v48, v49
    v_permlane32_swap_b32 v52, v53
    v_add_f32 v48, v48, v49
    v_add_f32_e64 v52, v52, v53
    v_mul_f32 v48, 0x3b000000, v48
    v_mul_f32 v52, 0x3b000000, v52
    v_fma_f32 v52, -v48, v48, v52
    v_max_f32_e64 v52, 0, v52
    v_add_f32 v52, 0x3727c5ac, v52
    v_rsq_f32_e64 v26, v52
    s_waitcnt vmcnt(16)
    s_barrier
    ds_read_b64_tr_b16 a[64:65], v8
    ds_read_b64_tr_b16 a[66:67], v8 offset:512
    ds_read_b64_tr_b16 a[68:69], v8 offset:2048
    ds_read_b64_tr_b16 a[70:71], v8 offset:2560
    ds_read_b64_tr_b16 a[72:73], v9
    ds_read_b64_tr_b16 a[74:75], v9 offset:512
    ds_read_b64_tr_b16 a[76:77], v9 offset:2048
    ds_read_b64_tr_b16 a[78:79], v9 offset:2560
    v_mul_f32_e64 v27, -v48, v26
    v_lshlrev_b32 v28, 16, v128
    v_and_b32 v29, s82, v128
    v_lshlrev_b32 v30, 16, v129
    v_and_b32 v31, s82, v129
    v_lshlrev_b32 v32, 16, v130
    v_and_b32 v33, s82, v130
    v_lshlrev_b32 v34, 16, v131
    v_and_b32 v35, s82, v131
    v_fma_f32 v28, v28, v26, v27
    v_fma_f32 v29, v29, v26, v27
    v_fma_f32 v30, v30, v26, v27
    v_fma_f32 v31, v31, v26, v27
    v_fma_f32 v32, v32, v26, v27
    v_fma_f32 v33, v33, v26, v27
    v_fma_f32 v34, v34, v26, v27
    v_fma_f32 v35, v35, v26, v27
    v_cvt_pk_bf16_f32 v128, v28, v29
    v_cvt_pk_bf16_f32 v129, v30, v31
    v_cvt_pk_bf16_f32 v130, v32, v33
    v_cvt_pk_bf16_f32 v131, v34, v35
    v_lshlrev_b32 v28, 16, v132
    v_and_b32 v29, s82, v132
    v_lshlrev_b32 v30, 16, v133
    v_and_b32 v31, s82, v133
    v_lshlrev_b32 v32, 16, v134
    v_and_b32 v33, s82, v134
    v_lshlrev_b32 v34, 16, v135
    v_and_b32 v35, s82, v135
    v_fma_f32 v28, v28, v26, v27
    v_fma_f32 v29, v29, v26, v27
    v_fma_f32 v30, v30, v26, v27
    v_fma_f32 v31, v31, v26, v27
    v_fma_f32 v32, v32, v26, v27
    v_fma_f32 v33, v33, v26, v27
    v_fma_f32 v34, v34, v26, v27
    v_fma_f32 v35, v35, v26, v27
    v_cvt_pk_bf16_f32 v132, v28, v29
    v_cvt_pk_bf16_f32 v133, v30, v31
    v_cvt_pk_bf16_f32 v134, v32, v33
    v_cvt_pk_bf16_f32 v135, v34, v35
    s_waitcnt lgkmcnt(6)
    v_mfma_f32_32x32x16_bf16 v[64:79], a[64:67], v[128:131], 0
    s_waitcnt lgkmcnt(4)
    ds_read_b64_tr_b16 a[80:81], v10
    ds_read_b64_tr_b16 a[82:83], v10 offset:512
    v_lshlrev_b32 v28, 16, v136
    v_and_b32 v29, s82, v136
    v_lshlrev_b32 v30, 16, v137
    v_and_b32 v31, s82, v137
    v_lshlrev_b32 v32, 16, v138
    v_and_b32 v33, s82, v138
    v_lshlrev_b32 v34, 16, v139
    v_mfma_f32_32x32x16_bf16 v[80:95], a[68:71], v[128:131], 0
    s_waitcnt lgkmcnt(4)
    s_add_u32 m0, s53, 20480
    ds_read_b64_tr_b16 a[84:85], v10 offset:2048
    ds_read_b64_tr_b16 a[86:87], v10 offset:2560
    buffer_load_dwordx4 v16, s[8:11], s65 offen lds
    v_and_b32_e64 v35, s82, v139
    v_fma_f32 v28, v28, v26, v27
    v_fma_f32 v29, v29, v26, v27
    v_fma_f32 v30, v30, v26, v27
    v_mfma_f32_32x32x16_bf16 v[96:111], a[72:75], v[128:131], 0
    s_waitcnt lgkmcnt(4)
    ds_read_b64_tr_b16 a[88:89], v11
    ds_read_b64_tr_b16 a[90:91], v11 offset:512
    buffer_load_dwordx4 v17, s[8:11], s65 offen offset:1024 lds
    v_fma_f32 v31, v31, v26, v27
    v_fma_f32 v32, v32, v26, v27
    v_fma_f32 v33, v33, v26, v27
    v_fma_f32 v34, v34, v26, v27
    v_mfma_f32_32x32x16_bf16 v[112:127], a[76:79], v[128:131], 0
    s_waitcnt lgkmcnt(4)
    ds_read_b64_tr_b16 a[92:93], v11 offset:2048
    ds_read_b64_tr_b16 a[94:95], v11 offset:2560
    buffer_load_dwordx4 v16, s[12:15], s65 offen offset:2048 lds
    v_fma_f32 v35, v35, v26, v27
    v_cvt_pk_bf16_f32 v136, v28, v29
    v_cvt_pk_bf16_f32 v137, v30, v31
    v_cvt_pk_bf16_f32 v138, v32, v33
    v_cvt_pk_bf16_f32 v139, v34, v35
    v_mfma_f32_32x32x16_bf16 v[64:79], a[80:83], v[132:135], v[64:79]
    s_waitcnt lgkmcnt(4)
    ds_read_b64_tr_b16 a[64:65], v12
    ds_read_b64_tr_b16 a[66:67], v12 offset:512
    v_mov_b32 v24, 0
    v_lshlrev_b32 v28, 16, v140
    v_and_b32 v29, s82, v140
    v_lshlrev_b32 v30, 16, v141
    v_and_b32 v31, s82, v141
    v_lshlrev_b32 v32, 16, v142
    v_and_b32 v33, s82, v142
    v_lshlrev_b32 v34, 16, v143
    v_mfma_f32_32x32x16_bf16 v[80:95], a[84:87], v[132:135], v[80:95]
    s_waitcnt lgkmcnt(4)
    ds_read_b64_tr_b16 a[68:69], v12 offset:2048
    ds_read_b64_tr_b16 a[70:71], v12 offset:2560
    buffer_load_dwordx4 v17, s[12:15], s65 offen offset:3072 lds
    v_and_b32_e64 v35, s82, v143
    v_fma_f32 v28, v28, v26, v27
    v_fma_f32 v29, v29, v26, v27
    v_fma_f32 v30, v30, v26, v27
    v_mfma_f32_32x32x16_bf16 v[96:111], a[88:91], v[132:135], v[96:111]
    s_waitcnt lgkmcnt(4)
    s_add_u32 m0, s53, 24576
    ds_read_b64_tr_b16 a[72:73], v13
    ds_read_b64_tr_b16 a[74:75], v13 offset:512
    buffer_load_dwordx4 v16, s[8:11], s66 offen lds
    v_fma_f32 v31, v31, v26, v27
    v_fma_f32 v32, v32, v26, v27
    v_fma_f32 v33, v33, v26, v27
    v_fma_f32 v34, v34, v26, v27
    v_mfma_f32_32x32x16_bf16 v[112:127], a[92:95], v[132:135], v[112:127]
    s_waitcnt lgkmcnt(4)
    ds_read_b64_tr_b16 a[76:77], v13 offset:2048
    ds_read_b64_tr_b16 a[78:79], v13 offset:2560
    buffer_load_dwordx4 v17, s[8:11], s66 offen offset:1024 lds
    v_fma_f32 v35, v35, v26, v27
    v_cvt_pk_bf16_f32 v140, v28, v29
    v_cvt_pk_bf16_f32 v141, v30, v31
    v_cvt_pk_bf16_f32 v142, v32, v33
    v_cvt_pk_bf16_f32 v143, v34, v35
    v_mfma_f32_32x32x16_bf16 v[64:79], a[64:67], v[136:139], v[64:79]
    s_waitcnt lgkmcnt(4)
    s_waitcnt vmcnt(18)
    s_barrier
    ds_read_b64_tr_b16 a[80:81], v14
    ds_read_b64_tr_b16 a[82:83], v14 offset:512
    v_lshlrev_b32 v28, 16, v144
    v_and_b32 v29, s82, v144
    v_lshlrev_b32 v30, 16, v145
    v_and_b32_e64 v31, s82, v145
    v_lshlrev_b32 v32, 16, v146
    v_mfma_f32_32x32x16_bf16 v[80:95], a[68:71], v[136:139], v[80:95]
    s_waitcnt lgkmcnt(4)
    ds_read_b64_tr_b16 a[84:85], v14 offset:2048
    ds_read_b64_tr_b16 a[86:87], v14 offset:2560
    buffer_load_dwordx4 v16, s[12:15], s66 offen offset:2048 lds
    v_and_b32 v33, s82, v146
    v_lshlrev_b32 v34, 16, v147
    v_and_b32_e64 v35, s82, v147
    v_fma_f32 v28, v28, v26, v27
    v_fma_f32 v29, v29, v26, v27
    v_mfma_f32_32x32x16_bf16 v[96:111], a[72:75], v[136:139], v[96:111]
    s_waitcnt lgkmcnt(4)
    ds_read_b64_tr_b16 a[88:89], v15
    ds_read_b64_tr_b16 a[90:91], v15 offset:512
    buffer_load_dwordx4 v17, s[12:15], s66 offen offset:3072 lds
    v_fma_f32 v30, v30, v26, v27
    v_fma_f32 v31, v31, v26, v27
    v_fma_f32 v32, v32, v26, v27
    v_fma_f32 v33, v33, v26, v27
    v_fma_f32 v34, v34, v26, v27
    v_mfma_f32_32x32x16_bf16 v[112:127], a[76:79], v[136:139], v[112:127]
    s_waitcnt lgkmcnt(4)
    s_add_u32 m0, s53, 28672
    ds_read_b64_tr_b16 a[92:93], v15 offset:2048
    ds_read_b64_tr_b16 a[94:95], v15 offset:2560
    buffer_load_dwordx4 v16, s[8:11], s67 offen lds
    v_fma_f32 v35, v35, v26, v27
    v_cvt_pk_bf16_f32 v144, v28, v29
    v_cvt_pk_bf16_f32 v145, v30, v31
    v_cvt_pk_bf16_f32 v146, v32, v33
    v_cvt_pk_bf16_f32 v147, v34, v35
    v_mfma_f32_32x32x16_bf16 v[64:79], a[80:83], v[140:143], v[64:79]
    s_waitcnt lgkmcnt(4)
    ds_read_b64_tr_b16 a[64:65], v8 offset:4096
    ds_read_b64_tr_b16 a[66:67], v8 offset:4608
    v_lshlrev_b32 v28, 16, v148
    v_and_b32 v29, s82, v148
    v_lshlrev_b32 v30, 16, v149
    v_and_b32 v31, s82, v149
    v_lshlrev_b32 v32, 16, v150
    v_and_b32_e64 v33, s82, v150
    v_lshlrev_b32 v34, 16, v151
    v_mfma_f32_32x32x16_bf16 v[80:95], a[84:87], v[140:143], v[80:95]
    s_waitcnt lgkmcnt(4)
    ds_read_b64_tr_b16 a[68:69], v8 offset:6144
    ds_read_b64_tr_b16 a[70:71], v8 offset:6656
    buffer_load_dwordx4 v17, s[8:11], s67 offen offset:1024 lds
    v_and_b32_e64 v35, s82, v151
    v_fma_f32 v28, v28, v26, v27
    v_fma_f32 v29, v29, v26, v27
    v_fma_f32 v30, v30, v26, v27
    v_mfma_f32_32x32x16_bf16 v[96:111], a[88:91], v[140:143], v[96:111]
    s_waitcnt lgkmcnt(4)
    ds_read_b64_tr_b16 a[72:73], v9 offset:4096
    ds_read_b64_tr_b16 a[74:75], v9 offset:4608
    buffer_load_dwordx4 v16, s[12:15], s67 offen offset:2048 lds
    v_fma_f32 v31, v31, v26, v27
    v_fma_f32 v32, v32, v26, v27
    v_fma_f32 v33, v33, v26, v27
    v_fma_f32 v34, v34, v26, v27
    v_fma_f32 v35, v35, v26, v27
    v_mfma_f32_32x32x16_bf16 v[112:127], a[92:95], v[140:143], v[112:127]
    s_waitcnt lgkmcnt(4)
    ds_read_b64_tr_b16 a[76:77], v9 offset:6144
    ds_read_b64_tr_b16 a[78:79], v9 offset:6656
    buffer_load_dwordx4 v17, s[12:15], s67 offen offset:3072 lds
    v_cvt_pk_bf16_f32 v148, v28, v29
    v_cvt_pk_bf16_f32 v149, v30, v31
    v_cvt_pk_bf16_f32 v150, v32, v33
    v_cvt_pk_bf16_f32 v151, v34, v35
    v_mfma_f32_32x32x16_bf16 v[64:79], a[64:67], v[144:147], v[64:79]
    s_waitcnt lgkmcnt(4)
    s_waitcnt vmcnt(20)
    s_barrier
    ds_read_b64_tr_b16 a[80:81], v10 offset:4096
    ds_read_b64_tr_b16 a[82:83], v10 offset:4608
    v_lshlrev_b32 v28, 16, v152
    v_and_b32 v29, s82, v152
    v_lshlrev_b32 v30, 16, v153
    v_and_b32_e64 v31, s82, v153
    v_lshlrev_b32 v32, 16, v154
    v_mfma_f32_32x32x16_bf16 v[80:95], a[68:71], v[144:147], v[80:95]
    s_waitcnt lgkmcnt(4)
    s_add_u32 m0, s53, 32768
    ds_read_b64_tr_b16 a[84:85], v10 offset:6144
    ds_read_b64_tr_b16 a[86:87], v10 offset:6656
    buffer_load_dwordx4 v18, s[8:11], s60 offen lds
    v_and_b32 v33, s82, v154
    v_lshlrev_b32 v34, 16, v155
    v_and_b32 v35, s82, v155
    v_fma_f32 v28, v28, v26, v27
    v_mfma_f32_32x32x16_bf16 v[96:111], a[72:75], v[144:147], v[96:111]
    s_waitcnt lgkmcnt(4)
    ds_read_b64_tr_b16 a[88:89], v11 offset:4096
    ds_read_b64_tr_b16 a[90:91], v11 offset:4608
    buffer_load_dwordx4 v19, s[8:11], s60 offen offset:1024 lds
    v_fma_f32 v29, v29, v26, v27
    v_fma_f32 v30, v30, v26, v27
    v_fma_f32 v31, v31, v26, v27
    v_fma_f32 v32, v32, v26, v27
    v_fma_f32 v33, v33, v26, v27
    v_fma_f32 v34, v34, v26, v27
    v_mfma_f32_32x32x16_bf16 v[112:127], a[76:79], v[144:147], v[112:127]
    s_waitcnt lgkmcnt(4)
    ds_read_b64_tr_b16 a[92:93], v11 offset:6144
    ds_read_b64_tr_b16 a[94:95], v11 offset:6656
    buffer_load_dwordx4 v18, s[12:15], s60 offen offset:2048 lds
    v_fma_f32 v35, v35, v26, v27
    v_cvt_pk_bf16_f32 v152, v28, v29
    v_cvt_pk_bf16_f32 v153, v30, v31
    v_cvt_pk_bf16_f32 v154, v32, v33
    v_cvt_pk_bf16_f32 v155, v34, v35
    v_mfma_f32_32x32x16_bf16 v[64:79], a[80:83], v[148:151], v[64:79]
    s_waitcnt lgkmcnt(4)
    ds_read_b64_tr_b16 a[64:65], v12 offset:4096
    ds_read_b64_tr_b16 a[66:67], v12 offset:4608
    v_lshlrev_b32 v28, 16, v156
    v_and_b32 v29, s82, v156
    v_lshlrev_b32 v30, 16, v157
    v_and_b32 v31, s82, v157
    v_lshlrev_b32_e64 v32, 16, v158
    v_and_b32 v33, s82, v158
    v_mfma_f32_32x32x16_bf16 v[80:95], a[84:87], v[148:151], v[80:95]
    s_waitcnt lgkmcnt(4)
    ds_read_b64_tr_b16 a[68:69], v12 offset:6144
    ds_read_b64_tr_b16 a[70:71], v12 offset:6656
    v_lshlrev_b32 v34, 16, v159
    v_and_b32 v35, s82, v159
    v_fma_f32 v28, v28, v26, v27
    v_fma_f32 v29, v29, v26, v27
    v_fma_f32 v30, v30, v26, v27
    v_mfma_f32_32x32x16_bf16 v[96:111], a[88:91], v[148:151], v[96:111]
    s_waitcnt lgkmcnt(4)
    ds_read_b64_tr_b16 a[72:73], v13 offset:4096
    ds_read_b64_tr_b16 a[74:75], v13 offset:4608
    buffer_load_dwordx4 v19, s[12:15], s60 offen offset:3072 lds
    v_fma_f32 v31, v31, v26, v27
    v_fma_f32 v32, v32, v26, v27
    v_fma_f32 v33, v33, v26, v27
    v_mfma_f32_32x32x16_bf16 v[112:127], a[92:95], v[148:151], v[112:127]
    s_waitcnt lgkmcnt(4)
    ds_read_b64_tr_b16 a[76:77], v13 offset:6144
    ds_read_b64_tr_b16 a[78:79], v13 offset:6656
    v_fma_f32 v34, v34, v26, v27
    v_fma_f32 v35, v35, v26, v27
    v_cvt_pk_bf16_f32 v156, v28, v29
    v_cvt_pk_bf16_f32 v157, v30, v31
    v_cvt_pk_bf16_f32 v158, v32, v33
    v_cvt_pk_bf16_f32 v159, v34, v35
    v_mfma_f32_32x32x16_bf16 v[64:79], a[64:67], v[152:155], v[64:79]
    s_waitcnt lgkmcnt(4)
    ds_read_b64_tr_b16 a[80:81], v14 offset:4096
    ds_read_b64_tr_b16 a[82:83], v14 offset:4608
    v_lshlrev_b32 v28, 16, v160
    v_and_b32 v29, s82, v160
    v_lshlrev_b32 v30, 16, v161
    v_and_b32 v31, s82, v161
    v_lshlrev_b32 v32, 16, v162
    v_and_b32 v33, s82, v162
    v_mfma_f32_32x32x16_bf16 v[80:95], a[68:71], v[152:155], v[80:95]
    s_waitcnt lgkmcnt(4)
    ds_read_b64_tr_b16 a[84:85], v14 offset:6144
    ds_read_b64_tr_b16 a[86:87], v14 offset:6656
    buffer_load_dword v58, v62, s[8:11], s1 offen
    v_lshlrev_b32_e64 v34, 16, v163
    v_and_b32 v35, s82, v163
    v_fma_f32 v28, v28, v26, v27
    v_fma_f32 v29, v29, v26, v27
    v_mfma_f32_32x32x16_bf16 v[96:111], a[72:75], v[152:155], v[96:111]
    s_waitcnt lgkmcnt(4)
    ds_read_b64_tr_b16 a[88:89], v15 offset:4096
    ds_read_b64_tr_b16 a[90:91], v15 offset:4608
    v_fma_f32 v30, v30, v26, v27
    v_fma_f32 v31, v31, v26, v27
    v_fma_f32 v32, v32, v26, v27
    v_fma_f32 v33, v33, v26, v27
    v_fma_f32 v34, v34, v26, v27
    v_fma_f32 v35, v35, v26, v27
    v_mfma_f32_32x32x16_bf16 v[112:127], a[76:79], v[152:155], v[112:127]
    s_waitcnt lgkmcnt(4)
    ds_read_b64_tr_b16 a[92:93], v15 offset:6144
    ds_read_b64_tr_b16 a[94:95], v15 offset:6656
    buffer_load_dword v59, v62, s[12:15], s49 offen
    v_cvt_pk_bf16_f32 v160, v28, v29
    v_cvt_pk_bf16_f32 v161, v30, v31
    v_cvt_pk_bf16_f32 v162, v32, v33
    v_cvt_pk_bf16_f32 v163, v34, v35
    v_mfma_f32_32x32x16_bf16 v[64:79], a[80:83], v[156:159], v[64:79]
    s_waitcnt lgkmcnt(4)
    ds_read_b64_tr_b16 a[64:65], v8 offset:8192
    ds_read_b64_tr_b16 a[66:67], v8 offset:8704
    v_lshlrev_b32 v28, 16, v164
    v_and_b32 v29, s82, v164
    v_lshlrev_b32 v30, 16, v165
    v_and_b32 v31, s82, v165
    v_lshlrev_b32_e64 v32, 16, v166
    v_and_b32 v33, s82, v166
    v_mfma_f32_32x32x16_bf16 v[80:95], a[84:87], v[156:159], v[80:95]
    s_waitcnt lgkmcnt(4)
    ds_read_b64_tr_b16 a[68:69], v8 offset:10240
    ds_read_b64_tr_b16 a[70:71], v8 offset:10752
    buffer_load_dword v7, v63, s[16:19], s50 offen
    v_lshlrev_b32_e64 v34, 16, v167
    v_and_b32 v35, s82, v167
    v_fma_f32 v28, v28, v26, v27
    v_fma_f32 v29, v29, v26, v27
    v_mfma_f32_32x32x16_bf16 v[96:111], a[88:91], v[156:159], v[96:111]
    s_waitcnt lgkmcnt(4)
    ds_read_b64_tr_b16 a[72:73], v9 offset:8192
    ds_read_b64_tr_b16 a[74:75], v9 offset:8704
    v_fma_f32 v30, v30, v26, v27
    v_fma_f32 v31, v31, v26, v27
    v_fma_f32 v32, v32, v26, v27
    v_fma_f32 v33, v33, v26, v27
    v_fma_f32 v34, v34, v26, v27
    v_fma_f32 v35, v35, v26, v27
    v_mfma_f32_32x32x16_bf16 v[112:127], a[92:95], v[156:159], v[112:127]
    s_waitcnt lgkmcnt(4)
    ds_read_b64_tr_b16 a[76:77], v9 offset:10240
    ds_read_b64_tr_b16 a[78:79], v9 offset:10752
    buffer_load_dword v25, v24, s[36:39], 0 offen sc1
    v_cvt_pk_bf16_f32 v164, v28, v29
    v_cvt_pk_bf16_f32 v165, v30, v31
    v_cvt_pk_bf16_f32 v166, v32, v33
    v_cvt_pk_bf16_f32 v167, v34, v35
    v_mfma_f32_32x32x16_bf16 v[64:79], a[64:67], v[160:163], v[64:79]
    s_waitcnt lgkmcnt(4)
    s_waitcnt vmcnt(24)
    s_barrier
    ds_read_b64_tr_b16 a[80:81], v10 offset:8192
    ds_read_b64_tr_b16 a[82:83], v10 offset:8704
    v_lshlrev_b32 v28, 16, v168
    v_and_b32 v29, s82, v168
    v_lshlrev_b32_e64 v30, 16, v169
    v_and_b32 v31, s82, v169
    v_mfma_f32_32x32x16_bf16 v[80:95], a[68:71], v[160:163], v[80:95]
    s_waitcnt lgkmcnt(4)
    ds_read_b64_tr_b16 a[84:85], v10 offset:10240
    ds_read_b64_tr_b16 a[86:87], v10 offset:10752
    buffer_load_ushort v42, v40, s[20:23], s72 offen
    v_lshlrev_b32 v32, 16, v170
    v_and_b32 v33, s82, v170
    v_lshlrev_b32_e64 v34, 16, v171
    v_and_b32 v35, s82, v171
    v_mfma_f32_32x32x16_bf16 v[96:111], a[72:75], v[160:163], v[96:111]
    s_waitcnt lgkmcnt(4)
    ds_read_b64_tr_b16 a[88:89], v11 offset:8192
    ds_read_b64_tr_b16 a[90:91], v11 offset:8704
    v_fma_f32 v28, v28, v26, v27
    v_fma_f32 v29, v29, v26, v27
    v_fma_f32 v30, v30, v26, v27
    v_fma_f32 v31, v31, v26, v27
    v_fma_f32 v32, v32, v26, v27
    v_fma_f32 v33, v33, v26, v27
    v_fma_f32 v34, v34, v26, v27
    v_mfma_f32_32x32x16_bf16 v[112:127], a[76:79], v[160:163], v[112:127]
    s_waitcnt lgkmcnt(4)
    ds_read_b64_tr_b16 a[92:93], v11 offset:10240
    ds_read_b64_tr_b16 a[94:95], v11 offset:10752
    buffer_load_ushort v50, v40, s[24:27], s72 offen
    v_fma_f32 v35, v35, v26, v27
    v_cvt_pk_bf16_f32 v168, v28, v29
    v_cvt_pk_bf16_f32 v169, v30, v31
    v_cvt_pk_bf16_f32 v170, v32, v33
    v_cvt_pk_bf16_f32 v171, v34, v35
    v_mfma_f32_32x32x16_bf16 v[64:79], a[80:83], v[164:167], v[64:79]
    s_waitcnt lgkmcnt(4)
    ds_read_b64_tr_b16 a[64:65], v12 offset:8192
    ds_read_b64_tr_b16 a[66:67], v12 offset:8704
    v_lshlrev_b32 v28, 16, v172
    v_and_b32 v29, s82, v172
    v_lshlrev_b32 v30, 16, v173
    v_and_b32 v31, s82, v173
    v_lshlrev_b32_e64 v32, 16, v174
    v_and_b32 v33, s82, v174
    v_mfma_f32_32x32x16_bf16 v[80:95], a[84:87], v[164:167], v[80:95]
    s_waitcnt lgkmcnt(4)
    ds_read_b64_tr_b16 a[68:69], v12 offset:10240
    ds_read_b64_tr_b16 a[70:71], v12 offset:10752
    buffer_load_ushort v43, v40, s[20:23], s72 offen offset:514
    v_lshlrev_b32_e64 v34, 16, v175
    v_and_b32 v35, s82, v175
    v_fma_f32 v28, v28, v26, v27
    v_fma_f32 v29, v29, v26, v27
    v_mfma_f32_32x32x16_bf16 v[96:111], a[88:91], v[164:167], v[96:111]
    s_waitcnt lgkmcnt(4)
    ds_read_b64_tr_b16 a[72:73], v13 offset:8192
    ds_read_b64_tr_b16 a[74:75], v13 offset:8704
    v_fma_f32 v30, v30, v26, v27
    v_fma_f32 v31, v31, v26, v27
    v_fma_f32 v32, v32, v26, v27
    v_fma_f32 v33, v33, v26, v27
    v_fma_f32 v34, v34, v26, v27
    v_fma_f32 v35, v35, v26, v27
    v_mfma_f32_32x32x16_bf16 v[112:127], a[92:95], v[164:167], v[112:127]
    s_waitcnt lgkmcnt(4)
    ds_read_b64_tr_b16 a[76:77], v13 offset:10240
    ds_read_b64_tr_b16 a[78:79], v13 offset:10752
    buffer_load_ushort v51, v40, s[24:27], s72 offen offset:514
    v_cvt_pk_bf16_f32 v172, v28, v29
    v_cvt_pk_bf16_f32 v173, v30, v31
    v_cvt_pk_bf16_f32 v174, v32, v33
    v_cvt_pk_bf16_f32 v175, v34, v35
    v_mfma_f32_32x32x16_bf16 v[64:79], a[64:67], v[168:171], v[64:79]
    s_waitcnt lgkmcnt(4)
    ds_read_b64_tr_b16 a[80:81], v14 offset:8192
    ds_read_b64_tr_b16 a[82:83], v14 offset:8704
    v_lshlrev_b32 v28, 16, v176
    v_and_b32 v29, s82, v176
    v_lshlrev_b32 v30, 16, v177
    v_and_b32 v31, s82, v177
    v_lshlrev_b32_e64 v32, 16, v178
    v_and_b32 v33, s82, v178
    v_mfma_f32_32x32x16_bf16 v[80:95], a[68:71], v[168:171], v[80:95]
    s_waitcnt lgkmcnt(4)
    ds_read_b64_tr_b16 a[84:85], v14 offset:10240
    ds_read_b64_tr_b16 a[86:87], v14 offset:10752
    buffer_load_ushort v44, v40, s[20:23], s72 offen offset:1028
    v_lshlrev_b32_e64 v34, 16, v179
    v_and_b32 v35, s82, v179
    v_fma_f32 v28, v28, v26, v27
    v_fma_f32 v29, v29, v26, v27
    v_mfma_f32_32x32x16_bf16 v[96:111], a[72:75], v[168:171], v[96:111]
    s_waitcnt lgkmcnt(4)
    ds_read_b64_tr_b16 a[88:89], v15 offset:8192
    ds_read_b64_tr_b16 a[90:91], v15 offset:8704
    v_fma_f32 v30, v30, v26, v27
    v_fma_f32 v31, v31, v26, v27
    v_fma_f32 v32, v32, v26, v27
    v_fma_f32 v33, v33, v26, v27
    v_fma_f32 v34, v34, v26, v27
    v_fma_f32 v35, v35, v26, v27
    v_mfma_f32_32x32x16_bf16 v[112:127], a[76:79], v[168:171], v[112:127]
    s_waitcnt lgkmcnt(4)
    ds_read_b64_tr_b16 a[92:93], v15 offset:10240
    ds_read_b64_tr_b16 a[94:95], v15 offset:10752
    buffer_load_ushort v52, v40, s[24:27], s72 offen offset:1028
    v_cvt_pk_bf16_f32 v176, v28, v29
    v_cvt_pk_bf16_f32 v177, v30, v31
    v_cvt_pk_bf16_f32 v178, v32, v33
    v_cvt_pk_bf16_f32 v179, v34, v35
    v_mfma_f32_32x32x16_bf16 v[64:79], a[80:83], v[172:175], v[64:79]
    s_waitcnt lgkmcnt(4)
    ds_read_b64_tr_b16 a[64:65], v8 offset:12288
    ds_read_b64_tr_b16 a[66:67], v8 offset:12800
    v_lshlrev_b32 v28, 16, v180
    v_and_b32 v29, s82, v180
    v_lshlrev_b32 v30, 16, v181
    v_and_b32 v31, s82, v181
    v_lshlrev_b32_e64 v32, 16, v182
    v_and_b32 v33, s82, v182
    v_mfma_f32_32x32x16_bf16 v[80:95], a[84:87], v[172:175], v[80:95]
    s_waitcnt lgkmcnt(4)
    ds_read_b64_tr_b16 a[68:69], v8 offset:14336
    ds_read_b64_tr_b16 a[70:71], v8 offset:14848
    buffer_load_ushort v45, v40, s[20:23], s72 offen offset:1542
    v_lshlrev_b32_e64 v34, 16, v183
    v_and_b32 v35, s82, v183
    v_fma_f32 v28, v28, v26, v27
    v_fma_f32 v29, v29, v26, v27
    v_mfma_f32_32x32x16_bf16 v[96:111], a[88:91], v[172:175], v[96:111]
    s_waitcnt lgkmcnt(4)
    ds_read_b64_tr_b16 a[72:73], v9 offset:12288
    ds_read_b64_tr_b16 a[74:75], v9 offset:12800
    v_fma_f32 v30, v30, v26, v27
    v_fma_f32 v31, v31, v26, v27
    v_fma_f32 v32, v32, v26, v27
    v_fma_f32 v33, v33, v26, v27
    v_fma_f32 v34, v34, v26, v27
    v_fma_f32 v35, v35, v26, v27
    v_mfma_f32_32x32x16_bf16 v[112:127], a[92:95], v[172:175], v[112:127]
    s_waitcnt lgkmcnt(4)
    ds_read_b64_tr_b16 a[76:77], v9 offset:14336
    ds_read_b64_tr_b16 a[78:79], v9 offset:14848
    buffer_load_ushort v53, v40, s[24:27], s72 offen offset:1542
    v_cvt_pk_bf16_f32 v180, v28, v29
    v_cvt_pk_bf16_f32 v181, v30, v31
    v_cvt_pk_bf16_f32 v182, v32, v33
    v_cvt_pk_bf16_f32 v183, v34, v35
    v_mfma_f32_32x32x16_bf16 v[64:79], a[64:67], v[176:179], v[64:79]
    s_waitcnt lgkmcnt(4)
    s_waitcnt vmcnt(28)
    s_barrier
    ds_read_b64_tr_b16 a[80:81], v10 offset:12288
    ds_read_b64_tr_b16 a[82:83], v10 offset:12800
    v_lshlrev_b32 v28, 16, v184
    v_and_b32 v29, s82, v184
    v_lshlrev_b32_e64 v30, 16, v185
    v_and_b32 v31, s82, v185
    v_mfma_f32_32x32x16_bf16 v[80:95], a[68:71], v[176:179], v[80:95]
    s_waitcnt lgkmcnt(4)
    ds_read_b64_tr_b16 a[84:85], v10 offset:14336
    ds_read_b64_tr_b16 a[86:87], v10 offset:14848
    buffer_load_ushort v46, v40, s[20:23], s73 offen
    v_lshlrev_b32 v32, 16, v186
    v_and_b32 v33, s82, v186
    v_lshlrev_b32_e64 v34, 16, v187
    v_and_b32 v35, s82, v187
    v_mfma_f32_32x32x16_bf16 v[96:111], a[72:75], v[176:179], v[96:111]
    s_waitcnt lgkmcnt(4)
    ds_read_b64_tr_b16 a[88:89], v11 offset:12288
    ds_read_b64_tr_b16 a[90:91], v11 offset:12800
    v_fma_f32 v28, v28, v26, v27
    v_fma_f32 v29, v29, v26, v27
    v_fma_f32 v30, v30, v26, v27
    v_fma_f32 v31, v31, v26, v27
    v_fma_f32 v32, v32, v26, v27
    v_fma_f32 v33, v33, v26, v27
    v_fma_f32 v34, v34, v26, v27
    v_mfma_f32_32x32x16_bf16 v[112:127], a[76:79], v[176:179], v[112:127]
    s_waitcnt lgkmcnt(4)
    ds_read_b64_tr_b16 a[92:93], v11 offset:14336
    ds_read_b64_tr_b16 a[94:95], v11 offset:14848
    buffer_load_ushort v54, v40, s[24:27], s73 offen
    v_fma_f32 v35, v35, v26, v27
    v_cvt_pk_bf16_f32 v184, v28, v29
    v_cvt_pk_bf16_f32 v185, v30, v31
    v_cvt_pk_bf16_f32 v186, v32, v33
    v_cvt_pk_bf16_f32 v187, v34, v35
    v_mfma_f32_32x32x16_bf16 v[64:79], a[80:83], v[180:183], v[64:79]
    s_waitcnt lgkmcnt(4)
    ds_read_b64_tr_b16 a[64:65], v12 offset:12288
    ds_read_b64_tr_b16 a[66:67], v12 offset:12800
    v_lshlrev_b32 v28, 16, v188
    v_and_b32 v29, s82, v188
    v_lshlrev_b32 v30, 16, v189
    v_and_b32 v31, s82, v189
    v_lshlrev_b32_e64 v32, 16, v190
    v_and_b32 v33, s82, v190
    v_mfma_f32_32x32x16_bf16 v[80:95], a[84:87], v[180:183], v[80:95]
    s_waitcnt lgkmcnt(4)
    ds_read_b64_tr_b16 a[68:69], v12 offset:14336
    ds_read_b64_tr_b16 a[70:71], v12 offset:14848
    buffer_load_ushort v47, v40, s[20:23], s73 offen offset:514
    v_lshlrev_b32_e64 v34, 16, v191
    v_and_b32 v35, s82, v191
    v_fma_f32 v28, v28, v26, v27
    v_fma_f32 v29, v29, v26, v27
    v_mfma_f32_32x32x16_bf16 v[96:111], a[88:91], v[180:183], v[96:111]
    s_waitcnt lgkmcnt(4)
    ds_read_b64_tr_b16 a[72:73], v13 offset:12288
    ds_read_b64_tr_b16 a[74:75], v13 offset:12800
    v_fma_f32 v30, v30, v26, v27
    v_fma_f32 v31, v31, v26, v27
    v_fma_f32 v32, v32, v26, v27
    v_fma_f32 v33, v33, v26, v27
    v_fma_f32 v34, v34, v26, v27
    v_fma_f32 v35, v35, v26, v27
    v_mfma_f32_32x32x16_bf16 v[112:127], a[92:95], v[180:183], v[112:127]
    s_waitcnt lgkmcnt(4)
    ds_read_b64_tr_b16 a[76:77], v13 offset:14336
    ds_read_b64_tr_b16 a[78:79], v13 offset:14848
    buffer_load_ushort v55, v40, s[24:27], s73 offen offset:514
    v_cvt_pk_bf16_f32 v188, v28, v29
    v_cvt_pk_bf16_f32 v189, v30, v31
    v_cvt_pk_bf16_f32 v190, v32, v33
    v_cvt_pk_bf16_f32 v191, v34, v35
    v_mfma_f32_32x32x16_bf16 v[64:79], a[64:67], v[184:187], v[64:79]
    s_waitcnt lgkmcnt(4)
    ds_read_b64_tr_b16 a[80:81], v14 offset:12288
    ds_read_b64_tr_b16 a[82:83], v14 offset:12800
    v_lshlrev_b32 v28, 16, v192
    v_and_b32 v29, s82, v192
    v_lshlrev_b32 v30, 16, v193
    v_and_b32 v31, s82, v193
    v_lshlrev_b32_e64 v32, 16, v194
    v_and_b32 v33, s82, v194
    v_mfma_f32_32x32x16_bf16 v[80:95], a[68:71], v[184:187], v[80:95]
    s_waitcnt lgkmcnt(4)
    ds_read_b64_tr_b16 a[84:85], v14 offset:14336
    ds_read_b64_tr_b16 a[86:87], v14 offset:14848
    buffer_load_ushort v48, v40, s[20:23], s73 offen offset:1028
    v_lshlrev_b32_e64 v34, 16, v195
    v_and_b32 v35, s82, v195
    v_fma_f32 v28, v28, v26, v27
    v_fma_f32 v29, v29, v26, v27
    v_mfma_f32_32x32x16_bf16 v[96:111], a[72:75], v[184:187], v[96:111]
    s_waitcnt lgkmcnt(4)
    ds_read_b64_tr_b16 a[88:89], v15 offset:12288
    ds_read_b64_tr_b16 a[90:91], v15 offset:12800
    v_fma_f32 v30, v30, v26, v27
    v_fma_f32 v31, v31, v26, v27
    v_fma_f32 v32, v32, v26, v27
    v_fma_f32 v33, v33, v26, v27
    v_fma_f32 v34, v34, v26, v27
    v_fma_f32 v35, v35, v26, v27
    v_mfma_f32_32x32x16_bf16 v[112:127], a[76:79], v[184:187], v[112:127]
    s_waitcnt lgkmcnt(4)
    ds_read_b64_tr_b16 a[92:93], v15 offset:14336
    ds_read_b64_tr_b16 a[94:95], v15 offset:14848
    buffer_load_ushort v56, v40, s[24:27], s73 offen offset:1028
    v_cvt_pk_bf16_f32 v192, v28, v29
    v_cvt_pk_bf16_f32 v193, v30, v31
    v_cvt_pk_bf16_f32 v194, v32, v33
    v_cvt_pk_bf16_f32 v195, v34, v35
    v_mfma_f32_32x32x16_bf16 v[64:79], a[80:83], v[188:191], v[64:79]
    s_waitcnt lgkmcnt(4)
    ds_read_b64_tr_b16 a[64:65], v8 offset:16384
    ds_read_b64_tr_b16 a[66:67], v8 offset:16896
    v_lshlrev_b32 v28, 16, v196
    v_and_b32 v29, s82, v196
    v_lshlrev_b32 v30, 16, v197
    v_and_b32 v31, s82, v197
    v_lshlrev_b32_e64 v32, 16, v198
    v_and_b32 v33, s82, v198
    v_mfma_f32_32x32x16_bf16 v[80:95], a[84:87], v[188:191], v[80:95]
    s_waitcnt lgkmcnt(4)
    ds_read_b64_tr_b16 a[68:69], v8 offset:18432
    ds_read_b64_tr_b16 a[70:71], v8 offset:18944
    buffer_load_ushort v49, v40, s[20:23], s73 offen offset:1542
    v_lshlrev_b32_e64 v34, 16, v199
    v_and_b32 v35, s82, v199
    v_fma_f32 v28, v28, v26, v27
    v_fma_f32 v29, v29, v26, v27
    v_mfma_f32_32x32x16_bf16 v[96:111], a[88:91], v[188:191], v[96:111]
    s_waitcnt lgkmcnt(4)
    ds_read_b64_tr_b16 a[72:73], v9 offset:16384
    ds_read_b64_tr_b16 a[74:75], v9 offset:16896
    v_fma_f32 v30, v30, v26, v27
    v_fma_f32 v31, v31, v26, v27
    v_fma_f32 v32, v32, v26, v27
    v_fma_f32 v33, v33, v26, v27
    v_fma_f32 v34, v34, v26, v27
    v_fma_f32 v35, v35, v26, v27
    v_mfma_f32_32x32x16_bf16 v[112:127], a[92:95], v[188:191], v[112:127]
    s_waitcnt lgkmcnt(4)
    ds_read_b64_tr_b16 a[76:77], v9 offset:18432
    ds_read_b64_tr_b16 a[78:79], v9 offset:18944
    buffer_load_ushort v57, v40, s[24:27], s73 offen offset:1542
    v_cvt_pk_bf16_f32 v196, v28, v29
    v_cvt_pk_bf16_f32 v197, v30, v31
    v_cvt_pk_bf16_f32 v198, v32, v33
    v_cvt_pk_bf16_f32 v199, v34, v35
    v_mfma_f32_32x32x16_bf16 v[64:79], a[64:67], v[192:195], v[64:79]
    s_waitcnt lgkmcnt(4)
    s_waitcnt vmcnt(32)
    s_barrier
    ds_read_b64_tr_b16 a[80:81], v10 offset:16384
    ds_read_b64_tr_b16 a[82:83], v10 offset:16896
    v_lshlrev_b32 v28, 16, v200
    v_and_b32 v29, s82, v200
    v_lshlrev_b32_e64 v30, 16, v201
    v_and_b32 v31, s82, v201
    v_mfma_f32_32x32x16_bf16 v[80:95], a[68:71], v[192:195], v[80:95]
    s_waitcnt lgkmcnt(4)
    s_mov_b32 s0, 524288
    ds_read_b64_tr_b16 a[84:85], v10 offset:18432
    ds_read_b64_tr_b16 a[86:87], v10 offset:18944
    buffer_load_dwordx4 a[120:123], v2, s[40:43], s0 offen
    v_lshlrev_b32 v32, 16, v202
    v_and_b32 v33, s82, v202
    v_lshlrev_b32_e64 v34, 16, v203
    v_and_b32 v35, s82, v203
    v_mfma_f32_32x32x16_bf16 v[96:111], a[72:75], v[192:195], v[96:111]
    s_waitcnt lgkmcnt(4)
    ds_read_b64_tr_b16 a[88:89], v11 offset:16384
    ds_read_b64_tr_b16 a[90:91], v11 offset:16896
    v_fma_f32 v28, v28, v26, v27
    v_fma_f32 v29, v29, v26, v27
    v_fma_f32 v30, v30, v26, v27
    v_fma_f32 v31, v31, v26, v27
    v_fma_f32 v32, v32, v26, v27
    v_fma_f32 v33, v33, v26, v27
    v_fma_f32 v34, v34, v26, v27
    v_mfma_f32_32x32x16_bf16 v[112:127], a[76:79], v[192:195], v[112:127]
    s_waitcnt lgkmcnt(4)
    ds_read_b64_tr_b16 a[92:93], v11 offset:18432
    ds_read_b64_tr_b16 a[94:95], v11 offset:18944
    buffer_load_dwordx4 a[124:127], v2, s[40:43], s0 offen offset:1024
    v_fma_f32 v35, v35, v26, v27
    v_cvt_pk_bf16_f32 v200, v28, v29
    v_cvt_pk_bf16_f32 v201, v30, v31
    v_cvt_pk_bf16_f32 v202, v32, v33
    v_cvt_pk_bf16_f32 v203, v34, v35
    v_mfma_f32_32x32x16_bf16 v[64:79], a[80:83], v[196:199], v[64:79]
    s_waitcnt lgkmcnt(4)
    ds_read_b64_tr_b16 a[64:65], v12 offset:16384
    ds_read_b64_tr_b16 a[66:67], v12 offset:16896
    v_lshlrev_b32 v28, 16, v204
    v_and_b32 v29, s82, v204
    v_lshlrev_b32 v30, 16, v205
    v_and_b32 v31, s82, v205
    v_lshlrev_b32_e64 v32, 16, v206
    v_and_b32 v33, s82, v206
    v_mfma_f32_32x32x16_bf16 v[80:95], a[84:87], v[196:199], v[80:95]
    s_waitcnt lgkmcnt(4)
    ds_read_b64_tr_b16 a[68:69], v12 offset:18432
    ds_read_b64_tr_b16 a[70:71], v12 offset:18944
    buffer_load_dwordx4 a[128:131], v2, s[40:43], s0 offen offset:2048
    v_lshlrev_b32_e64 v34, 16, v207
    v_and_b32 v35, s82, v207
    v_fma_f32 v28, v28, v26, v27
    v_fma_f32 v29, v29, v26, v27
    v_mfma_f32_32x32x16_bf16 v[96:111], a[88:91], v[196:199], v[96:111]
    s_waitcnt lgkmcnt(4)
    ds_read_b64_tr_b16 a[72:73], v13 offset:16384
    ds_read_b64_tr_b16 a[74:75], v13 offset:16896
    v_fma_f32 v30, v30, v26, v27
    v_fma_f32 v31, v31, v26, v27
    v_fma_f32 v32, v32, v26, v27
    v_fma_f32 v33, v33, v26, v27
    v_fma_f32 v34, v34, v26, v27
    v_fma_f32 v35, v35, v26, v27
    v_mfma_f32_32x32x16_bf16 v[112:127], a[92:95], v[196:199], v[112:127]
    s_waitcnt lgkmcnt(4)
    ds_read_b64_tr_b16 a[76:77], v13 offset:18432
    ds_read_b64_tr_b16 a[78:79], v13 offset:18944
    buffer_load_dwordx4 a[132:135], v2, s[40:43], s0 offen offset:3072
    v_cvt_pk_bf16_f32 v204, v28, v29
    v_cvt_pk_bf16_f32 v205, v30, v31
    v_cvt_pk_bf16_f32 v206, v32, v33
    v_cvt_pk_bf16_f32 v207, v34, v35
    v_mfma_f32_32x32x16_bf16 v[64:79], a[64:67], v[200:203], v[64:79]
    s_waitcnt lgkmcnt(4)
    ds_read_b64_tr_b16 a[80:81], v14 offset:16384
    ds_read_b64_tr_b16 a[82:83], v14 offset:16896
    v_lshlrev_b32 v28, 16, v208
    v_and_b32 v29, s82, v208
    v_lshlrev_b32 v30, 16, v209
    v_and_b32 v31, s82, v209
    v_lshlrev_b32 v32, 16, v210
    v_and_b32 v33, s82, v210
    v_lshlrev_b32 v34, 16, v211
    v_mfma_f32_32x32x16_bf16 v[80:95], a[68:71], v[200:203], v[80:95]
    s_waitcnt lgkmcnt(4)
    s_mov_b32 s0, 528384
    ds_read_b64_tr_b16 a[84:85], v14 offset:18432
    ds_read_b64_tr_b16 a[86:87], v14 offset:18944
    buffer_load_dwordx4 a[136:139], v2, s[40:43], s0 offen
    v_and_b32 v35, s82, v211
    v_fma_f32 v28, v28, v26, v27
    v_fma_f32 v29, v29, v26, v27
    v_mfma_f32_32x32x16_bf16 v[96:111], a[72:75], v[200:203], v[96:111]
    s_waitcnt lgkmcnt(4)
    ds_read_b64_tr_b16 a[88:89], v15 offset:16384
    ds_read_b64_tr_b16 a[90:91], v15 offset:16896
    v_fma_f32 v30, v30, v26, v27
    v_fma_f32 v31, v31, v26, v27
    v_fma_f32 v32, v32, v26, v27
    v_fma_f32 v33, v33, v26, v27
    v_fma_f32 v34, v34, v26, v27
    v_fma_f32 v35, v35, v26, v27
    v_mfma_f32_32x32x16_bf16 v[112:127], a[76:79], v[200:203], v[112:127]
    s_waitcnt lgkmcnt(4)
    ds_read_b64_tr_b16 a[92:93], v15 offset:18432
    ds_read_b64_tr_b16 a[94:95], v15 offset:18944
    buffer_load_dwordx4 a[140:143], v2, s[40:43], s0 offen offset:1024
    v_cvt_pk_bf16_f32 v208, v28, v29
    v_cvt_pk_bf16_f32 v209, v30, v31
    v_cvt_pk_bf16_f32 v210, v32, v33
    v_cvt_pk_bf16_f32 v211, v34, v35
    v_mfma_f32_32x32x16_bf16 v[64:79], a[80:83], v[204:207], v[64:79]
    s_waitcnt lgkmcnt(4)
    ds_read_b64_tr_b16 a[64:65], v8 offset:20480
    ds_read_b64_tr_b16 a[66:67], v8 offset:20992
    v_lshlrev_b32 v28, 16, v212
    v_and_b32 v29, s82, v212
    v_lshlrev_b32 v30, 16, v213
    v_and_b32 v31, s82, v213
    v_lshlrev_b32 v32, 16, v214
    v_mfma_f32_32x32x16_bf16 v[80:95], a[84:87], v[204:207], v[80:95]
    s_waitcnt lgkmcnt(4)
    ds_read_b64_tr_b16 a[68:69], v8 offset:22528
    ds_read_b64_tr_b16 a[70:71], v8 offset:23040
    v_and_b32 v33, s82, v214
    v_lshlrev_b32 v34, 16, v215
    v_and_b32_e64 v35, s82, v215
    v_fma_f32 v28, v28, v26, v27
    v_fma_f32 v29, v29, v26, v27
    v_mfma_f32_32x32x16_bf16 v[96:111], a[88:91], v[204:207], v[96:111]
    s_waitcnt lgkmcnt(4)
    ds_read_b64_tr_b16 a[72:73], v9 offset:20480
    ds_read_b64_tr_b16 a[74:75], v9 offset:20992
    v_fma_f32 v30, v30, v26, v27
    v_fma_f32 v31, v31, v26, v27
    v_fma_f32 v32, v32, v26, v27
    v_fma_f32 v33, v33, v26, v27
    v_fma_f32 v34, v34, v26, v27
    v_mfma_f32_32x32x16_bf16 v[112:127], a[92:95], v[204:207], v[112:127]
    s_waitcnt lgkmcnt(4)
    ds_read_b64_tr_b16 a[76:77], v9 offset:22528
    ds_read_b64_tr_b16 a[78:79], v9 offset:23040
    v_fma_f32 v35, v35, v26, v27
    v_cvt_pk_bf16_f32 v212, v28, v29
    v_cvt_pk_bf16_f32 v213, v30, v31
    v_cvt_pk_bf16_f32 v214, v32, v33
    v_cvt_pk_bf16_f32 v215, v34, v35
    v_mfma_f32_32x32x16_bf16 v[64:79], a[64:67], v[208:211], v[64:79]
    s_waitcnt lgkmcnt(4)
    s_waitcnt vmcnt(34)
    s_barrier
    ds_read_b64_tr_b16 a[80:81], v10 offset:20480
    ds_read_b64_tr_b16 a[82:83], v10 offset:20992
    v_lshlrev_b32 v28, 16, v216
    v_and_b32 v29, s82, v216
    v_mfma_f32_32x32x16_bf16 v[80:95], a[68:71], v[208:211], v[80:95]
    s_waitcnt lgkmcnt(4)
    ds_read_b64_tr_b16 a[84:85], v10 offset:22528
    ds_read_b64_tr_b16 a[86:87], v10 offset:23040
    v_lshlrev_b32 v30, 16, v217
    v_and_b32 v31, s82, v217
    v_lshlrev_b32 v32, 16, v218
    v_and_b32 v33, s82, v218
    v_lshlrev_b32_e64 v34, 16, v219
    v_and_b32 v35, s82, v219
    v_mfma_f32_32x32x16_bf16 v[96:111], a[72:75], v[208:211], v[96:111]
    s_waitcnt lgkmcnt(4)
    ds_read_b64_tr_b16 a[88:89], v11 offset:20480
    ds_read_b64_tr_b16 a[90:91], v11 offset:20992
    v_fma_f32 v28, v28, v26, v27
    v_fma_f32 v29, v29, v26, v27
    v_fma_f32 v30, v30, v26, v27
    v_fma_f32 v31, v31, v26, v27
    v_fma_f32 v32, v32, v26, v27
    v_fma_f32 v33, v33, v26, v27
    v_mfma_f32_32x32x16_bf16 v[112:127], a[76:79], v[208:211], v[112:127]
    s_waitcnt lgkmcnt(4)
    ds_read_b64_tr_b16 a[92:93], v11 offset:22528
    ds_read_b64_tr_b16 a[94:95], v11 offset:23040
    v_fma_f32 v34, v34, v26, v27
    v_fma_f32 v35, v35, v26, v27
    v_cvt_pk_bf16_f32 v216, v28, v29
    v_cvt_pk_bf16_f32 v217, v30, v31
    v_cvt_pk_bf16_f32 v218, v32, v33
    v_cvt_pk_bf16_f32 v219, v34, v35
    v_mfma_f32_32x32x16_bf16 v[64:79], a[80:83], v[212:215], v[64:79]
    s_waitcnt lgkmcnt(4)
    ds_read_b64_tr_b16 a[64:65], v12 offset:20480
    ds_read_b64_tr_b16 a[66:67], v12 offset:20992
    v_lshlrev_b32 v28, 16, v220
    v_and_b32 v29, s82, v220
    v_lshlrev_b32 v30, 16, v221
    v_and_b32 v31, s82, v221
    v_lshlrev_b32 v32, 16, v222
    v_mfma_f32_32x32x16_bf16 v[80:95], a[84:87], v[212:215], v[80:95]
    s_waitcnt lgkmcnt(4)
    ds_read_b64_tr_b16 a[68:69], v12 offset:22528
    ds_read_b64_tr_b16 a[70:71], v12 offset:23040
    v_and_b32 v33, s82, v222
    v_lshlrev_b32 v34, 16, v223
    v_and_b32_e64 v35, s82, v223
    v_fma_f32 v28, v28, v26, v27
    v_fma_f32 v29, v29, v26, v27
    v_mfma_f32_32x32x16_bf16 v[96:111], a[88:91], v[212:215], v[96:111]
    s_waitcnt lgkmcnt(4)
    ds_read_b64_tr_b16 a[72:73], v13 offset:20480
    ds_read_b64_tr_b16 a[74:75], v13 offset:20992
    v_fma_f32 v30, v30, v26, v27
    v_fma_f32 v31, v31, v26, v27
    v_fma_f32 v32, v32, v26, v27
    v_fma_f32 v33, v33, v26, v27
    v_fma_f32 v34, v34, v26, v27
    v_mfma_f32_32x32x16_bf16 v[112:127], a[92:95], v[212:215], v[112:127]
    s_waitcnt lgkmcnt(4)
    ds_read_b64_tr_b16 a[76:77], v13 offset:22528
    ds_read_b64_tr_b16 a[78:79], v13 offset:23040
    v_fma_f32 v35, v35, v26, v27
    v_cvt_pk_bf16_f32 v220, v28, v29
    v_cvt_pk_bf16_f32 v221, v30, v31
    v_cvt_pk_bf16_f32 v222, v32, v33
    v_cvt_pk_bf16_f32 v223, v34, v35
    v_mfma_f32_32x32x16_bf16 v[64:79], a[64:67], v[216:219], v[64:79]
    s_waitcnt lgkmcnt(4)
    ds_read_b64_tr_b16 a[80:81], v14 offset:20480
    ds_read_b64_tr_b16 a[82:83], v14 offset:20992
    v_lshlrev_b32 v28, 16, v224
    v_and_b32 v29, s82, v224
    v_lshlrev_b32 v30, 16, v225
    v_and_b32_e64 v31, s82, v225
    v_lshlrev_b32 v32, 16, v226
    v_mfma_f32_32x32x16_bf16 v[80:95], a[68:71], v[216:219], v[80:95]
    s_waitcnt lgkmcnt(4)
    ds_read_b64_tr_b16 a[84:85], v14 offset:22528
    ds_read_b64_tr_b16 a[86:87], v14 offset:23040
    v_and_b32 v33, s82, v226
    v_lshlrev_b32 v34, 16, v227
    v_and_b32_e64 v35, s82, v227
    v_fma_f32 v28, v28, v26, v27
    v_fma_f32 v29, v29, v26, v27
    v_mfma_f32_32x32x16_bf16 v[96:111], a[72:75], v[216:219], v[96:111]
    s_waitcnt lgkmcnt(4)
    ds_read_b64_tr_b16 a[88:89], v15 offset:20480
    ds_read_b64_tr_b16 a[90:91], v15 offset:20992
    v_fma_f32 v30, v30, v26, v27
    v_fma_f32 v31, v31, v26, v27
    v_fma_f32 v32, v32, v26, v27
    v_fma_f32 v33, v33, v26, v27
    v_fma_f32 v34, v34, v26, v27
    v_mfma_f32_32x32x16_bf16 v[112:127], a[76:79], v[216:219], v[112:127]
    s_waitcnt lgkmcnt(4)
    ds_read_b64_tr_b16 a[92:93], v15 offset:22528
    ds_read_b64_tr_b16 a[94:95], v15 offset:23040
    v_fma_f32 v35, v35, v26, v27
    v_cvt_pk_bf16_f32 v224, v28, v29
    v_cvt_pk_bf16_f32 v225, v30, v31
    v_cvt_pk_bf16_f32 v226, v32, v33
    v_cvt_pk_bf16_f32 v227, v34, v35
    v_mfma_f32_32x32x16_bf16 v[64:79], a[80:83], v[220:223], v[64:79]
    s_waitcnt lgkmcnt(4)
    ds_read_b64_tr_b16 a[64:65], v8 offset:24576
    ds_read_b64_tr_b16 a[66:67], v8 offset:25088
    v_lshlrev_b32 v28, 16, v228
    v_and_b32 v29, s82, v228
    v_lshlrev_b32 v30, 16, v229
    v_and_b32 v31, s82, v229
    v_lshlrev_b32 v32, 16, v230
    v_and_b32 v33, s82, v230
    v_mfma_f32_32x32x16_bf16 v[80:95], a[84:87], v[220:223], v[80:95]
    s_waitcnt lgkmcnt(4)
    ds_read_b64_tr_b16 a[68:69], v8 offset:26624
    ds_read_b64_tr_b16 a[70:71], v8 offset:27136
    v_lshlrev_b32 v34, 16, v231
    v_and_b32 v35, s82, v231
    v_fma_f32 v28, v28, v26, v27
    v_fma_f32 v29, v29, v26, v27
    v_fma_f32 v30, v30, v26, v27
    v_fma_f32 v31, v31, v26, v27
    v_mfma_f32_32x32x16_bf16 v[96:111], a[88:91], v[220:223], v[96:111]
    s_waitcnt lgkmcnt(4)
    ds_read_b64_tr_b16 a[72:73], v9 offset:24576
    ds_read_b64_tr_b16 a[74:75], v9 offset:25088
    v_fma_f32 v32, v32, v26, v27
    v_fma_f32 v33, v33, v26, v27
    v_fma_f32 v34, v34, v26, v27
    v_fma_f32 v35, v35, v26, v27
    v_cvt_pk_bf16_f32 v228, v28, v29
    v_mfma_f32_32x32x16_bf16 v[112:127], a[92:95], v[220:223], v[112:127]
    s_waitcnt lgkmcnt(4)
    ds_read_b64_tr_b16 a[76:77], v9 offset:26624
    ds_read_b64_tr_b16 a[78:79], v9 offset:27136
    v_cvt_pk_bf16_f32 v229, v30, v31
    v_cvt_pk_bf16_f32 v230, v32, v33
    v_cvt_pk_bf16_f32 v231, v34, v35
    v_lshlrev_b32 v28, 16, v232
    v_and_b32 v29, s82, v232
    v_lshlrev_b32 v30, 16, v233
    v_mfma_f32_32x32x16_bf16 v[64:79], a[64:67], v[224:227], v[64:79]
    s_waitcnt lgkmcnt(4)
    s_waitcnt vmcnt(30)
    s_barrier
    ds_read_b64_tr_b16 a[80:81], v10 offset:24576
    ds_read_b64_tr_b16 a[82:83], v10 offset:25088
    v_and_b32 v31, s82, v233
    v_lshlrev_b32 v32, 16, v234
    v_and_b32 v33, s82, v234
    v_mfma_f32_32x32x16_bf16 v[80:95], a[68:71], v[224:227], v[80:95]
    s_waitcnt lgkmcnt(4)
    ds_read_b64_tr_b16 a[84:85], v10 offset:26624
    ds_read_b64_tr_b16 a[86:87], v10 offset:27136
    v_lshlrev_b32 v34, 16, v235
    v_and_b32 v35, s82, v235
    v_fma_f32 v28, v28, v26, v27
    v_fma_f32 v29, v29, v26, v27
    v_fma_f32 v30, v30, v26, v27
    v_fma_f32 v31, v31, v26, v27
    v_fma_f32 v32, v32, v26, v27
    v_mfma_f32_32x32x16_bf16 v[96:111], a[72:75], v[224:227], v[96:111]
    s_waitcnt lgkmcnt(4)
    ds_read_b64_tr_b16 a[88:89], v11 offset:24576
    ds_read_b64_tr_b16 a[90:91], v11 offset:25088
    v_fma_f32 v33, v33, v26, v27
    v_fma_f32 v34, v34, v26, v27
    v_fma_f32 v35, v35, v26, v27
    v_cvt_pk_bf16_f32 v232, v28, v29
    v_cvt_pk_bf16_f32 v233, v30, v31
    v_cvt_pk_bf16_f32 v234, v32, v33
    v_mfma_f32_32x32x16_bf16 v[112:127], a[76:79], v[224:227], v[112:127]
    s_waitcnt lgkmcnt(4)
    ds_read_b64_tr_b16 a[92:93], v11 offset:26624
    ds_read_b64_tr_b16 a[94:95], v11 offset:27136
    v_cvt_pk_bf16_f32 v235, v34, v35
    v_lshlrev_b32 v28, 16, v236
    v_and_b32 v29, s82, v236
    v_lshlrev_b32 v30, 16, v237
    v_and_b32 v31, s82, v237
    v_lshlrev_b32_e64 v32, 16, v238
    v_and_b32 v33, s82, v238
    v_mfma_f32_32x32x16_bf16 v[64:79], a[80:83], v[228:231], v[64:79]
    s_waitcnt lgkmcnt(4)
    ds_read_b64_tr_b16 a[64:65], v12 offset:24576
    ds_read_b64_tr_b16 a[66:67], v12 offset:25088
    s_waitcnt vmcnt(22)
    v_cmp_gt_u32 vcc, 1, v25
    s_nop 1
    s_cbranch_vccnz L_slow_gatef_1
L_ret_gatef_1:
    v_mfma_f32_32x32x16_bf16 v[80:95], a[84:87], v[228:231], v[80:95]
    s_waitcnt lgkmcnt(4)
    s_add_u32 m0, s53, 0
    ds_read_b64_tr_b16 a[68:69], v12 offset:26624
    ds_read_b64_tr_b16 a[70:71], v12 offset:27136
    buffer_load_dwordx4 v18, s[8:11], s61 offen lds
    v_lshlrev_b32 v34, 16, v239
    v_and_b32 v35, s82, v239
    v_fma_f32 v28, v28, v26, v27
    v_fma_f32 v29, v29, v26, v27
    v_fma_f32 v30, v30, v26, v27
    v_fma_f32 v31, v31, v26, v27
    v_fma_f32 v32, v32, v26, v27
    v_mfma_f32_32x32x16_bf16 v[96:111], a[88:91], v[228:231], v[96:111]
    s_waitcnt lgkmcnt(4)
    ds_read_b64_tr_b16 a[72:73], v13 offset:24576
    ds_read_b64_tr_b16 a[74:75], v13 offset:25088
    v_fma_f32 v33, v33, v26, v27
    v_fma_f32 v34, v34, v26, v27
    v_fma_f32 v35, v35, v26, v27
    v_cvt_pk_bf16_f32 v236, v28, v29
    v_cvt_pk_bf16_f32 v237, v30, v31
    v_cvt_pk_bf16_f32 v238, v32, v33
    v_mfma_f32_32x32x16_bf16 v[112:127], a[92:95], v[228:231], v[112:127]
    s_waitcnt lgkmcnt(4)
    ds_read_b64_tr_b16 a[76:77], v13 offset:26624
    ds_read_b64_tr_b16 a[78:79], v13 offset:27136
    buffer_load_dwordx4 v19, s[8:11], s61 offen offset:1024 lds
    v_cvt_pk_bf16_f32 v239, v34, v35
    v_lshlrev_b32 v28, 16, v240
    v_and_b32 v29, s82, v240
    v_lshlrev_b32_e64 v30, 16, v241
    v_mfma_f32_32x32x16_bf16 v[64:79], a[64:67], v[232:235], v[64:79]
    s_waitcnt lgkmcnt(4)
    ds_read_b64_tr_b16 a[80:81], v14 offset:24576
    ds_read_b64_tr_b16 a[82:83], v14 offset:25088
    s_waitcnt vmcnt(8)
    v_lshl_or_b32 v42, v50, 16, v42
    v_lshl_or_b32 v43, v51, 16, v43
    v_lshl_or_b32 v44, v52, 16, v44
    v_lshl_or_b32 v45, v53, 16, v45
    v_lshl_or_b32 v46, v54, 16, v46
    v_lshl_or_b32 v47, v55, 16, v47
    v_mfma_f32_32x32x16_bf16 v[80:95], a[68:71], v[232:235], v[80:95]
    s_waitcnt lgkmcnt(4)
    ds_read_b64_tr_b16 a[84:85], v14 offset:26624
    ds_read_b64_tr_b16 a[86:87], v14 offset:27136
    buffer_load_dwordx4 v18, s[12:15], s61 offen offset:2048 lds
    v_lshl_or_b32 v48, v56, 16, v48
    v_lshl_or_b32 v49, v57, 16, v49
    v_mfma_f32_32x32x16_bf16 v[96:111], a[72:75], v[232:235], v[96:111]
    s_waitcnt lgkmcnt(4)
    ds_read_b64_tr_b16 a[88:89], v15 offset:24576
    ds_read_b64_tr_b16 a[90:91], v15 offset:25088
    buffer_store_dwordx4 v[42:45], v41, s[28:31], s74 offen sc1
    buffer_store_dwordx4 v[46:49], v41, s[28:31], s74 offen offset:64 sc1
    v_mfma_f32_32x32x16_bf16 v[112:127], a[76:79], v[232:235], v[112:127]
    s_waitcnt lgkmcnt(4)
    ds_read_b64_tr_b16 a[92:93], v15 offset:26624
    ds_read_b64_tr_b16 a[94:95], v15 offset:27136
    buffer_load_dwordx4 v19, s[12:15], s61 offen offset:3072 lds
    v_and_b32 v31, s82, v241
    v_lshlrev_b32_e64 v32, 16, v242
    v_and_b32 v33, s82, v242
    v_mfma_f32_32x32x16_bf16 v[64:79], a[80:83], v[236:239], v[64:79]
    s_waitcnt lgkmcnt(4)
    ds_read_b64_tr_b16 a[64:65], v8 offset:28672
    ds_read_b64_tr_b16 a[66:67], v8 offset:29184
    v_lshlrev_b32 v34, 16, v243
    v_and_b32 v35, s82, v243
    v_fma_f32 v28, v28, v26, v27
    v_fma_f32 v29, v29, v26, v27
    v_fma_f32 v30, v30, v26, v27
    v_fma_f32 v31, v31, v26, v27
    v_mfma_f32_32x32x16_bf16 v[80:95], a[84:87], v[236:239], v[80:95]
    s_waitcnt lgkmcnt(4)
    s_add_u32 m0, s53, 16384
    s_lshl_b32 s55, s84, 16
    ds_read_b64_tr_b16 a[68:69], v8 offset:30720
    ds_read_b64_tr_b16 a[70:71], v8 offset:31232
    buffer_load_dwordx4 v20, s[16:19], s55 offen lds
    v_fma_f32 v32, v32, v26, v27
    v_fma_f32 v33, v33, v26, v27
    v_mfma_f32_32x32x16_bf16 v[96:111], a[88:91], v[236:239], v[96:111]
    s_waitcnt lgkmcnt(4)
    ds_read_b64_tr_b16 a[72:73], v9 offset:28672
    ds_read_b64_tr_b16 a[74:75], v9 offset:29184
    v_fma_f32 v34, v34, v26, v27
    v_fma_f32 v35, v35, v26, v27
    v_cvt_pk_bf16_f32 v240, v28, v29
    v_cvt_pk_bf16_f32 v241, v30, v31
    v_cvt_pk_bf16_f32 v242, v32, v33
    v_cvt_pk_bf16_f32 v243, v34, v35
    v_mfma_f32_32x32x16_bf16 v[112:127], a[92:95], v[236:239], v[112:127]
    s_waitcnt lgkmcnt(4)
    ds_read_b64_tr_b16 a[76:77], v9 offset:30720
    ds_read_b64_tr_b16 a[78:79], v9 offset:31232
    buffer_load_dwordx4 v21, s[16:19], s55 offen offset:1024 lds
    v_lshlrev_b32 v28, 16, v244
    v_and_b32 v29, s82, v244
    v_lshlrev_b32 v30, 16, v245
    v_and_b32 v31, s82, v245
    v_mfma_f32_32x32x16_bf16 v[64:79], a[64:67], v[240:243], v[64:79]
    s_waitcnt lgkmcnt(4)
    s_barrier
    ds_read_b64_tr_b16 a[80:81], v10 offset:28672
    ds_read_b64_tr_b16 a[82:83], v10 offset:29184
    v_lshlrev_b32 v32, 16, v246
    v_and_b32 v33, s82, v246
    v_lshlrev_b32 v34, 16, v247
    v_mfma_f32_32x32x16_bf16 v[80:95], a[68:71], v[240:243], v[80:95]
    s_waitcnt lgkmcnt(4)
    ds_read_b64_tr_b16 a[84:85], v10 offset:30720
    ds_read_b64_tr_b16 a[86:87], v10 offset:31232
    buffer_load_dwordx4 v22, s[16:19], s55 offen offset:2048 lds
    v_and_b32_e64 v35, s82, v247
    v_fma_f32 v28, v28, v26, v27
    v_fma_f32 v29, v29, v26, v27
    v_mfma_f32_32x32x16_bf16 v[96:111], a[72:75], v[240:243], v[96:111]
    s_waitcnt lgkmcnt(4)
    ds_read_b64_tr_b16 a[88:89], v11 offset:28672
    ds_read_b64_tr_b16 a[90:91], v11 offset:29184
    v_fma_f32 v30, v30, v26, v27
    v_fma_f32 v31, v31, v26, v27
    v_fma_f32 v32, v32, v26, v27
    v_fma_f32 v33, v33, v26, v27
    v_fma_f32 v34, v34, v26, v27
    v_fma_f32 v35, v35, v26, v27
    v_mfma_f32_32x32x16_bf16 v[112:127], a[76:79], v[240:243], v[112:127]
    s_waitcnt lgkmcnt(4)
    ds_read_b64_tr_b16 a[92:93], v11 offset:30720
    ds_read_b64_tr_b16 a[94:95], v11 offset:31232
    buffer_load_dwordx4 v23, s[16:19], s55 offen offset:3072 lds
    v_cvt_pk_bf16_f32 v244, v28, v29
    v_cvt_pk_bf16_f32 v245, v30, v31
    v_cvt_pk_bf16_f32 v246, v32, v33
    v_cvt_pk_bf16_f32 v247, v34, v35
    s_nop 1
    v_mfma_f32_32x32x16_bf16 v[64:79], a[80:83], v[244:247], v[64:79]
    s_waitcnt lgkmcnt(4)
    ds_read_b64_tr_b16 a[64:65], v12 offset:28672
    ds_read_b64_tr_b16 a[66:67], v12 offset:29184
    v_lshlrev_b32 v28, 16, v248
    v_and_b32 v29, s82, v248
    v_lshlrev_b32 v30, 16, v249
    v_and_b32 v31, s82, v249
    v_lshlrev_b32 v32, 16, v250
    v_and_b32 v33, s82, v250
    v_lshlrev_b32 v34, 16, v251
    v_mfma_f32_32x32x16_bf16 v[80:95], a[84:87], v[244:247], v[80:95]
    s_waitcnt lgkmcnt(4)
    s_add_u32 m0, s53, 4096
    ds_read_b64_tr_b16 a[68:69], v12 offset:30720
    ds_read_b64_tr_b16 a[70:71], v12 offset:31232
    buffer_load_dwordx4 v18, s[8:11], s62 offen lds
    v_and_b32_e64 v35, s82, v251
    v_fma_f32 v28, v28, v26, v27
    v_fma_f32 v29, v29, v26, v27
    v_mfma_f32_32x32x16_bf16 v[96:111], a[88:91], v[244:247], v[96:111]
    s_waitcnt lgkmcnt(4)
    ds_read_b64_tr_b16 a[72:73], v13 offset:28672
    ds_read_b64_tr_b16 a[74:75], v13 offset:29184
    v_fma_f32 v30, v30, v26, v27
    v_fma_f32 v31, v31, v26, v27
    v_fma_f32 v32, v32, v26, v27
    v_fma_f32 v33, v33, v26, v27
    v_fma_f32 v34, v34, v26, v27
    v_fma_f32 v35, v35, v26, v27
    v_mfma_f32_32x32x16_bf16 v[112:127], a[92:95], v[244:247], v[112:127]
    s_waitcnt lgkmcnt(4)
    ds_read_b64_tr_b16 a[76:77], v13 offset:30720
    ds_read_b64_tr_b16 a[78:79], v13 offset:31232
    buffer_load_dwordx4 v19, s[8:11], s62 offen offset:1024 lds
    v_cvt_pk_bf16_f32 v248, v28, v29
    v_cvt_pk_bf16_f32 v249, v30, v31
    v_cvt_pk_bf16_f32 v250, v32, v33
    v_cvt_pk_bf16_f32 v251, v34, v35
    s_nop 1
    v_mfma_f32_32x32x16_bf16 v[64:79], a[64:67], v[248:251], v[64:79]
    s_waitcnt lgkmcnt(4)
    ds_read_b64_tr_b16 a[80:81], v14 offset:28672
    ds_read_b64_tr_b16 a[82:83], v14 offset:29184
    v_lshlrev_b32 v28, 16, v252
    v_and_b32 v29, s82, v252
    v_lshlrev_b32 v30, 16, v253
    v_and_b32 v31, s82, v253
    v_lshlrev_b32_e64 v32, 16, v254
    v_and_b32 v33, s82, v254
    v_mfma_f32_32x32x16_bf16 v[80:95], a[68:71], v[248:251], v[80:95]
    s_waitcnt lgkmcnt(4)
    ds_read_b64_tr_b16 a[84:85], v14 offset:30720
    ds_read_b64_tr_b16 a[86:87], v14 offset:31232
    buffer_load_dwordx4 v18, s[12:15], s62 offen offset:2048 lds
    v_lshlrev_b32 v34, 16, v255
    v_and_b32 v35, s82, v255
    v_fma_f32 v28, v28, v26, v27
    v_fma_f32 v29, v29, v26, v27
    v_mfma_f32_32x32x16_bf16 v[96:111], a[72:75], v[248:251], v[96:111]
    s_waitcnt lgkmcnt(4)
    ds_read_b64_tr_b16 a[88:89], v15 offset:28672
    ds_read_b64_tr_b16 a[90:91], v15 offset:29184
    v_fma_f32 v30, v30, v26, v27
    v_fma_f32 v31, v31, v26, v27
    v_fma_f32 v32, v32, v26, v27
    v_fma_f32 v33, v33, v26, v27
    v_fma_f32 v34, v34, v26, v27
    v_fma_f32 v35, v35, v26, v27
    v_mfma_f32_32x32x16_bf16 v[112:127], a[76:79], v[248:251], v[112:127]
    s_waitcnt lgkmcnt(4)
    ds_read_b64_tr_b16 a[92:93], v15 offset:30720
    ds_read_b64_tr_b16 a[94:95], v15 offset:31232
    buffer_load_dwordx4 v19, s[12:15], s62 offen offset:3072 lds
    v_cvt_pk_bf16_f32 v252, v28, v29
    v_cvt_pk_bf16_f32 v253, v30, v31
    v_cvt_pk_bf16_f32 v254, v32, v33
    v_cvt_pk_bf16_f32 v255, v34, v35
    s_nop 1
    v_mfma_f32_32x32x16_bf16 v[64:79], a[80:83], v[252:255], v[64:79]
    s_waitcnt lgkmcnt(4)
    ds_read_b64_tr_b16 a[64:65], v8 offset:32768
    ds_read_b64_tr_b16 a[66:67], v8 offset:33280
    s_mov_b32 s20, 0xbdd2d3e8
    v_mfma_f32_32x32x16_bf16 v[80:95], a[84:87], v[252:255], v[80:95]
    s_waitcnt lgkmcnt(4)
    s_add_u32 m0, s53, 20480
    s_lshl_b32 s55, s84, 16
    s_add_u32 s55, s55, 32768
    ds_read_b64_tr_b16 a[68:69], v8 offset:34816
    ds_read_b64_tr_b16 a[70:71], v8 offset:35328
    buffer_load_dwordx4 v20, s[16:19], s55 offen lds
    v_mfma_f32_32x32x16_bf16 v[96:111], a[88:91], v[252:255], v[96:111]
    s_waitcnt lgkmcnt(4)
    ds_read_b64_tr_b16 a[72:73], v9 offset:32768
    ds_read_b64_tr_b16 a[74:75], v9 offset:33280
    s_mov_b32 s21, 0xbdd2d3e8
    v_mfma_f32_32x32x16_bf16 v[112:127], a[92:95], v[252:255], v[112:127]
    s_waitcnt lgkmcnt(4)
    ds_read_b64_tr_b16 a[76:77], v9 offset:34816
    ds_read_b64_tr_b16 a[78:79], v9 offset:35328
    buffer_load_dwordx4 v21, s[16:19], s55 offen offset:1024 lds
    v_pk_mul_f32 v[28:29], v[64:65], v[64:65]
    v_pk_mul_f32 v[30:31], v[66:67], v[66:67]
    v_pk_mul_f32 v[32:33], v[68:69], v[68:69]
    v_pk_mul_f32 v[34:35], v[70:71], v[70:71]
    v_pk_fma_f32 v[28:29], v[28:29], s[20:21], v[6:7] op_sel_hi:[1,1,0]
    v_pk_fma_f32 v[30:31], v[30:31], s[20:21], v[6:7] op_sel_hi:[1,1,0]
    v_pk_fma_f32 v[32:33], v[32:33], s[20:21], v[6:7] op_sel_hi:[1,1,0]
    v_pk_fma_f32 v[34:35], v[34:35], s[20:21], v[6:7] op_sel_hi:[1,1,0]
    v_pk_mul_f32 v[28:29], v[28:29], v[64:65]
    v_pk_mul_f32 v[30:31], v[30:31], v[66:67]
    v_pk_mul_f32 v[32:33], v[32:33], v[68:69]
    v_pk_mul_f32 v[34:35], v[34:35], v[70:71]
    v_exp_f32_e64 v28, v28
    v_pk_mul_f32 v[80:81], v[80:81], v[64:65]
    v_exp_f32_e64 v29, v29
    v_pk_mul_f32 v[82:83], v[82:83], v[66:67]
    v_exp_f32_e64 v30, v30
    v_pk_mul_f32 v[84:85], v[84:85], v[68:69]
    v_exp_f32_e64 v31, v31
    v_pk_mul_f32 v[86:87], v[86:87], v[70:71]
    v_exp_f32_e64 v32, v32
    v_pk_mul_f32 v[36:37], v[72:73], v[72:73]
    v_exp_f32_e64 v33, v33
    v_pk_mul_f32 v[38:39], v[74:75], v[74:75]
    v_exp_f32_e64 v34, v34
    v_pk_mul_f32 v[40:41], v[76:77], v[76:77]
    v_exp_f32_e64 v35, v35
    v_pk_mul_f32 v[42:43], v[78:79], v[78:79]
    v_pk_add_f32 v[28:29], v[28:29], 1.0 op_sel_hi:[1,0]
    v_pk_add_f32 v[30:31], v[30:31], 1.0 op_sel_hi:[1,0]
    v_pk_add_f32 v[32:33], v[32:33], 1.0 op_sel_hi:[1,0]
    v_pk_add_f32 v[34:35], v[34:35], 1.0 op_sel_hi:[1,0]
    v_rcp_f32_e64 v28, v28
    v_pk_fma_f32 v[36:37], v[36:37], s[20:21], v[6:7] op_sel_hi:[1,1,0]
    v_rcp_f32_e64 v29, v29
    v_pk_fma_f32 v[38:39], v[38:39], s[20:21], v[6:7] op_sel_hi:[1,1,0]
    v_rcp_f32_e64 v30, v30
    v_pk_fma_f32 v[40:41], v[40:41], s[20:21], v[6:7] op_sel_hi:[1,1,0]
    v_rcp_f32_e64 v31, v31
    v_pk_fma_f32 v[42:43], v[42:43], s[20:21], v[6:7] op_sel_hi:[1,1,0]
    v_rcp_f32_e64 v32, v32
    v_pk_mul_f32 v[36:37], v[36:37], v[72:73]
    v_rcp_f32_e64 v33, v33
    v_pk_mul_f32 v[38:39], v[38:39], v[74:75]
    v_rcp_f32_e64 v34, v34
    v_pk_mul_f32 v[40:41], v[40:41], v[76:77]
    v_rcp_f32_e64 v35, v35
    v_pk_mul_f32 v[42:43], v[42:43], v[78:79]
    v_pk_mul_f32 v[80:81], v[80:81], v[28:29]
    v_pk_mul_f32 v[82:83], v[82:83], v[30:31]
    v_pk_mul_f32 v[84:85], v[84:85], v[32:33]
    v_pk_mul_f32 v[86:87], v[86:87], v[34:35]
    v_cvt_pk_bf16_f32 v48, v80, v81
    v_cvt_pk_bf16_f32 v49, v82, v83
    v_cvt_pk_bf16_f32 v50, v84, v85
    v_cvt_pk_bf16_f32 v51, v86, v87
    buffer_store_dwordx4 v[48:51], v2, s[28:31], s69 offen sc1
    v_exp_f32_e64 v36, v36
    v_pk_mul_f32 v[88:89], v[88:89], v[72:73]
    v_exp_f32_e64 v37, v37
    v_pk_mul_f32 v[90:91], v[90:91], v[74:75]
    v_exp_f32_e64 v38, v38
    v_pk_mul_f32 v[92:93], v[92:93], v[76:77]
    v_exp_f32_e64 v39, v39
    v_pk_mul_f32 v[94:95], v[94:95], v[78:79]
    v_exp_f32_e64 v40, v40
    v_pk_mul_f32 v[28:29], v[96:97], v[96:97]
    v_exp_f32_e64 v41, v41
    v_pk_mul_f32 v[30:31], v[98:99], v[98:99]
    v_exp_f32_e64 v42, v42
    v_pk_mul_f32 v[32:33], v[100:101], v[100:101]
    v_exp_f32_e64 v43, v43
    v_pk_mul_f32 v[34:35], v[102:103], v[102:103]
    v_pk_add_f32 v[36:37], v[36:37], 1.0 op_sel_hi:[1,0]
    v_pk_add_f32 v[38:39], v[38:39], 1.0 op_sel_hi:[1,0]
    v_pk_add_f32 v[40:41], v[40:41], 1.0 op_sel_hi:[1,0]
    v_pk_add_f32 v[42:43], v[42:43], 1.0 op_sel_hi:[1,0]
    v_rcp_f32_e64 v36, v36
    v_pk_fma_f32 v[28:29], v[28:29], s[20:21], v[6:7] op_sel_hi:[1,1,0]
    v_rcp_f32_e64 v37, v37
    v_pk_fma_f32 v[30:31], v[30:31], s[20:21], v[6:7] op_sel_hi:[1,1,0]
    v_rcp_f32_e64 v38, v38
    v_pk_fma_f32 v[32:33], v[32:33], s[20:21], v[6:7] op_sel_hi:[1,1,0]
    v_rcp_f32_e64 v39, v39
    v_pk_fma_f32 v[34:35], v[34:35], s[20:21], v[6:7] op_sel_hi:[1,1,0]
    v_rcp_f32_e64 v40, v40
    v_pk_mul_f32 v[28:29], v[28:29], v[96:97]
    v_rcp_f32_e64 v41, v41
    v_pk_mul_f32 v[30:31], v[30:31], v[98:99]
    v_rcp_f32_e64 v42, v42
    v_pk_mul_f32 v[32:33], v[32:33], v[100:101]
    v_rcp_f32_e64 v43, v43
    v_pk_mul_f32 v[34:35], v[34:35], v[102:103]
    v_pk_mul_f32 v[88:89], v[88:89], v[36:37]
    v_pk_mul_f32 v[90:91], v[90:91], v[38:39]
    v_pk_mul_f32 v[92:93], v[92:93], v[40:41]
    v_pk_mul_f32 v[94:95], v[94:95], v[42:43]
    v_cvt_pk_bf16_f32 v52, v88, v89
    v_cvt_pk_bf16_f32 v53, v90, v91
    v_cvt_pk_bf16_f32 v54, v92, v93
    v_cvt_pk_bf16_f32 v55, v94, v95
    buffer_store_dwordx4 v[52:55], v2, s[28:31], s69 offen offset:1024 sc1
    v_exp_f32_e64 v28, v28
    v_pk_mul_f32 v[112:113], v[112:113], v[96:97]
    v_exp_f32_e64 v29, v29
    v_pk_mul_f32 v[114:115], v[114:115], v[98:99]
    v_exp_f32_e64 v30, v30
    v_pk_mul_f32 v[116:117], v[116:117], v[100:101]
    v_exp_f32_e64 v31, v31
    v_pk_mul_f32 v[118:119], v[118:119], v[102:103]
    v_exp_f32_e64 v32, v32
    v_pk_mul_f32 v[36:37], v[104:105], v[104:105]
    v_exp_f32_e64 v33, v33
    v_pk_mul_f32 v[38:39], v[106:107], v[106:107]
    v_exp_f32_e64 v34, v34
    v_pk_mul_f32 v[40:41], v[108:109], v[108:109]
    v_exp_f32_e64 v35, v35
    v_pk_mul_f32 v[42:43], v[110:111], v[110:111]
    v_pk_add_f32 v[28:29], v[28:29], 1.0 op_sel_hi:[1,0]
    v_pk_add_f32 v[30:31], v[30:31], 1.0 op_sel_hi:[1,0]
    v_pk_add_f32 v[32:33], v[32:33], 1.0 op_sel_hi:[1,0]
    v_pk_add_f32 v[34:35], v[34:35], 1.0 op_sel_hi:[1,0]
    v_rcp_f32_e64 v28, v28
    v_pk_fma_f32 v[36:37], v[36:37], s[20:21], v[6:7] op_sel_hi:[1,1,0]
    v_rcp_f32_e64 v29, v29
    v_pk_fma_f32 v[38:39], v[38:39], s[20:21], v[6:7] op_sel_hi:[1,1,0]
    v_rcp_f32_e64 v30, v30
    v_pk_fma_f32 v[40:41], v[40:41], s[20:21], v[6:7] op_sel_hi:[1,1,0]
    v_rcp_f32_e64 v31, v31
    v_pk_fma_f32 v[42:43], v[42:43], s[20:21], v[6:7] op_sel_hi:[1,1,0]
    v_rcp_f32_e64 v32, v32
    v_pk_mul_f32 v[36:37], v[36:37], v[104:105]
    v_rcp_f32_e64 v33, v33
    v_pk_mul_f32 v[38:39], v[38:39], v[106:107]
    v_rcp_f32_e64 v34, v34
    v_pk_mul_f32 v[40:41], v[40:41], v[108:109]
    v_rcp_f32_e64 v35, v35
    v_pk_mul_f32 v[42:43], v[42:43], v[110:111]
    v_pk_mul_f32 v[112:113], v[112:113], v[28:29]
    v_pk_mul_f32 v[114:115], v[114:115], v[30:31]
    v_pk_mul_f32 v[116:117], v[116:117], v[32:33]
    v_pk_mul_f32 v[118:119], v[118:119], v[34:35]
    v_cvt_pk_bf16_f32 v56, v112, v113
    v_cvt_pk_bf16_f32 v57, v114, v115
    v_cvt_pk_bf16_f32 v58, v116, v117
    v_cvt_pk_bf16_f32 v59, v118, v119
    buffer_store_dwordx4 v[56:59], v2, s[28:31], s69 offen offset:2048 sc1
    v_exp_f32 v36, v36
    v_exp_f32 v37, v37
    v_pk_mul_f32 v[120:121], v[120:121], v[104:105]
    v_exp_f32 v38, v38
    v_exp_f32 v39, v39
    v_pk_mul_f32 v[122:123], v[122:123], v[106:107]
    v_exp_f32 v40, v40
    v_exp_f32 v41, v41
    v_pk_mul_f32 v[124:125], v[124:125], v[108:109]
    v_exp_f32 v42, v42
    v_exp_f32 v43, v43
    v_pk_mul_f32 v[126:127], v[126:127], v[110:111]
    v_pk_add_f32 v[36:37], v[36:37], 1.0 op_sel_hi:[1,0]
    v_pk_add_f32 v[38:39], v[38:39], 1.0 op_sel_hi:[1,0]
    v_pk_add_f32 v[40:41], v[40:41], 1.0 op_sel_hi:[1,0]
    v_pk_add_f32 v[42:43], v[42:43], 1.0 op_sel_hi:[1,0]
    v_rcp_f32 v36, v36
    v_rcp_f32 v37, v37
    v_rcp_f32 v38, v38
    v_rcp_f32 v39, v39
    v_rcp_f32 v40, v40
    v_rcp_f32 v41, v41
    v_rcp_f32 v42, v42
    v_rcp_f32 v43, v43
    v_pk_mul_f32 v[120:121], v[120:121], v[36:37]
    v_pk_mul_f32 v[122:123], v[122:123], v[38:39]
    v_pk_mul_f32 v[124:125], v[124:125], v[40:41]
    v_pk_mul_f32 v[126:127], v[126:127], v[42:43]
    v_cvt_pk_bf16_f32 v60, v120, v121
    v_cvt_pk_bf16_f32 v61, v122, v123
    v_cvt_pk_bf16_f32 v62, v124, v125
    v_cvt_pk_bf16_f32 v63, v126, v127
    buffer_store_dwordx4 v[60:63], v2, s[28:31], s69 offen offset:3072 sc1
    v_mfma_f32_32x32x16_bf16 v[64:79], a[64:67], v[128:131], 0
    s_waitcnt lgkmcnt(4)
    s_waitcnt vmcnt(14)
    s_barrier
    ds_read_b64_tr_b16 a[80:81], v10 offset:32768
    ds_read_b64_tr_b16 a[82:83], v10 offset:33280
    v_mfma_f32_32x32x16_bf16 v[80:95], a[68:71], v[128:131], 0
    s_waitcnt lgkmcnt(4)
    ds_read_b64_tr_b16 a[84:85], v10 offset:34816
    ds_read_b64_tr_b16 a[86:87], v10 offset:35328
    buffer_load_dwordx4 v22, s[16:19], s55 offen offset:2048 lds
    v_accvgpr_read_b32 v28, a187
    v_mfma_f32_32x32x16_bf16 v[96:111], a[72:75], v[128:131], 0
    s_waitcnt lgkmcnt(4)
    ds_read_b64_tr_b16 a[88:89], v11 offset:32768
    ds_read_b64_tr_b16 a[90:91], v11 offset:33280
    v_accvgpr_read_b32 v30, a189
    v_accvgpr_read_b32 v32, a191
    v_accvgpr_read_b32 v29, a188
    v_accvgpr_read_b32 v31, a190
    v_mfma_f32_32x32x16_bf16 v[112:127], a[76:79], v[128:131], 0
    s_waitcnt lgkmcnt(4)
    ds_read_b64_tr_b16 a[92:93], v11 offset:34816
    ds_read_b64_tr_b16 a[94:95], v11 offset:35328
    buffer_load_dwordx4 v23, s[16:19], s55 offen offset:3072 lds
    v_accvgpr_read_b32 v33, a192
    v_mfma_f32_32x32x16_bf16 v[64:79], a[80:83], v[132:135], v[64:79]
    s_waitcnt lgkmcnt(4)
    ds_read_b64_tr_b16 a[64:65], v12 offset:32768
    ds_read_b64_tr_b16 a[66:67], v12 offset:33280
    s_add_u32 s26, s80, 0
    s_and_b32 s26, s26, 3
    s_cselect_b64 s[24:25], 0, -1
    s_lshl_b32 s26, s26, 4
    v_mfma_f32_32x32x16_bf16 v[80:95], a[84:87], v[132:135], v[80:95]
    s_waitcnt lgkmcnt(4)
    s_add_u32 m0, s53, 8192
    ds_read_b64_tr_b16 a[68:69], v12 offset:34816
    ds_read_b64_tr_b16 a[70:71], v12 offset:35328
    buffer_load_dwordx4 v18, s[8:11], s63 offen lds
    v_mfma_f32_32x32x16_bf16 v[96:111], a[88:91], v[132:135], v[96:111]
    s_waitcnt lgkmcnt(4)
    ds_read_b64_tr_b16 a[72:73], v13 offset:32768
    ds_read_b64_tr_b16 a[74:75], v13 offset:33280
    v_cvt_f32_u32 v35, s26
    v_fma_f32 v34, v35, v28, v30
    v_fma_f32 v35, v35, v29, v31
    v_cndmask_b32 v44, v34, v32, s[24:25]
    v_mfma_f32_32x32x16_bf16 v[112:127], a[92:95], v[132:135], v[112:127]
    s_waitcnt lgkmcnt(4)
    ds_read_b64_tr_b16 a[76:77], v13 offset:34816
    ds_read_b64_tr_b16 a[78:79], v13 offset:35328
    buffer_load_dwordx4 v19, s[8:11], s63 offen offset:1024 lds
    v_fmamk_f32 v45, v28, 0x3f800000, v34
    v_mfma_f32_32x32x16_bf16 v[64:79], a[64:67], v[136:139], v[64:79]
    s_waitcnt lgkmcnt(4)
    ds_read_b64_tr_b16 a[80:81], v14 offset:32768
    ds_read_b64_tr_b16 a[82:83], v14 offset:33280
    v_fmamk_f32 v46, v28, 0x40000000, v34
    v_fmamk_f32 v47, v28, 0x40400000, v34
    v_cos_f32 v48, v44
    v_mfma_f32_32x32x16_bf16 v[80:95], a[68:71], v[136:139], v[80:95]
    s_waitcnt lgkmcnt(4)
    ds_read_b64_tr_b16 a[84:85], v14 offset:34816
    ds_read_b64_tr_b16 a[86:87], v14 offset:35328
    buffer_load_dwordx4 v18, s[12:15], s63 offen offset:2048 lds
    v_mfma_f32_32x32x16_bf16 v[96:111], a[72:75], v[136:139], v[96:111]
    s_waitcnt lgkmcnt(4)
    ds_read_b64_tr_b16 a[88:89], v15 offset:32768
    ds_read_b64_tr_b16 a[90:91], v15 offset:33280
    v_cos_f32 v49, v45
    v_cos_f32_e64 v50, v46
    v_mfma_f32_32x32x16_bf16 v[112:127], a[76:79], v[136:139], v[112:127]
    s_waitcnt lgkmcnt(4)
    ds_read_b64_tr_b16 a[92:93], v15 offset:34816
    ds_read_b64_tr_b16 a[94:95], v15 offset:35328
    buffer_load_dwordx4 v19, s[12:15], s63 offen offset:3072 lds
    v_mfma_f32_32x32x16_bf16 v[64:79], a[80:83], v[140:143], v[64:79]
    s_waitcnt lgkmcnt(4)
    ds_read_b64_tr_b16 a[64:65], v8
    ds_read_b64_tr_b16 a[66:67], v8 offset:512
    v_cos_f32 v51, v47
    v_sin_f32_e64 v44, -v44
    v_mfma_f32_32x32x16_bf16 v[80:95], a[84:87], v[140:143], v[80:95]
    s_waitcnt lgkmcnt(4)
    s_add_u32 m0, s53, 24576
    s_lshl_b32 s55, s85, 16
    ds_read_b64_tr_b16 a[68:69], v8 offset:2048
    ds_read_b64_tr_b16 a[70:71], v8 offset:2560
    buffer_load_dwordx4 v20, s[16:19], s55 offen lds
    v_mfma_f32_32x32x16_bf16 v[96:111], a[88:91], v[140:143], v[96:111]
    s_waitcnt lgkmcnt(4)
    ds_read_b64_tr_b16 a[72:73], v9
    ds_read_b64_tr_b16 a[74:75], v9 offset:512
    v_sin_f32_e64 v45, -v45
    v_sin_f32_e64 v46, -v46
    v_mfma_f32_32x32x16_bf16 v[112:127], a[92:95], v[140:143], v[112:127]
    s_waitcnt lgkmcnt(4)
    ds_read_b64_tr_b16 a[76:77], v9 offset:2048
    ds_read_b64_tr_b16 a[78:79], v9 offset:2560
    buffer_load_dwordx4 v21, s[16:19], s55 offen offset:1024 lds
    v_mfma_f32_32x32x16_bf16 v[64:79], a[64:67], v[144:147], v[64:79]
    s_waitcnt lgkmcnt(4)
    s_waitcnt vmcnt(14)
    s_barrier
    ds_read_b64_tr_b16 a[80:81], v10
    ds_read_b64_tr_b16 a[82:83], v10 offset:512
    v_mfma_f32_32x32x16_bf16 v[80:95], a[68:71], v[144:147], v[80:95]
    s_waitcnt lgkmcnt(4)
    ds_read_b64_tr_b16 a[84:85], v10 offset:2048
    ds_read_b64_tr_b16 a[86:87], v10 offset:2560
    buffer_load_dwordx4 v22, s[16:19], s55 offen offset:2048 lds
    v_sin_f32_e64 v47, -v47
    v_mfma_f32_32x32x16_bf16 v[96:111], a[72:75], v[144:147], v[96:111]
    s_waitcnt lgkmcnt(4)
    ds_read_b64_tr_b16 a[88:89], v11
    ds_read_b64_tr_b16 a[90:91], v11 offset:512
    v_cvt_pk_bf16_f32 v128, v48, v49
    v_cvt_pk_bf16_f32 v129, v50, v51
    v_cvt_pk_bf16_f32 v130, v44, v45
    v_cvt_pk_bf16_f32 v131, v46, v47
    v_mfma_f32_32x32x16_bf16 v[112:127], a[76:79], v[144:147], v[112:127]
    s_waitcnt lgkmcnt(4)
    ds_read_b64_tr_b16 a[92:93], v11 offset:2048
    ds_read_b64_tr_b16 a[94:95], v11 offset:2560
    buffer_load_dwordx4 v23, s[16:19], s55 offen offset:3072 lds
    v_cndmask_b32 v52, v35, v33, s[24:25]
    v_mfma_f32_32x32x16_bf16 v[64:79], a[80:83], v[148:151], v[64:79]
    s_waitcnt lgkmcnt(4)
    ds_read_b64_tr_b16 a[64:65], v12
    ds_read_b64_tr_b16 a[66:67], v12 offset:512
    v_fmamk_f32 v53, v29, 0x3f800000, v35
    v_fmamk_f32 v54, v29, 0x40000000, v35
    v_fmamk_f32 v55, v29, 0x40400000, v35
    v_mfma_f32_32x32x16_bf16 v[80:95], a[84:87], v[148:151], v[80:95]
    s_waitcnt lgkmcnt(4)
    ds_read_b64_tr_b16 a[68:69], v12 offset:2048
    ds_read_b64_tr_b16 a[70:71], v12 offset:2560
    buffer_atomic_add v5, v3, s[28:31], s75 offen sc1
    v_cos_f32 v56, v52
    v_mfma_f32_32x32x16_bf16 v[96:111], a[88:91], v[148:151], v[96:111]
    s_waitcnt lgkmcnt(4)
    ds_read_b64_tr_b16 a[72:73], v13
    ds_read_b64_tr_b16 a[74:75], v13 offset:512
    v_cos_f32 v57, v53
    v_cos_f32_e64 v58, v54
    v_mfma_f32_32x32x16_bf16 v[112:127], a[92:95], v[148:151], v[112:127]
    s_waitcnt lgkmcnt(4)
    ds_read_b64_tr_b16 a[76:77], v13 offset:2048
    ds_read_b64_tr_b16 a[78:79], v13 offset:2560
    s_waitcnt vmcnt(11)
    buffer_atomic_add v5, v4, s[28:31], s48 offen sc1
    v_cos_f32 v59, v55
    v_mfma_f32_32x32x16_bf16 v[64:79], a[64:67], v[152:155], v[64:79]
    s_waitcnt lgkmcnt(4)
    ds_read_b64_tr_b16 a[80:81], v14
    ds_read_b64_tr_b16 a[82:83], v14 offset:512
    v_sin_f32_e64 v52, -v52
    v_sin_f32_e64 v53, -v53
    v_mfma_f32_32x32x16_bf16 v[80:95], a[68:71], v[152:155], v[80:95]
    s_waitcnt lgkmcnt(4)
    s_add_u32 m0, s53, 12288
    ds_read_b64_tr_b16 a[84:85], v14 offset:2048
    ds_read_b64_tr_b16 a[86:87], v14 offset:2560
    buffer_load_dwordx4 v18, s[8:11], s64 offen lds
    v_mfma_f32_32x32x16_bf16 v[96:111], a[72:75], v[152:155], v[96:111]
    s_waitcnt lgkmcnt(4)
    ds_read_b64_tr_b16 a[88:89], v15
    ds_read_b64_tr_b16 a[90:91], v15 offset:512
    v_sin_f32_e64 v54, -v54
    v_sin_f32_e64 v55, -v55
    v_mfma_f32_32x32x16_bf16 v[112:127], a[76:79], v[152:155], v[112:127]
    s_waitcnt lgkmcnt(4)
    ds_read_b64_tr_b16 a[92:93], v15 offset:2048
    ds_read_b64_tr_b16 a[94:95], v15 offset:2560
    buffer_load_dwordx4 v19, s[8:11], s64 offen offset:1024 lds
    v_mfma_f32_32x32x16_bf16 v[64:79], a[80:83], v[156:159], v[64:79]
    s_waitcnt lgkmcnt(4)
    ds_read_b64_tr_b16 a[64:65], v8 offset:4096
    ds_read_b64_tr_b16 a[66:67], v8 offset:4608
    v_cvt_pk_bf16_f32 v132, v56, v57
    v_cvt_pk_bf16_f32 v133, v58, v59
    v_cvt_pk_bf16_f32 v134, v52, v53
    v_mfma_f32_32x32x16_bf16 v[80:95], a[84:87], v[156:159], v[80:95]
    s_waitcnt lgkmcnt(4)
    ds_read_b64_tr_b16 a[68:69], v8 offset:6144
    ds_read_b64_tr_b16 a[70:71], v8 offset:6656
    buffer_load_dwordx4 v18, s[12:15], s64 offen offset:2048 lds
    v_cvt_pk_bf16_f32 v135, v54, v55
    v_mfma_f32_32x32x16_bf16 v[96:111], a[88:91], v[156:159], v[96:111]
    s_waitcnt lgkmcnt(4)
    ds_read_b64_tr_b16 a[72:73], v9 offset:4096
    ds_read_b64_tr_b16 a[74:75], v9 offset:4608
    v_fmamk_f32 v44, v28, 0x41000000, v34
    v_fmamk_f32 v45, v28, 0x41100000, v34
    v_fmamk_f32 v46, v28, 0x41200000, v34
    v_mfma_f32_32x32x16_bf16 v[112:127], a[92:95], v[156:159], v[112:127]
    s_waitcnt lgkmcnt(4)
    ds_read_b64_tr_b16 a[76:77], v9 offset:6144
    ds_read_b64_tr_b16 a[78:79], v9 offset:6656
    buffer_load_dwordx4 v19, s[12:15], s64 offen offset:3072 lds
    v_fmamk_f32 v47, v28, 0x41300000, v34
    v_mfma_f32_32x32x16_bf16 v[64:79], a[64:67], v[160:163], v[64:79]
    s_waitcnt lgkmcnt(4)
    s_waitcnt vmcnt(10)
    s_barrier
    ds_read_b64_tr_b16 a[80:81], v10 offset:4096
    ds_read_b64_tr_b16 a[82:83], v10 offset:4608
    v_mfma_f32_32x32x16_bf16 v[80:95], a[68:71], v[160:163], v[80:95]
    s_waitcnt lgkmcnt(4)
    s_add_u32 m0, s53, 28672
    ds_read_b64_tr_b16 a[84:85], v10 offset:6144
    ds_read_b64_tr_b16 a[86:87], v10 offset:6656
    buffer_load_dwordx4 v18, s[8:11], s65 offen lds
    v_mfma_f32_32x32x16_bf16 v[96:111], a[72:75], v[160:163], v[96:111]
    s_waitcnt lgkmcnt(4)
    ds_read_b64_tr_b16 a[88:89], v11 offset:4096
    ds_read_b64_tr_b16 a[90:91], v11 offset:4608
    v_cos_f32_e64 v48, v44
    v_cos_f32 v49, v45
    v_mfma_f32_32x32x16_bf16 v[112:127], a[76:79], v[160:163], v[112:127]
    s_waitcnt lgkmcnt(4)
    ds_read_b64_tr_b16 a[92:93], v11 offset:6144
    ds_read_b64_tr_b16 a[94:95], v11 offset:6656
    buffer_load_dwordx4 v19, s[8:11], s65 offen offset:1024 lds
    v_cos_f32 v50, v46
    v_mfma_f32_32x32x16_bf16 v[64:79], a[80:83], v[164:167], v[64:79]
    s_waitcnt lgkmcnt(4)
    ds_read_b64_tr_b16 a[64:65], v12 offset:4096
    ds_read_b64_tr_b16 a[66:67], v12 offset:4608
    v_cos_f32_e64 v51, v47
    v_sin_f32_e64 v44, -v44
    v_mfma_f32_32x32x16_bf16 v[80:95], a[84:87], v[164:167], v[80:95]
    s_waitcnt lgkmcnt(4)
    ds_read_b64_tr_b16 a[68:69], v12 offset:6144
    ds_read_b64_tr_b16 a[70:71], v12 offset:6656
    buffer_load_dwordx4 v18, s[12:15], s65 offen offset:2048 lds
    v_sin_f32_e64 v45, -v45
    v_mfma_f32_32x32x16_bf16 v[96:111], a[88:91], v[164:167], v[96:111]
    s_waitcnt lgkmcnt(4)
    ds_read_b64_tr_b16 a[72:73], v13 offset:4096
    ds_read_b64_tr_b16 a[74:75], v13 offset:4608
    v_sin_f32_e64 v46, -v46
    v_mfma_f32_32x32x16_bf16 v[112:127], a[92:95], v[164:167], v[112:127]
    s_waitcnt lgkmcnt(4)
    ds_read_b64_tr_b16 a[76:77], v13 offset:6144
    ds_read_b64_tr_b16 a[78:79], v13 offset:6656
    buffer_load_dwordx4 v19, s[12:15], s65 offen offset:3072 lds
    v_sin_f32_e64 v47, -v47
    v_mfma_f32_32x32x16_bf16 v[64:79], a[64:67], v[168:171], v[64:79]
    s_waitcnt lgkmcnt(4)
    ds_read_b64_tr_b16 a[80:81], v14 offset:4096
    ds_read_b64_tr_b16 a[82:83], v14 offset:4608
    v_cvt_pk_bf16_f32 v136, v48, v49
    v_cvt_pk_bf16_f32 v137, v50, v51
    v_cvt_pk_bf16_f32 v138, v44, v45
    v_cvt_pk_bf16_f32 v139, v46, v47
    v_mfma_f32_32x32x16_bf16 v[80:95], a[68:71], v[168:171], v[80:95]
    s_waitcnt lgkmcnt(4)
    s_add_u32 m0, s53, 32768
    ds_read_b64_tr_b16 a[84:85], v14 offset:6144
    ds_read_b64_tr_b16 a[86:87], v14 offset:6656
    buffer_load_dwordx4 v18, s[8:11], s66 offen lds
    v_mfma_f32_32x32x16_bf16 v[96:111], a[72:75], v[168:171], v[96:111]
    s_waitcnt lgkmcnt(4)
    ds_read_b64_tr_b16 a[88:89], v15 offset:4096
    ds_read_b64_tr_b16 a[90:91], v15 offset:4608
    v_fmamk_f32 v52, v29, 0x41000000, v35
    v_fmamk_f32 v53, v29, 0x41100000, v35
    v_fmamk_f32 v54, v29, 0x41200000, v35
    v_mfma_f32_32x32x16_bf16 v[112:127], a[76:79], v[168:171], v[112:127]
    s_waitcnt lgkmcnt(4)
    ds_read_b64_tr_b16 a[92:93], v15 offset:6144
    ds_read_b64_tr_b16 a[94:95], v15 offset:6656
    buffer_load_dwordx4 v19, s[8:11], s66 offen offset:1024 lds
    v_fmamk_f32 v55, v29, 0x41300000, v35
    v_mfma_f32_32x32x16_bf16 v[64:79], a[80:83], v[172:175], v[64:79]
    s_waitcnt lgkmcnt(4)
    ds_read_b64_tr_b16 a[64:65], v8 offset:8192
    ds_read_b64_tr_b16 a[66:67], v8 offset:8704
    v_cos_f32_e64 v56, v52
    v_cos_f32 v57, v53
    v_mfma_f32_32x32x16_bf16 v[80:95], a[84:87], v[172:175], v[80:95]
    s_waitcnt lgkmcnt(4)
    ds_read_b64_tr_b16 a[68:69], v8 offset:10240
    ds_read_b64_tr_b16 a[70:71], v8 offset:10752
    buffer_load_dwordx4 v18, s[12:15], s66 offen offset:2048 lds
    v_mfma_f32_32x32x16_bf16 v[96:111], a[88:91], v[172:175], v[96:111]
    s_waitcnt lgkmcnt(4)
    ds_read_b64_tr_b16 a[72:73], v9 offset:8192
    ds_read_b64_tr_b16 a[74:75], v9 offset:8704
    v_cos_f32 v58, v54
    v_cos_f32 v59, v55
    v_mfma_f32_32x32x16_bf16 v[112:127], a[92:95], v[172:175], v[112:127]
    s_waitcnt lgkmcnt(4)
    ds_read_b64_tr_b16 a[76:77], v9 offset:10240
    ds_read_b64_tr_b16 a[78:79], v9 offset:10752
    buffer_load_dwordx4 v19, s[12:15], s66 offen offset:3072 lds
    v_mfma_f32_32x32x16_bf16 v[64:79], a[64:67], v[176:179], v[64:79]
    s_waitcnt lgkmcnt(4)
    s_waitcnt vmcnt(8)
    s_barrier
    ds_read_b64_tr_b16 a[80:81], v10 offset:8192
    ds_read_b64_tr_b16 a[82:83], v10 offset:8704
    v_mfma_f32_32x32x16_bf16 v[80:95], a[68:71], v[176:179], v[80:95]
    s_waitcnt lgkmcnt(4)
    s_add_u32 m0, s53, 0
    ds_read_b64_tr_b16 a[84:85], v10 offset:10240
    ds_read_b64_tr_b16 a[86:87], v10 offset:10752
    buffer_load_dwordx4 v18, s[8:11], s67 offen lds
    v_mfma_f32_32x32x16_bf16 v[96:111], a[72:75], v[176:179], v[96:111]
    s_waitcnt lgkmcnt(4)
    ds_read_b64_tr_b16 a[88:89], v11 offset:8192
    ds_read_b64_tr_b16 a[90:91], v11 offset:8704
    v_sin_f32_e64 v52, -v52
    v_sin_f32_e64 v53, -v53
    v_mfma_f32_32x32x16_bf16 v[112:127], a[76:79], v[176:179], v[112:127]
    s_waitcnt lgkmcnt(4)
    ds_read_b64_tr_b16 a[92:93], v11 offset:10240
    ds_read_b64_tr_b16 a[94:95], v11 offset:10752
    buffer_load_dwordx4 v19, s[8:11], s67 offen offset:1024 lds
    v_sin_f32_e64 v54, -v54
    v_mfma_f32_32x32x16_bf16 v[64:79], a[80:83], v[180:183], v[64:79]
    s_waitcnt lgkmcnt(4)
    ds_read_b64_tr_b16 a[64:65], v12 offset:8192
    ds_read_b64_tr_b16 a[66:67], v12 offset:8704
    v_sin_f32_e64 v55, -v55
    v_cvt_pk_bf16_f32 v140, v56, v57
    v_cvt_pk_bf16_f32 v141, v58, v59
    v_mfma_f32_32x32x16_bf16 v[80:95], a[84:87], v[180:183], v[80:95]
    s_waitcnt lgkmcnt(4)
    ds_read_b64_tr_b16 a[68:69], v12 offset:10240
    ds_read_b64_tr_b16 a[70:71], v12 offset:10752
    buffer_load_dwordx4 v18, s[12:15], s67 offen offset:2048 lds
    v_cvt_pk_bf16_f32 v142, v52, v53
    v_mfma_f32_32x32x16_bf16 v[96:111], a[88:91], v[180:183], v[96:111]
    s_waitcnt lgkmcnt(4)
    ds_read_b64_tr_b16 a[72:73], v13 offset:8192
    ds_read_b64_tr_b16 a[74:75], v13 offset:8704
    v_cvt_pk_bf16_f32 v143, v54, v55
    v_mfma_f32_32x32x16_bf16 v[112:127], a[92:95], v[180:183], v[112:127]
    s_waitcnt lgkmcnt(4)
    ds_read_b64_tr_b16 a[76:77], v13 offset:10240
    ds_read_b64_tr_b16 a[78:79], v13 offset:10752
    buffer_load_dwordx4 v19, s[12:15], s67 offen offset:3072 lds
    s_add_u32 s26, s80, 1
    s_and_b32 s26, s26, 3
    s_cselect_b64 s[24:25], 0, -1
    s_lshl_b32 s26, s26, 4
    v_mfma_f32_32x32x16_bf16 v[64:79], a[64:67], v[184:187], v[64:79]
    s_waitcnt lgkmcnt(4)
    ds_read_b64_tr_b16 a[80:81], v14 offset:8192
    ds_read_b64_tr_b16 a[82:83], v14 offset:8704
    v_cvt_f32_u32 v35, s26
    v_fma_f32 v34, v35, v28, v30
    v_fma_f32 v35, v35, v29, v31
    v_mfma_f32_32x32x16_bf16 v[80:95], a[68:71], v[184:187], v[80:95]
    s_waitcnt lgkmcnt(4)
    s_add_u32 m0, s53, 4096
    s_lshl_b32 s55, s85, 16
    s_add_u32 s55, s55, 32768
    ds_read_b64_tr_b16 a[84:85], v14 offset:10240
    ds_read_b64_tr_b16 a[86:87], v14 offset:10752
    buffer_load_dwordx4 v20, s[16:19], s55 offen lds
    v_mfma_f32_32x32x16_bf16 v[96:111], a[72:75], v[184:187], v[96:111]
    s_waitcnt lgkmcnt(4)
    ds_read_b64_tr_b16 a[88:89], v15 offset:8192
    ds_read_b64_tr_b16 a[90:91], v15 offset:8704
    v_cndmask_b32 v44, v34, v32, s[24:25]
    v_fmamk_f32 v45, v28, 0x3f800000, v34
    v_fmamk_f32 v46, v28, 0x40000000, v34
    v_fmamk_f32 v47, v28, 0x40400000, v34
    v_mfma_f32_32x32x16_bf16 v[112:127], a[76:79], v[184:187], v[112:127]
    s_waitcnt lgkmcnt(4)
    ds_read_b64_tr_b16 a[92:93], v15 offset:10240
    ds_read_b64_tr_b16 a[94:95], v15 offset:10752
    buffer_load_dwordx4 v21, s[16:19], s55 offen offset:1024 lds
    v_mfma_f32_32x32x16_bf16 v[64:79], a[80:83], v[188:191], v[64:79]
    s_waitcnt lgkmcnt(4)
    ds_read_b64_tr_b16 a[64:65], v8 offset:12288
    ds_read_b64_tr_b16 a[66:67], v8 offset:12800
    v_min_u32_e64 v24, 1, v1
    v_lshlrev_b32 v24, 8, v24
    v_accvgpr_read_b32 v16, a185
    v_accvgpr_read_b32 v17, a186
    v_mfma_f32_32x32x16_bf16 v[80:95], a[84:87], v[188:191], v[80:95]
    s_waitcnt lgkmcnt(4)
    ds_read_b64_tr_b16 a[68:69], v8 offset:14336
    ds_read_b64_tr_b16 a[70:71], v8 offset:14848
    buffer_load_dwordx4 v22, s[16:19], s55 offen offset:2048 lds
    v_cos_f32 v48, v44
    v_mfma_f32_32x32x16_bf16 v[96:111], a[88:91], v[188:191], v[96:111]
    s_waitcnt lgkmcnt(4)
    ds_read_b64_tr_b16 a[72:73], v9 offset:12288
    ds_read_b64_tr_b16 a[74:75], v9 offset:12800
    v_cos_f32 v49, v45
    v_mfma_f32_32x32x16_bf16 v[112:127], a[92:95], v[188:191], v[112:127]
    s_waitcnt lgkmcnt(4)
    ds_read_b64_tr_b16 a[76:77], v9 offset:14336
    ds_read_b64_tr_b16 a[78:79], v9 offset:14848
    buffer_load_dwordx4 v23, s[16:19], s55 offen offset:3072 lds
    v_cos_f32_e64 v50, v46
    v_mfma_f32_32x32x16_bf16 v[64:79], a[64:67], v[192:195], v[64:79]
    s_waitcnt lgkmcnt(4)
    s_waitcnt vmcnt(12)
    s_barrier
    ds_read_b64_tr_b16 a[80:81], v10 offset:12288
    ds_read_b64_tr_b16 a[82:83], v10 offset:12800
    v_mfma_f32_32x32x16_bf16 v[80:95], a[68:71], v[192:195], v[80:95]
    s_waitcnt lgkmcnt(4)
    ds_read_b64_tr_b16 a[84:85], v10 offset:14336
    ds_read_b64_tr_b16 a[86:87], v10 offset:14848
    v_cos_f32 v51, v47
    v_sin_f32_e64 v44, -v44
    v_mfma_f32_32x32x16_bf16 v[96:111], a[72:75], v[192:195], v[96:111]
    s_waitcnt lgkmcnt(4)
    ds_read_b64_tr_b16 a[88:89], v11 offset:12288
    ds_read_b64_tr_b16 a[90:91], v11 offset:12800
    v_sin_f32_e64 v45, -v45
    v_mfma_f32_32x32x16_bf16 v[112:127], a[76:79], v[192:195], v[112:127]
    s_waitcnt lgkmcnt(4)
    ds_read_b64_tr_b16 a[92:93], v11 offset:14336
    ds_read_b64_tr_b16 a[94:95], v11 offset:14848
    v_sin_f32_e64 v46, -v46
    v_sin_f32_e64 v47, -v47
    v_mfma_f32_32x32x16_bf16 v[64:79], a[80:83], v[196:199], v[64:79]
    s_waitcnt lgkmcnt(4)
    ds_read_b64_tr_b16 a[64:65], v12 offset:12288
    ds_read_b64_tr_b16 a[66:67], v12 offset:12800
    v_cvt_pk_bf16_f32 v144, v48, v49
    v_cvt_pk_bf16_f32 v145, v50, v51
    v_cvt_pk_bf16_f32 v146, v44, v45
    v_cvt_pk_bf16_f32 v147, v46, v47
    v_mfma_f32_32x32x16_bf16 v[80:95], a[84:87], v[196:199], v[80:95]
    s_waitcnt lgkmcnt(4)
    ds_read_b64_tr_b16 a[68:69], v12 offset:14336
    ds_read_b64_tr_b16 a[70:71], v12 offset:14848
    buffer_load_dword v25, v24, s[28:31], s51 offen sc1
    v_mfma_f32_32x32x16_bf16 v[96:111], a[88:91], v[196:199], v[96:111]
    s_waitcnt lgkmcnt(4)
    ds_read_b64_tr_b16 a[72:73], v13 offset:12288
    ds_read_b64_tr_b16 a[74:75], v13 offset:12800
    v_cndmask_b32 v52, v35, v33, s[24:25]
    v_fmamk_f32 v53, v29, 0x3f800000, v35
    v_fmamk_f32 v54, v29, 0x40000000, v35
    v_fmamk_f32 v55, v29, 0x40400000, v35
    v_mfma_f32_32x32x16_bf16 v[112:127], a[92:95], v[196:199], v[112:127]
    s_waitcnt lgkmcnt(4)
    s_add_u32 m0, s53, 8192
    s_lshl_b32 s55, s86, 16
    ds_read_b64_tr_b16 a[76:77], v13 offset:14336
    ds_read_b64_tr_b16 a[78:79], v13 offset:14848
    buffer_load_dwordx4 v20, s[16:19], s55 offen lds
    v_mfma_f32_32x32x16_bf16 v[64:79], a[64:67], v[200:203], v[64:79]
    s_waitcnt lgkmcnt(4)
    ds_read_b64_tr_b16 a[80:81], v14 offset:12288
    ds_read_b64_tr_b16 a[82:83], v14 offset:12800
    v_cos_f32 v56, v52
    v_cos_f32 v57, v53
    v_mfma_f32_32x32x16_bf16 v[80:95], a[68:71], v[200:203], v[80:95]
    s_waitcnt lgkmcnt(4)
    ds_read_b64_tr_b16 a[84:85], v14 offset:14336
    ds_read_b64_tr_b16 a[86:87], v14 offset:14848
    buffer_load_dwordx4 v21, s[16:19], s55 offen offset:1024 lds
    v_cos_f32 v58, v54
    v_mfma_f32_32x32x16_bf16 v[96:111], a[72:75], v[200:203], v[96:111]
    s_waitcnt lgkmcnt(4)
    ds_read_b64_tr_b16 a[88:89], v15 offset:12288
    ds_read_b64_tr_b16 a[90:91], v15 offset:12800
    v_cos_f32 v59, v55
    v_mfma_f32_32x32x16_bf16 v[112:127], a[76:79], v[200:203], v[112:127]
    s_waitcnt lgkmcnt(4)
    ds_read_b64_tr_b16 a[92:93], v15 offset:14336
    ds_read_b64_tr_b16 a[94:95], v15 offset:14848
    buffer_load_dwordx4 v22, s[16:19], s55 offen offset:2048 lds
    v_sin_f32_e64 v52, -v52
    v_mfma_f32_32x32x16_bf16 v[64:79], a[80:83], v[204:207], v[64:79]
    s_waitcnt lgkmcnt(4)
    ds_read_b64_tr_b16 a[64:65], v8 offset:28672
    ds_read_b64_tr_b16 a[66:67], v8 offset:29184
    v_sin_f32_e64 v53, -v53
    v_sin_f32_e64 v54, -v54
    v_mfma_f32_32x32x16_bf16 v[80:95], a[84:87], v[204:207], v[80:95]
    s_waitcnt lgkmcnt(4)
    ds_read_b64_tr_b16 a[68:69], v8 offset:30720
    ds_read_b64_tr_b16 a[70:71], v8 offset:31232
    v_sin_f32_e64 v55, -v55
    v_mfma_f32_32x32x16_bf16 v[96:111], a[88:91], v[204:207], v[96:111]
    s_waitcnt lgkmcnt(4)
    ds_read_b64_tr_b16 a[72:73], v9 offset:28672
    ds_read_b64_tr_b16 a[74:75], v9 offset:29184
    buffer_load_dwordx4 v23, s[16:19], s55 offen offset:3072 lds
    v_cvt_pk_bf16_f32 v148, v56, v57
    v_mfma_f32_32x32x16_bf16 v[112:127], a[92:95], v[204:207], v[112:127]
    s_waitcnt lgkmcnt(4)
    ds_read_b64_tr_b16 a[76:77], v9 offset:30720
    ds_read_b64_tr_b16 a[78:79], v9 offset:31232
    v_cvt_pk_bf16_f32 v149, v58, v59
    v_cvt_pk_bf16_f32 v150, v52, v53
    v_cvt_pk_bf16_f32 v151, v54, v55
    v_mfma_f32_32x32x16_bf16 v[64:79], a[64:67], v[208:211], v[64:79]
    s_waitcnt lgkmcnt(4)
    s_waitcnt vmcnt(13)
    s_barrier
    ds_read_b64_tr_b16 a[80:81], v10 offset:28672
    ds_read_b64_tr_b16 a[82:83], v10 offset:29184
    v_mfma_f32_32x32x16_bf16 v[80:95], a[68:71], v[208:211], v[80:95]
    s_waitcnt lgkmcnt(4)
    ds_read_b64_tr_b16 a[84:85], v10 offset:30720
    ds_read_b64_tr_b16 a[86:87], v10 offset:31232
    v_fmamk_f32 v44, v28, 0x41000000, v34
    v_fmamk_f32 v45, v28, 0x41100000, v34
    v_fmamk_f32 v46, v28, 0x41200000, v34
    v_mfma_f32_32x32x16_bf16 v[96:111], a[72:75], v[208:211], v[96:111]
    s_waitcnt lgkmcnt(4)
    ds_read_b64_tr_b16 a[88:89], v11 offset:28672
    ds_read_b64_tr_b16 a[90:91], v11 offset:29184
    v_fmamk_f32 v47, v28, 0x41300000, v34
    v_cos_f32 v48, v44
    v_mfma_f32_32x32x16_bf16 v[112:127], a[76:79], v[208:211], v[112:127]
    s_waitcnt lgkmcnt(4)
    ds_read_b64_tr_b16 a[92:93], v11 offset:30720
    ds_read_b64_tr_b16 a[94:95], v11 offset:31232
    v_cos_f32 v49, v45
    v_cos_f32 v50, v46
    v_mfma_f32_32x32x16_bf16 v[64:79], a[80:83], v[212:215], v[64:79]
    s_waitcnt lgkmcnt(4)
    ds_read_b64_tr_b16 a[64:65], v12 offset:28672
    ds_read_b64_tr_b16 a[66:67], v12 offset:29184
    s_waitcnt vmcnt(4)
    v_cmp_gt_u32 vcc, 12, v25
    v_accvgpr_read_b32 v24, a194
    s_nop 0
    s_cmp_eq_u64 vcc, 0
    s_cselect_b32 s49, s91, 0x7f000000
    s_cselect_b32 s50, 1, 0
    v_mfma_f32_32x32x16_bf16 v[80:95], a[84:87], v[212:215], v[80:95]
    s_waitcnt lgkmcnt(4)
    s_add_u32 m0, s53, 12288
    s_lshl_b32 s55, s86, 16
    s_add_u32 s55, s55, 32768
    ds_read_b64_tr_b16 a[68:69], v12 offset:30720
    ds_read_b64_tr_b16 a[70:71], v12 offset:31232
    buffer_load_dwordx4 v20, s[16:19], s55 offen lds
    v_mfma_f32_32x32x16_bf16 v[96:111], a[88:91], v[212:215], v[96:111]
    s_waitcnt lgkmcnt(4)
    ds_read_b64_tr_b16 a[72:73], v13 offset:28672
    ds_read_b64_tr_b16 a[74:75], v13 offset:29184
    v_accvgpr_read_b32 v192, a176
    v_accvgpr_read_b32 v193, a177
    v_accvgpr_read_b32 v194, a178
    v_accvgpr_read_b32 v195, a179
    v_cos_f32_e64 v51, v47
    v_mfma_f32_32x32x16_bf16 v[112:127], a[92:95], v[212:215], v[112:127]
    s_waitcnt lgkmcnt(4)
    ds_read_b64_tr_b16 a[76:77], v13 offset:30720
    ds_read_b64_tr_b16 a[78:79], v13 offset:31232
    buffer_load_dwordx4 v21, s[16:19], s55 offen offset:1024 lds
    v_sin_f32_e64 v44, -v44
    v_mfma_f32_32x32x16_bf16 v[64:79], a[64:67], v[216:219], v[64:79]
    s_waitcnt lgkmcnt(4)
    ds_read_b64_tr_b16 a[80:81], v14 offset:28672
    ds_read_b64_tr_b16 a[82:83], v14 offset:29184
    v_accvgpr_read_b32 v203, a180
    v_accvgpr_read_b32 v26, a181
    v_add_u32 v199, 81920, v195
    v_add_u32 v207, 81920, v194
    v_xor_b32 v196, 128, v195
    v_mfma_f32_32x32x16_bf16 v[80:95], a[68:71], v[216:219], v[80:95]
    s_waitcnt lgkmcnt(4)
    ds_read_b64_tr_b16 a[84:85], v14 offset:30720
    ds_read_b64_tr_b16 a[86:87], v14 offset:31232
    buffer_load_dwordx4 v22, s[16:19], s55 offen offset:2048 lds
    v_sin_f32_e64 v45, -v45
    v_mfma_f32_32x32x16_bf16 v[96:111], a[72:75], v[216:219], v[96:111]
    s_waitcnt lgkmcnt(4)
    ds_read_b64_tr_b16 a[88:89], v15 offset:28672
    ds_read_b64_tr_b16 a[90:91], v15 offset:29184
    buffer_load_dwordx4 v23, s[16:19], s55 offen offset:3072 lds
    v_sin_f32_e64 v46, -v46
    v_sin_f32_e64 v47, -v47
    v_mfma_f32_32x32x16_bf16 v[112:127], a[76:79], v[216:219], v[112:127]
    s_waitcnt lgkmcnt(4)
    s_lshl_b32 s57, s84, 12
    s_add_u32 s57, s57, s49
    ds_read_b64_tr_b16 a[92:93], v15 offset:30720
    ds_read_b64_tr_b16 a[94:95], v15 offset:31232
    buffer_load_dwordx4 a[0:3], v16, s[28:31], s57 offen sc1
    v_mfma_f32_32x32x16_bf16 v[64:79], a[80:83], v[220:223], v[64:79]
    s_waitcnt lgkmcnt(4)
    ds_read_b64_tr_b16 a[64:65], v8 offset:32768
    ds_read_b64_tr_b16 a[66:67], v8 offset:33280
    v_xor_b32_e64 v197, 32, v195
    v_xor_b32 v198, 160, v195
    v_xor_b32 v200, 128, v199
    v_xor_b32 v201, 32, v199
    v_cvt_pk_bf16_f32 v152, v48, v49
    v_mfma_f32_32x32x16_bf16 v[80:95], a[84:87], v[220:223], v[80:95]
    s_waitcnt lgkmcnt(4)
    ds_read_b64_tr_b16 a[68:69], v8 offset:34816
    ds_read_b64_tr_b16 a[70:71], v8 offset:35328
    buffer_load_dword v25, v24, s[28:31], 0 offen sc1
    v_cvt_pk_bf16_f32 v153, v50, v51
    v_cvt_pk_bf16_f32 v154, v44, v45
    v_mfma_f32_32x32x16_bf16 v[96:111], a[88:91], v[220:223], v[96:111]
    s_waitcnt lgkmcnt(4)
    ds_read_b64_tr_b16 a[72:73], v9 offset:32768
    ds_read_b64_tr_b16 a[74:75], v9 offset:33280
    buffer_load_dwordx4 a[4:7], v17, s[28:31], s57 offen sc1
    v_cvt_pk_bf16_f32 v155, v46, v47
    v_fmamk_f32 v52, v29, 0x41000000, v35
    v_mfma_f32_32x32x16_bf16 v[112:127], a[92:95], v[220:223], v[112:127]
    s_waitcnt lgkmcnt(4)
    ds_read_b64_tr_b16 a[76:77], v9 offset:34816
    ds_read_b64_tr_b16 a[78:79], v9 offset:35328
    buffer_load_dwordx4 a[8:11], v16, s[28:31], s57 offen offset:1024 sc1
    v_fmamk_f32 v53, v29, 0x41100000, v35
    v_fmamk_f32 v54, v29, 0x41200000, v35
    v_mfma_f32_32x32x16_bf16 v[64:79], a[64:67], v[224:227], v[64:79]
    s_waitcnt lgkmcnt(4)
    s_barrier
    ds_read_b64_tr_b16 a[80:81], v10 offset:32768
    ds_read_b64_tr_b16 a[82:83], v10 offset:33280
    v_xor_b32 v202, 160, v199
    v_add_u32 v204, 81920, v203
    v_mfma_f32_32x32x16_bf16 v[80:95], a[68:71], v[224:227], v[80:95]
    s_waitcnt lgkmcnt(4)
    ds_read_b64_tr_b16 a[84:85], v10 offset:34816
    ds_read_b64_tr_b16 a[86:87], v10 offset:35328
    buffer_load_dwordx4 a[12:15], v17, s[28:31], s57 offen offset:1024 sc1
    v_add_u32 v205, 38912, v2
    v_add_u32 v206, 120832, v2
    v_mfma_f32_32x32x16_bf16 v[96:111], a[72:75], v[224:227], v[96:111]
    s_waitcnt lgkmcnt(4)
    ds_read_b64_tr_b16 a[88:89], v11 offset:32768
    ds_read_b64_tr_b16 a[90:91], v11 offset:33280
    buffer_load_dwordx4 a[16:19], v16, s[28:31], s57 offen offset:2048 sc1
    v_fmamk_f32 v55, v29, 0x41300000, v35
    v_cos_f32 v56, v52
    v_mfma_f32_32x32x16_bf16 v[112:127], a[76:79], v[224:227], v[112:127]
    s_waitcnt lgkmcnt(4)
    ds_read_b64_tr_b16 a[92:93], v11 offset:34816
    ds_read_b64_tr_b16 a[94:95], v11 offset:35328
    buffer_load_dwordx4 a[20:23], v17, s[28:31], s57 offen offset:2048 sc1
    v_cos_f32 v57, v53
    v_mfma_f32_32x32x16_bf16 v[64:79], a[80:83], v[228:231], v[64:79]
    s_waitcnt lgkmcnt(4)
    ds_read_b64_tr_b16 a[64:65], v12 offset:32768
    ds_read_b64_tr_b16 a[66:67], v12 offset:33280
    v_cos_f32 v58, v54
    v_cos_f32 v59, v55
    v_mfma_f32_32x32x16_bf16 v[80:95], a[84:87], v[228:231], v[80:95]
    s_waitcnt lgkmcnt(4)
    s_add_u32 m0, s53, 28672
    s_lshl_b32 s55, s87, 16
    ds_read_b64_tr_b16 a[68:69], v12 offset:34816
    ds_read_b64_tr_b16 a[70:71], v12 offset:35328
    buffer_load_dwordx4 v20, s[16:19], s55 offen lds
    v_mfma_f32_32x32x16_bf16 v[96:111], a[88:91], v[228:231], v[96:111]
    s_waitcnt lgkmcnt(4)
    ds_read_b64_tr_b16 a[72:73], v13 offset:32768
    ds_read_b64_tr_b16 a[74:75], v13 offset:33280
    buffer_load_dwordx4 v21, s[16:19], s55 offen offset:1024 lds
    v_mfma_f32_32x32x16_bf16 v[112:127], a[92:95], v[228:231], v[112:127]
    s_waitcnt lgkmcnt(4)
    ds_read_b64_tr_b16 a[76:77], v13 offset:34816
    ds_read_b64_tr_b16 a[78:79], v13 offset:35328
    buffer_load_dwordx4 a[24:27], v16, s[28:31], s57 offen offset:3072 sc1
    v_mfma_f32_32x32x16_bf16 v[64:79], a[64:67], v[232:235], v[64:79]
    s_waitcnt lgkmcnt(4)
    ds_read_b64_tr_b16 a[80:81], v14 offset:32768
    ds_read_b64_tr_b16 a[82:83], v14 offset:33280
    v_sin_f32_e64 v52, -v52
    v_sin_f32_e64 v53, -v53
    v_mfma_f32_32x32x16_bf16 v[80:95], a[68:71], v[232:235], v[80:95]
    s_waitcnt lgkmcnt(4)
    ds_read_b64_tr_b16 a[84:85], v14 offset:34816
    ds_read_b64_tr_b16 a[86:87], v14 offset:35328
    buffer_load_dwordx4 v22, s[16:19], s55 offen offset:2048 lds
    v_sin_f32_e64 v54, -v54
    v_mfma_f32_32x32x16_bf16 v[96:111], a[72:75], v[232:235], v[96:111]
    s_waitcnt lgkmcnt(4)
    ds_read_b64_tr_b16 a[88:89], v15 offset:32768
    ds_read_b64_tr_b16 a[90:91], v15 offset:33280
    buffer_load_dwordx4 v23, s[16:19], s55 offen offset:3072 lds
    v_mfma_f32_32x32x16_bf16 v[112:127], a[76:79], v[232:235], v[112:127]
    s_waitcnt lgkmcnt(4)
    ds_read_b64_tr_b16 a[92:93], v15 offset:34816
    ds_read_b64_tr_b16 a[94:95], v15 offset:35328
    buffer_load_dwordx4 a[28:31], v17, s[28:31], s57 offen offset:3072 sc1
    v_sin_f32_e64 v55, -v55
    v_mfma_f32_32x32x16_bf16 v[64:79], a[80:83], v[236:239], v[64:79]
    s_waitcnt lgkmcnt(4)
    ds_read_b64_tr_b16 a[64:65], v8
    ds_read_b64_tr_b16 a[66:67], v8 offset:512
    s_waitcnt vmcnt(11)
    v_cmp_gt_u32 vcc, 16, v25
    s_nop 1
    s_cbranch_vccnz L_slow_awf_2
L_ret_awf_2:
    v_mfma_f32_32x32x16_bf16 v[80:95], a[84:87], v[236:239], v[80:95]
    s_waitcnt lgkmcnt(4)
    s_lshl_b32 s57, s85, 12
    s_add_u32 s57, s57, s49
    ds_read_b64_tr_b16 a[68:69], v8 offset:2048
    ds_read_b64_tr_b16 a[70:71], v8 offset:2560
    buffer_load_dwordx4 a[32:35], v16, s[28:31], s57 offen sc1
    v_cvt_pk_bf16_f32 v156, v56, v57
    v_cvt_pk_bf16_f32 v157, v58, v59
    v_mfma_f32_32x32x16_bf16 v[96:111], a[88:91], v[236:239], v[96:111]
    s_waitcnt lgkmcnt(4)
    ds_read_b64_tr_b16 a[72:73], v9
    ds_read_b64_tr_b16 a[74:75], v9 offset:512
    buffer_load_dwordx4 a[36:39], v17, s[28:31], s57 offen sc1
    v_cvt_pk_bf16_f32 v158, v52, v53
    v_mfma_f32_32x32x16_bf16 v[112:127], a[92:95], v[236:239], v[112:127]
    s_waitcnt lgkmcnt(4)
    ds_read_b64_tr_b16 a[76:77], v9 offset:2048
    ds_read_b64_tr_b16 a[78:79], v9 offset:2560
    buffer_load_dwordx4 a[40:43], v16, s[28:31], s57 offen offset:1024 sc1
    v_cvt_pk_bf16_f32 v159, v54, v55
    v_mfma_f32_32x32x16_bf16 v[64:79], a[64:67], v[240:243], v[64:79]
    s_waitcnt lgkmcnt(4)
    s_barrier
    ds_read_b64_tr_b16 a[80:81], v10
    ds_read_b64_tr_b16 a[82:83], v10 offset:512
    v_accvgpr_read_b32 v208, a144
    v_accvgpr_read_b32 v209, a145
    v_mfma_f32_32x32x16_bf16 v[80:95], a[68:71], v[240:243], v[80:95]
    s_waitcnt lgkmcnt(4)
    s_add_u32 s56, s92, 9437184
    s_add_u32 m0, s53, 36864
    ds_read_b64_tr_b16 a[84:85], v10 offset:2048
    ds_read_b64_tr_b16 a[86:87], v10 offset:2560
    buffer_load_dwordx4 v192, s[28:31], s56 offen sc1 lds
    v_accvgpr_read_b32 v210, a146
    v_mfma_f32_32x32x16_bf16 v[96:111], a[72:75], v[240:243], v[96:111]
    s_waitcnt lgkmcnt(4)
    ds_read_b64_tr_b16 a[88:89], v11
    ds_read_b64_tr_b16 a[90:91], v11 offset:512
    buffer_load_dwordx4 a[44:47], v17, s[28:31], s57 offen offset:1024 sc1
    v_accvgpr_read_b32 v211, a147
    v_accvgpr_read_b32 v212, a148
    v_mfma_f32_32x32x16_bf16 v[112:127], a[76:79], v[240:243], v[112:127]
    s_waitcnt lgkmcnt(4)
    ds_read_b64_tr_b16 a[92:93], v11 offset:2048
    ds_read_b64_tr_b16 a[94:95], v11 offset:2560
    buffer_load_dwordx4 a[48:51], v16, s[28:31], s57 offen offset:2048 sc1
    v_accvgpr_read_b32 v213, a149
    v_accvgpr_read_b32 v214, a150
    v_accvgpr_read_b32 v215, a151
    v_mfma_f32_32x32x16_bf16 v[64:79], a[80:83], v[244:247], v[64:79]
    s_waitcnt lgkmcnt(4)
    ds_read_b64_tr_b16 a[64:65], v12
    ds_read_b64_tr_b16 a[66:67], v12 offset:512
    v_accvgpr_read_b32 v216, a152
    v_accvgpr_read_b32 v217, a153
    v_accvgpr_read_b32 v218, a154
    v_accvgpr_read_b32 v219, a155
    v_mfma_f32_32x32x16_bf16 v[80:95], a[84:87], v[244:247], v[80:95]
    s_waitcnt lgkmcnt(4)
    ds_read_b64_tr_b16 a[68:69], v12 offset:2048
    ds_read_b64_tr_b16 a[70:71], v12 offset:2560
    buffer_load_dwordx4 v193, s[28:31], s56 offen offset:1024 sc1 lds
    v_accvgpr_read_b32 v220, a156
    v_mfma_f32_32x32x16_bf16 v[96:111], a[88:91], v[244:247], v[96:111]
    s_waitcnt lgkmcnt(4)
    ds_read_b64_tr_b16 a[72:73], v13
    ds_read_b64_tr_b16 a[74:75], v13 offset:512
    buffer_load_dwordx4 a[52:55], v17, s[28:31], s57 offen offset:2048 sc1
    v_accvgpr_read_b32 v221, a157
    v_accvgpr_read_b32 v222, a158
    v_mfma_f32_32x32x16_bf16 v[112:127], a[92:95], v[244:247], v[112:127]
    s_waitcnt lgkmcnt(4)
    ds_read_b64_tr_b16 a[76:77], v13 offset:2048
    ds_read_b64_tr_b16 a[78:79], v13 offset:2560
    buffer_load_dwordx4 a[56:59], v16, s[28:31], s57 offen offset:3072 sc1
    v_accvgpr_read_b32 v223, a159
    v_mfma_f32_32x32x16_bf16 v[64:79], a[64:67], v[248:251], v[64:79]
    s_waitcnt lgkmcnt(4)
    ds_read_b64_tr_b16 a[80:81], v14
    ds_read_b64_tr_b16 a[82:83], v14 offset:512
    v_accvgpr_read_b32 v224, a160
    v_accvgpr_read_b32 v225, a161
    v_accvgpr_read_b32 v226, a162
    v_accvgpr_read_b32 v227, a163
    v_accvgpr_read_b32 v228, a164
    v_mfma_f32_32x32x16_bf16 v[80:95], a[68:71], v[248:251], v[80:95]
    s_waitcnt lgkmcnt(4)
    s_lshl_b32 s55, s52, 11
    s_add_u32 s56, s92, 12582912
    s_add_u32 s56, s56, s55
    s_add_u32 m0, s53, 32768
    ds_read_b64_tr_b16 a[84:85], v14 offset:2048
    ds_read_b64_tr_b16 a[86:87], v14 offset:2560
    buffer_load_dwordx4 v2, s[28:31], s56 offen sc1 lds
    v_mfma_f32_32x32x16_bf16 v[96:111], a[72:75], v[248:251], v[96:111]
    s_waitcnt lgkmcnt(4)
    ds_read_b64_tr_b16 a[88:89], v15
    ds_read_b64_tr_b16 a[90:91], v15 offset:512
    buffer_load_dwordx4 a[60:63], v17, s[28:31], s57 offen offset:3072 sc1
    v_accvgpr_read_b32 v229, a165
    v_accvgpr_read_b32 v230, a166
    v_accvgpr_read_b32 v231, a167
    v_mfma_f32_32x32x16_bf16 v[112:127], a[76:79], v[248:251], v[112:127]
    s_waitcnt lgkmcnt(4)
    s_lshl_b32 s57, s86, 12
    s_add_u32 s57, s57, s49
    ds_read_b64_tr_b16 a[92:93], v15 offset:2048
    ds_read_b64_tr_b16 a[94:95], v15 offset:2560
    buffer_load_dwordx4 a[196:199], v16, s[28:31], s57 offen sc1
    v_mfma_f32_32x32x16_bf16 v[64:79], a[80:83], v[252:255], v[64:79]
    s_waitcnt lgkmcnt(4)
    v_accvgpr_read_b32 v232, a168
    v_accvgpr_read_b32 v233, a169
    v_accvgpr_read_b32 v234, a170
    v_accvgpr_read_b32 v235, a171
    v_mfma_f32_32x32x16_bf16 v[80:95], a[84:87], v[252:255], v[80:95]
    s_waitcnt lgkmcnt(2)
    buffer_load_dwordx4 v2, s[28:31], s56 offen offset:1024 sc1 lds
    v_accvgpr_read_b32 v236, a172
    v_mfma_f32_32x32x16_bf16 v[96:111], a[88:91], v[252:255], v[96:111]
    s_waitcnt lgkmcnt(0)
    buffer_load_dwordx4 a[200:203], v17, s[28:31], s57 offen sc1
    v_accvgpr_read_b32 v237, a173
    v_accvgpr_read_b32 v238, a174
    v_mfma_f32_32x32x16_bf16 v[112:127], a[92:95], v[252:255], v[112:127]
    buffer_load_dwordx4 a[204:207], v16, s[28:31], s57 offen offset:1024 sc1
    v_accvgpr_read_b32 v239, a175
    buffer_load_dwordx4 a[208:211], v17, s[28:31], s57 offen offset:1024 sc1
    v_pk_mul_f32 v[28:29], v[64:65], v[64:65]
    v_pk_mul_f32 v[30:31], v[66:67], v[66:67]
    v_pk_mul_f32 v[32:33], v[68:69], v[68:69]
    v_pk_mul_f32 v[34:35], v[70:71], v[70:71]
    v_pk_fma_f32 v[28:29], v[28:29], s[20:21], v[6:7] op_sel_hi:[1,1,0]
    v_pk_fma_f32 v[30:31], v[30:31], s[20:21], v[6:7] op_sel_hi:[1,1,0]
    v_pk_fma_f32 v[32:33], v[32:33], s[20:21], v[6:7] op_sel_hi:[1,1,0]
    v_pk_fma_f32 v[34:35], v[34:35], s[20:21], v[6:7] op_sel_hi:[1,1,0]
    v_pk_mul_f32 v[28:29], v[28:29], v[64:65]
    v_pk_mul_f32 v[30:31], v[30:31], v[66:67]
    v_pk_mul_f32 v[32:33], v[32:33], v[68:69]
    v_pk_mul_f32 v[34:35], v[34:35], v[70:71]
    v_exp_f32_e64 v28, v28
    v_pk_mul_f32 v[80:81], v[80:81], v[64:65]
    v_exp_f32_e64 v29, v29
    v_pk_mul_f32 v[82:83], v[82:83], v[66:67]
    v_exp_f32_e64 v30, v30
    v_pk_mul_f32 v[84:85], v[84:85], v[68:69]
    v_exp_f32_e64 v31, v31
    v_pk_mul_f32 v[86:87], v[86:87], v[70:71]
    v_exp_f32_e64 v32, v32
    v_pk_mul_f32 v[36:37], v[72:73], v[72:73]
    v_exp_f32_e64 v33, v33
    v_pk_mul_f32 v[38:39], v[74:75], v[74:75]
    v_exp_f32_e64 v34, v34
    v_pk_mul_f32 v[40:41], v[76:77], v[76:77]
    v_exp_f32_e64 v35, v35
    v_pk_mul_f32 v[42:43], v[78:79], v[78:79]
    v_pk_add_f32 v[28:29], v[28:29], 1.0 op_sel_hi:[1,0]
    v_pk_add_f32 v[30:31], v[30:31], 1.0 op_sel_hi:[1,0]
    v_pk_add_f32 v[32:33], v[32:33], 1.0 op_sel_hi:[1,0]
    v_pk_add_f32 v[34:35], v[34:35], 1.0 op_sel_hi:[1,0]
    v_rcp_f32_e64 v28, v28
    v_pk_fma_f32 v[36:37], v[36:37], s[20:21], v[6:7] op_sel_hi:[1,1,0]
    v_rcp_f32_e64 v29, v29
    v_pk_fma_f32 v[38:39], v[38:39], s[20:21], v[6:7] op_sel_hi:[1,1,0]
    v_rcp_f32_e64 v30, v30
    v_pk_fma_f32 v[40:41], v[40:41], s[20:21], v[6:7] op_sel_hi:[1,1,0]
    v_rcp_f32_e64 v31, v31
    v_pk_fma_f32 v[42:43], v[42:43], s[20:21], v[6:7] op_sel_hi:[1,1,0]
    v_rcp_f32_e64 v32, v32
    v_pk_mul_f32 v[36:37], v[36:37], v[72:73]
    v_rcp_f32_e64 v33, v33
    v_pk_mul_f32 v[38:39], v[38:39], v[74:75]
    v_rcp_f32_e64 v34, v34
    v_pk_mul_f32 v[40:41], v[40:41], v[76:77]
    v_rcp_f32_e64 v35, v35
    v_pk_mul_f32 v[42:43], v[42:43], v[78:79]
    v_pk_mul_f32 v[80:81], v[80:81], v[28:29]
    v_pk_mul_f32 v[82:83], v[82:83], v[30:31]
    v_pk_mul_f32 v[84:85], v[84:85], v[32:33]
    v_pk_mul_f32 v[86:87], v[86:87], v[34:35]
    v_cvt_pk_bf16_f32 v48, v80, v81
    v_cvt_pk_bf16_f32 v49, v82, v83
    v_cvt_pk_bf16_f32 v50, v84, v85
    v_cvt_pk_bf16_f32 v51, v86, v87
    buffer_store_dwordx4 v[48:51], v2, s[28:31], s70 offen sc1
    buffer_load_dwordx4 a[212:215], v16, s[28:31], s57 offen offset:2048 sc1
    v_exp_f32_e64 v36, v36
    v_pk_mul_f32 v[88:89], v[88:89], v[72:73]
    v_exp_f32_e64 v37, v37
    v_pk_mul_f32 v[90:91], v[90:91], v[74:75]
    v_exp_f32_e64 v38, v38
    v_pk_mul_f32 v[92:93], v[92:93], v[76:77]
    v_exp_f32_e64 v39, v39
    v_pk_mul_f32 v[94:95], v[94:95], v[78:79]
    v_exp_f32_e64 v40, v40
    v_pk_mul_f32 v[28:29], v[96:97], v[96:97]
    v_exp_f32_e64 v41, v41
    v_pk_mul_f32 v[30:31], v[98:99], v[98:99]
    v_exp_f32_e64 v42, v42
    v_pk_mul_f32 v[32:33], v[100:101], v[100:101]
    v_exp_f32_e64 v43, v43
    v_pk_mul_f32 v[34:35], v[102:103], v[102:103]
    v_pk_add_f32 v[36:37], v[36:37], 1.0 op_sel_hi:[1,0]
    v_pk_add_f32 v[38:39], v[38:39], 1.0 op_sel_hi:[1,0]
    v_pk_add_f32 v[40:41], v[40:41], 1.0 op_sel_hi:[1,0]
    v_pk_add_f32 v[42:43], v[42:43], 1.0 op_sel_hi:[1,0]
    v_rcp_f32_e64 v36, v36
    v_pk_fma_f32 v[28:29], v[28:29], s[20:21], v[6:7] op_sel_hi:[1,1,0]
    v_rcp_f32_e64 v37, v37
    v_pk_fma_f32 v[30:31], v[30:31], s[20:21], v[6:7] op_sel_hi:[1,1,0]
    v_rcp_f32_e64 v38, v38
    v_pk_fma_f32 v[32:33], v[32:33], s[20:21], v[6:7] op_sel_hi:[1,1,0]
    v_rcp_f32_e64 v39, v39
    v_pk_fma_f32 v[34:35], v[34:35], s[20:21], v[6:7] op_sel_hi:[1,1,0]
    v_rcp_f32_e64 v40, v40
    v_pk_mul_f32 v[28:29], v[28:29], v[96:97]
    v_rcp_f32_e64 v41, v41
    v_pk_mul_f32 v[30:31], v[30:31], v[98:99]
    v_rcp_f32_e64 v42, v42
    v_pk_mul_f32 v[32:33], v[32:33], v[100:101]
    v_rcp_f32_e64 v43, v43
    v_pk_mul_f32 v[34:35], v[34:35], v[102:103]
    v_pk_mul_f32 v[88:89], v[88:89], v[36:37]
    v_pk_mul_f32 v[90:91], v[90:91], v[38:39]
    v_pk_mul_f32 v[92:93], v[92:93], v[40:41]
    v_pk_mul_f32 v[94:95], v[94:95], v[42:43]
    v_cvt_pk_bf16_f32 v52, v88, v89
    v_cvt_pk_bf16_f32 v53, v90, v91
    v_cvt_pk_bf16_f32 v54, v92, v93
    v_cvt_pk_bf16_f32 v55, v94, v95
    buffer_store_dwordx4 v[52:55], v2, s[28:31], s70 offen offset:1024 sc1
    buffer_load_dwordx4 a[216:219], v17, s[28:31], s57 offen offset:2048 sc1
    v_exp_f32_e64 v28, v28
    v_pk_mul_f32 v[112:113], v[112:113], v[96:97]
    v_exp_f32_e64 v29, v29
    v_pk_mul_f32 v[114:115], v[114:115], v[98:99]
    v_exp_f32_e64 v30, v30
    v_pk_mul_f32 v[116:117], v[116:117], v[100:101]
    v_exp_f32_e64 v31, v31
    v_pk_mul_f32 v[118:119], v[118:119], v[102:103]
    v_exp_f32_e64 v32, v32
    v_pk_mul_f32 v[36:37], v[104:105], v[104:105]
    v_exp_f32_e64 v33, v33
    v_pk_mul_f32 v[38:39], v[106:107], v[106:107]
    v_exp_f32_e64 v34, v34
    v_pk_mul_f32 v[40:41], v[108:109], v[108:109]
    v_exp_f32_e64 v35, v35
    v_pk_mul_f32 v[42:43], v[110:111], v[110:111]
    v_pk_add_f32 v[28:29], v[28:29], 1.0 op_sel_hi:[1,0]
    v_pk_add_f32 v[30:31], v[30:31], 1.0 op_sel_hi:[1,0]
    v_pk_add_f32 v[32:33], v[32:33], 1.0 op_sel_hi:[1,0]
    v_pk_add_f32 v[34:35], v[34:35], 1.0 op_sel_hi:[1,0]
    v_rcp_f32_e64 v28, v28
    v_pk_fma_f32 v[36:37], v[36:37], s[20:21], v[6:7] op_sel_hi:[1,1,0]
    v_rcp_f32_e64 v29, v29
    v_pk_fma_f32 v[38:39], v[38:39], s[20:21], v[6:7] op_sel_hi:[1,1,0]
    v_rcp_f32_e64 v30, v30
    v_pk_fma_f32 v[40:41], v[40:41], s[20:21], v[6:7] op_sel_hi:[1,1,0]
    v_rcp_f32_e64 v31, v31
    v_pk_fma_f32 v[42:43], v[42:43], s[20:21], v[6:7] op_sel_hi:[1,1,0]
    v_rcp_f32_e64 v32, v32
    v_pk_mul_f32 v[36:37], v[36:37], v[104:105]
    v_rcp_f32_e64 v33, v33
    v_pk_mul_f32 v[38:39], v[38:39], v[106:107]
    v_rcp_f32_e64 v34, v34
    v_pk_mul_f32 v[40:41], v[40:41], v[108:109]
    v_rcp_f32_e64 v35, v35
    v_pk_mul_f32 v[42:43], v[42:43], v[110:111]
    v_pk_mul_f32 v[112:113], v[112:113], v[28:29]
    v_pk_mul_f32 v[114:115], v[114:115], v[30:31]
    v_pk_mul_f32 v[116:117], v[116:117], v[32:33]
    v_pk_mul_f32 v[118:119], v[118:119], v[34:35]
    v_cvt_pk_bf16_f32 v56, v112, v113
    v_cvt_pk_bf16_f32 v57, v114, v115
    v_cvt_pk_bf16_f32 v58, v116, v117
    v_cvt_pk_bf16_f32 v59, v118, v119
    buffer_store_dwordx4 v[56:59], v2, s[28:31], s70 offen offset:2048 sc1
    buffer_load_dwordx4 a[220:223], v16, s[28:31], s57 offen offset:3072 sc1
    v_exp_f32 v36, v36
    v_exp_f32 v37, v37
    v_pk_mul_f32 v[120:121], v[120:121], v[104:105]
    v_exp_f32 v38, v38
    v_exp_f32 v39, v39
    v_pk_mul_f32 v[122:123], v[122:123], v[106:107]
    v_exp_f32 v40, v40
    v_exp_f32 v41, v41
    v_pk_mul_f32 v[124:125], v[124:125], v[108:109]
    v_exp_f32 v42, v42
    v_exp_f32 v43, v43
    v_pk_mul_f32 v[126:127], v[126:127], v[110:111]
    v_pk_add_f32 v[36:37], v[36:37], 1.0 op_sel_hi:[1,0]
    v_pk_add_f32 v[38:39], v[38:39], 1.0 op_sel_hi:[1,0]
    v_pk_add_f32 v[40:41], v[40:41], 1.0 op_sel_hi:[1,0]
    v_pk_add_f32 v[42:43], v[42:43], 1.0 op_sel_hi:[1,0]
    buffer_load_dwordx4 a[224:227], v17, s[28:31], s57 offen offset:3072 sc1
    v_rcp_f32 v36, v36
    v_rcp_f32 v37, v37
    v_rcp_f32 v38, v38
    v_rcp_f32 v39, v39
    v_rcp_f32 v40, v40
    v_rcp_f32 v41, v41
    v_rcp_f32 v42, v42
    v_rcp_f32 v43, v43
    v_pk_mul_f32 v[120:121], v[120:121], v[36:37]
    v_pk_mul_f32 v[122:123], v[122:123], v[38:39]
    v_pk_mul_f32 v[124:125], v[124:125], v[40:41]
    v_pk_mul_f32 v[126:127], v[126:127], v[42:43]
    v_cvt_pk_bf16_f32 v60, v120, v121
    v_cvt_pk_bf16_f32 v61, v122, v123
    v_cvt_pk_bf16_f32 v62, v124, v125
    v_cvt_pk_bf16_f32 v63, v126, v127
    buffer_store_dwordx4 v[60:63], v2, s[28:31], s70 offen offset:3072 sc1
    s_waitcnt vmcnt(11)
    s_barrier
    ds_read_b128 v[80:83], v195
    ds_read_b128 v[84:87], v196
    ds_read_b128 v[88:91], v197
    ds_read_b128 v[92:95], v198
    ds_read_b128 v[96:99], v199
    ds_read_b128 v[100:103], v200
    ds_read_b128 v[104:107], v201
    ds_read_b128 v[108:111], v202
    ds_read2st64_b32 v[240:241], v194 offset0:0 offset1:1
    ds_read2st64_b32 v[242:243], v194 offset0:2 offset1:3
    ds_read2st64_b32 v[244:245], v207 offset0:0 offset1:1
    ds_read2st64_b32 v[246:247], v207 offset0:2 offset1:3
    v_accvgpr_read_b32 v8, a182
    v_accvgpr_read_b32 v10, a183
    v_accvgpr_read_b32 v12, a184
    v_accvgpr_read_b32 v32, a193
    v_accvgpr_read_b32 v28, a195
    s_waitcnt lgkmcnt(11)
    v_mfma_f32_16x16x32_bf16 v[64:67], v[80:83], a[96:99], 0
    v_mfma_f32_16x16x32_bf16 v[72:75], v[80:83], a[112:115], 0
    v_xor_b32_e64 v9, 64, v8
    s_waitcnt lgkmcnt(10)
    v_mfma_f32_16x16x32_bf16 v[64:67], v[84:87], a[100:103], v[64:67]
    v_mfma_f32_16x16x32_bf16 v[72:75], v[84:87], a[116:119], v[72:75]
    v_xor_b32 v11, 128, v10
    s_waitcnt lgkmcnt(9)
    v_mfma_f32_16x16x32_bf16 v[64:67], v[88:91], a[104:107], v[64:67]
    v_mfma_f32_16x16x32_bf16 v[72:75], v[88:91], a[96:99], v[72:75]
    s_waitcnt lgkmcnt(8)
    v_mfma_f32_16x16x32_bf16 v[64:67], v[92:95], a[108:111], v[64:67]
    v_xor_b32_e64 v29, 32, v28
    v_mfma_f32_16x16x32_bf16 v[72:75], v[92:95], a[100:103], v[72:75]
    s_waitcnt lgkmcnt(7)
    v_mfma_f32_16x16x32_bf16 v[68:71], v[96:99], a[96:99], 0
    v_mfma_f32_16x16x32_bf16 v[76:79], v[96:99], a[112:115], 0
    v_add_u32 v13, 32768, v12
    s_waitcnt lgkmcnt(6)
    v_mfma_f32_16x16x32_bf16 v[68:71], v[100:103], a[100:103], v[68:71]
    v_mfma_f32_16x16x32_bf16 v[76:79], v[100:103], a[116:119], v[76:79]
    v_add_u32 v14, 65536, v12
    s_waitcnt lgkmcnt(5)
    v_mfma_f32_16x16x32_bf16 v[68:71], v[104:107], a[104:107], v[68:71]
    v_mfma_f32_16x16x32_bf16 v[76:79], v[104:107], a[96:99], v[76:79]
    s_waitcnt lgkmcnt(4)
    v_mfma_f32_16x16x32_bf16 v[68:71], v[108:111], a[108:111], v[68:71]
    v_add_u32 v15, 98304, v12
    v_mfma_f32_16x16x32_bf16 v[76:79], v[108:111], a[100:103], v[76:79]
    s_waitcnt lgkmcnt(3)
    v_lshlrev_b32 v44, 16, v240
    v_and_b32 v52, s82, v240
    v_lshlrev_b32 v45, 16, v241
    v_and_b32 v53, s82, v241
    s_waitcnt lgkmcnt(2)
    v_lshlrev_b32 v46, 16, v242
    v_and_b32 v54, s82, v242
    v_lshlrev_b32 v47, 16, v243
    v_and_b32 v55, s82, v243
    s_waitcnt lgkmcnt(1)
    v_lshlrev_b32 v48, 16, v244
    v_and_b32 v56, s82, v244
    v_lshlrev_b32 v49, 16, v245
    v_and_b32 v57, s82, v245
    s_waitcnt lgkmcnt(0)
    v_lshlrev_b32 v50, 16, v246
    v_and_b32 v58, s82, v246
    v_lshlrev_b32 v51, 16, v247
    v_and_b32 v59, s82, v247
    v_pk_mul_f32 v[112:113], v[64:65], v[208:209]
    v_pk_mul_f32 v[120:121], v[72:73], v[208:209]
    v_pk_mul_f32 v[114:115], v[66:67], v[210:211]
    v_pk_mul_f32 v[122:123], v[74:75], v[210:211]
    v_pk_mul_f32 v[116:117], v[68:69], v[212:213]
    v_pk_mul_f32 v[124:125], v[76:77], v[212:213]
    v_pk_mul_f32 v[118:119], v[70:71], v[214:215]
    v_pk_mul_f32 v[126:127], v[78:79], v[214:215]
    v_pk_fma_f32 v[112:113], v[72:73], v[216:217], v[112:113]
    v_pk_fma_f32 v[120:121], v[64:65], v[216:217], v[120:121] neg_lo:[1,0,0] neg_hi:[1,0,0]
    v_pk_fma_f32 v[114:115], v[74:75], v[218:219], v[114:115]
    v_pk_fma_f32 v[122:123], v[66:67], v[218:219], v[122:123] neg_lo:[1,0,0] neg_hi:[1,0,0]
    v_pk_fma_f32 v[116:117], v[76:77], v[220:221], v[116:117]
    v_pk_fma_f32 v[124:125], v[68:69], v[220:221], v[124:125] neg_lo:[1,0,0] neg_hi:[1,0,0]
    v_pk_fma_f32 v[118:119], v[78:79], v[222:223], v[118:119]
    v_pk_fma_f32 v[126:127], v[70:71], v[222:223], v[126:127] neg_lo:[1,0,0] neg_hi:[1,0,0]
    v_cvt_pk_bf16_f32 v80, v112, v113
    v_cvt_pk_bf16_f32 v81, v114, v115
    v_cvt_pk_bf16_f32 v82, v116, v117
    v_cvt_pk_bf16_f32 v83, v118, v119
    v_cvt_pk_bf16_f32 v84, v120, v121
    v_cvt_pk_bf16_f32 v85, v122, v123
    v_cvt_pk_bf16_f32 v86, v124, v125
    v_cvt_pk_bf16_f32 v87, v126, v127
    v_mfma_f32_16x16x32_bf16 v[64:67], a[120:123], v[80:83], 0
    s_nop 0
    v_mfma_f32_16x16x32_bf16 v[72:75], a[120:123], v[84:87], 0
    v_mfma_f32_16x16x32_bf16 v[68:71], a[124:127], v[80:83], 0
    v_mfma_f32_16x16x32_bf16 v[76:79], a[124:127], v[84:87], 0
    v_mfma_f32_16x16x32_bf16 v[64:67], a[128:131], v[84:87], v[64:67]
    v_mfma_f32_16x16x32_bf16 v[72:75], a[136:139], v[80:83], v[72:75]
    v_mfma_f32_16x16x32_bf16 v[68:71], a[132:135], v[84:87], v[68:71]
    v_mfma_f32_16x16x32_bf16 v[76:79], a[140:143], v[80:83], v[76:79]
    s_add_u32 s56, s48, 16384
    s_waitcnt vmcnt(0)
    buffer_atomic_add v5, v4, s[28:31], s56 offen sc1
    v_lshrrev_b32 v31, 4, v1
    v_and_b32 v30, 7, v1
    v_xor_b32 v30, v30, v31
    v_lshrrev_b32 v31, 3, v1
    v_lshlrev_b32_e64 v30, 4, v30
    v_lshl_add_u32 v30, v31, 15, v30
    v_xor_b32_e64 v31, 64, v30
    v_add_u32 v31, 261120, v31
    v_min_u32_e64 v24, 1, v1
    v_lshlrev_b32 v24, 8, v24
    v_pk_mul_f32 v[112:113], v[64:65], v[44:45]
    v_pk_mul_f32 v[120:121], v[72:73], v[44:45]
    v_pk_mul_f32 v[114:115], v[66:67], v[46:47]
    v_pk_mul_f32 v[122:123], v[74:75], v[46:47]
    v_pk_mul_f32 v[116:117], v[68:69], v[48:49]
    v_pk_mul_f32 v[124:125], v[76:77], v[48:49]
    v_pk_mul_f32 v[118:119], v[70:71], v[50:51]
    v_pk_mul_f32 v[126:127], v[78:79], v[50:51]
    v_pk_fma_f32 v[112:113], v[72:73], v[52:53], v[112:113] neg_lo:[1,0,0] neg_hi:[1,0,0]
    v_pk_fma_f32 v[120:121], v[64:65], v[52:53], v[120:121]
    v_pk_fma_f32 v[114:115], v[74:75], v[54:55], v[114:115] neg_lo:[1,0,0] neg_hi:[1,0,0]
    v_pk_fma_f32 v[122:123], v[66:67], v[54:55], v[122:123]
    v_pk_fma_f32 v[116:117], v[76:77], v[56:57], v[116:117] neg_lo:[1,0,0] neg_hi:[1,0,0]
    v_pk_fma_f32 v[124:125], v[68:69], v[56:57], v[124:125]
    v_pk_fma_f32 v[118:119], v[78:79], v[58:59], v[118:119] neg_lo:[1,0,0] neg_hi:[1,0,0]
    v_pk_fma_f32 v[126:127], v[70:71], v[58:59], v[126:127]
    v_cvt_pk_bf16_f32 v88, v112, v113
    v_cvt_pk_bf16_f32 v89, v114, v115
    v_cvt_pk_bf16_f32 v90, v116, v117
    v_cvt_pk_bf16_f32 v91, v118, v119
    v_cvt_pk_bf16_f32 v92, v120, v121
    v_cvt_pk_bf16_f32 v93, v122, v123
    v_cvt_pk_bf16_f32 v94, v124, v125
    v_cvt_pk_bf16_f32 v95, v126, v127
    v_mfma_f32_16x16x32_bf16 v[64:67], v[88:91], a[120:123], 0
    s_nop 0
    v_mfma_f32_16x16x32_bf16 v[72:75], v[92:95], a[120:123], 0
    v_mfma_f32_16x16x32_bf16 v[68:71], v[88:91], a[124:127], 0
    v_mfma_f32_16x16x32_bf16 v[76:79], v[92:95], a[124:127], 0
    v_mfma_f32_16x16x32_bf16 v[64:67], v[92:95], a[136:139], v[64:67]
    v_mfma_f32_16x16x32_bf16 v[72:75], v[88:91], a[128:131], v[72:75]
    v_mfma_f32_16x16x32_bf16 v[68:71], v[92:95], a[140:143], v[68:71]
    v_mfma_f32_16x16x32_bf16 v[76:79], v[88:91], a[132:135], v[76:79]
    ds_read_b64_tr_b16 a[64:65], v8 offset:16384
    ds_read_b64_tr_b16 a[66:67], v8 offset:17408
    ds_read_b64_tr_b16 a[68:69], v9 offset:16384
    ds_read_b64_tr_b16 a[70:71], v9 offset:17408
    s_lshr_b32 s22, s2, 3
    s_add_u32 s22, s22, 160
    s_lshl_b32 s22, s22, 8
    s_add_u32 s0, s92, 15728640
    v_pk_mul_f32 v[112:113], v[64:65], v[224:225]
    v_pk_mul_f32 v[120:121], v[72:73], v[224:225]
    v_pk_mul_f32 v[114:115], v[66:67], v[226:227]
    v_pk_mul_f32 v[122:123], v[74:75], v[226:227]
    v_pk_mul_f32 v[116:117], v[68:69], v[228:229]
    v_pk_mul_f32 v[124:125], v[76:77], v[228:229]
    v_pk_mul_f32 v[118:119], v[70:71], v[230:231]
    v_pk_mul_f32 v[126:127], v[78:79], v[230:231]
    v_pk_fma_f32 v[112:113], v[72:73], v[232:233], v[112:113] neg_lo:[1,0,0] neg_hi:[1,0,0]
    v_pk_fma_f32 v[120:121], v[64:65], v[232:233], v[120:121]
    v_pk_fma_f32 v[114:115], v[74:75], v[234:235], v[114:115] neg_lo:[1,0,0] neg_hi:[1,0,0]
    v_pk_fma_f32 v[122:123], v[66:67], v[234:235], v[122:123]
    v_pk_fma_f32 v[116:117], v[76:77], v[236:237], v[116:117] neg_lo:[1,0,0] neg_hi:[1,0,0]
    v_pk_fma_f32 v[124:125], v[68:69], v[236:237], v[124:125]
    v_pk_fma_f32 v[118:119], v[78:79], v[238:239], v[118:119] neg_lo:[1,0,0] neg_hi:[1,0,0]
    v_pk_fma_f32 v[126:127], v[70:71], v[238:239], v[126:127]
    v_cvt_pk_bf16_f32 v80, v112, v113
    v_cvt_pk_bf16_f32 v81, v114, v115
    v_cvt_pk_bf16_f32 v82, v116, v117
    v_cvt_pk_bf16_f32 v83, v118, v119
    v_cvt_pk_bf16_f32 v84, v120, v121
    v_cvt_pk_bf16_f32 v85, v122, v123
    v_cvt_pk_bf16_f32 v86, v124, v125
    v_cvt_pk_bf16_f32 v87, v126, v127
    ds_write_b64 v203, v[80:81]
    ds_write_b64 v203, v[84:85] offset:40960
    ds_write_b64 v204, v[82:83]
    ds_write_b64 v204, v[86:87] offset:40960
    s_waitcnt lgkmcnt(0)
    s_barrier
    ds_read_b128 v[80:83], v205
    ds_read_b128 v[84:87], v205 offset:1024
    ds_read_b128 v[88:91], v205 offset:40960
    ds_read_b128 v[92:95], v205 offset:41984
    ds_read_b128 v[96:99], v206
    ds_read_b128 v[100:103], v206 offset:1024
    ds_read_b128 v[104:107], v206 offset:40960
    ds_read_b128 v[108:111], v206 offset:41984
    s_add_u32 m0, s53, 0
    s_lshl_b32 s55, s87, 16
    s_add_u32 s55, s55, 32768
    buffer_load_dwordx4 v20, s[16:19], s55 offen lds
    buffer_load_dwordx4 v21, s[16:19], s55 offen offset:1024 lds
    s_waitcnt lgkmcnt(7)
    v_mfma_f32_16x16x32_bf16 v[64:67], a[96:99], v[80:83], 0
    v_mfma_f32_16x16x32_bf16 v[72:75], a[104:107], v[80:83], 0
    s_waitcnt lgkmcnt(6)
    v_mfma_f32_16x16x32_bf16 v[64:67], a[100:103], v[84:87], v[64:67]
    v_mfma_f32_16x16x32_bf16 v[72:75], a[108:111], v[84:87], v[72:75]
    s_waitcnt lgkmcnt(5)
    v_mfma_f32_16x16x32_bf16 v[64:67], a[112:115], v[88:91], v[64:67]
    v_mfma_f32_16x16x32_bf16 v[72:75], a[96:99], v[88:91], v[72:75]
    s_waitcnt lgkmcnt(4)
    v_mfma_f32_16x16x32_bf16 v[64:67], a[116:119], v[92:95], v[64:67]
    v_mfma_f32_16x16x32_bf16 v[72:75], a[100:103], v[92:95], v[72:75]
    s_waitcnt lgkmcnt(3)
    v_mfma_f32_16x16x32_bf16 v[68:71], a[96:99], v[96:99], 0
    v_mfma_f32_16x16x32_bf16 v[76:79], a[104:107], v[96:99], 0
    s_waitcnt lgkmcnt(2)
    v_mfma_f32_16x16x32_bf16 v[68:71], a[100:103], v[100:103], v[68:71]
    v_mfma_f32_16x16x32_bf16 v[76:79], a[108:111], v[100:103], v[76:79]
    s_waitcnt lgkmcnt(1)
    v_mfma_f32_16x16x32_bf16 v[68:71], a[112:115], v[104:107], v[68:71]
    v_mfma_f32_16x16x32_bf16 v[76:79], a[96:99], v[104:107], v[76:79]
    s_waitcnt lgkmcnt(0)
    v_mfma_f32_16x16x32_bf16 v[68:71], a[116:119], v[108:111], v[68:71]
    v_mfma_f32_16x16x32_bf16 v[76:79], a[100:103], v[108:111], v[76:79]
    buffer_load_dwordx4 v22, s[16:19], s55 offen offset:2048 lds
    buffer_load_dwordx4 v23, s[16:19], s55 offen offset:3072 lds
    v_cvt_pk_bf16_f32 v248, v64, v65
    v_cvt_pk_bf16_f32 v249, v66, v67
    v_cvt_pk_bf16_f32 v250, v72, v73
    v_cvt_pk_bf16_f32 v251, v74, v75
    s_nop 0
    v_cvt_pk_bf16_f32 v252, v68, v69
    v_cvt_pk_bf16_f32 v253, v70, v71
    v_cvt_pk_bf16_f32 v254, v76, v77
    v_cvt_pk_bf16_f32 v255, v78, v79
    buffer_store_dwordx4 v[248:251], v26, s[28:31], s0 offen sc1
    s_add_u32 s0, s0, 4096
    buffer_store_dwordx4 v[252:255], v26, s[28:31], s0 offen sc1
    s_cmp_eq_u32 s50, 0
    s_cbranch_scc1 L_slow_h1f_3
L_ret_h1f_3:
    s_add_u32 s51, s51, 16384
    v_mfma_f32_32x32x16_bf16 v[64:79], a[64:67], a[0:3], 0
    ds_read_b64_tr_b16 a[72:73], v8 offset:18432
    ds_read_b64_tr_b16 a[74:75], v8 offset:19456
    v_accvgpr_read_b32 v192, a187
    v_accvgpr_read_b32 v194, a189
    v_accvgpr_read_b32 v196, a191
    v_mfma_f32_32x32x16_bf16 v[96:111], a[64:67], a[4:7], 0
    s_add_u32 m0, s53, 32768
    s_lshl_b32 s55, s88, 16
    ds_read_b64_tr_b16 a[76:77], v9 offset:18432
    ds_read_b64_tr_b16 a[78:79], v9 offset:19456
    buffer_load_dwordx4 v20, s[16:19], s55 offen lds
    v_mfma_f32_32x32x16_bf16 v[80:95], a[68:71], a[0:3], 0
    buffer_load_dwordx4 v21, s[16:19], s55 offen offset:1024 lds
    v_accvgpr_read_b32 v193, a188
    v_mfma_f32_32x32x16_bf16 v[112:127], a[68:71], a[4:7], 0
    s_waitcnt lgkmcnt(2)
    buffer_load_dwordx4 v22, s[16:19], s55 offen offset:2048 lds
    v_accvgpr_read_b32 v195, a190
    v_accvgpr_read_b32 v197, a192
    v_mfma_f32_32x32x16_bf16 v[64:79], a[72:75], a[8:11], v[64:79]
    ds_read_b64_tr_b16 a[80:81], v8 offset:20480
    ds_read_b64_tr_b16 a[82:83], v8 offset:21504
    s_add_u32 s26, s80, 2
    s_and_b32 s26, s26, 3
    s_cselect_b64 s[24:25], 0, -1
    s_lshl_b32 s26, s26, 4
    v_mfma_f32_32x32x16_bf16 v[96:111], a[72:75], a[12:15], v[96:111]
    s_waitcnt lgkmcnt(2)
    ds_read_b64_tr_b16 a[84:85], v9 offset:20480
    ds_read_b64_tr_b16 a[86:87], v9 offset:21504
    buffer_load_dwordx4 v23, s[16:19], s55 offen offset:3072 lds
    v_cvt_f32_u32_e64 v199, s26
    v_fma_f32 v198, v199, v192, v194
    v_mfma_f32_32x32x16_bf16 v[80:95], a[76:79], a[8:11], v[80:95]
    s_lshl_b32 s55, s52, 19
    s_lshl_b32 s83, s79, 10
    s_add_u32 s55, s55, s83
    s_lshl_b32 s83, s80, 7
    s_add_u32 m0, s53, 36864
    s_add_u32 s55, s55, s83
    buffer_load_dwordx4 v30, s[4:7], s55 offen lds
    v_mfma_f32_32x32x16_bf16 v[112:127], a[76:79], a[12:15], v[112:127]
    s_waitcnt lgkmcnt(2)
    buffer_load_dwordx4 v31, s[4:7], s55 offen offset:1024 lds
    v_fma_f32 v199, v199, v193, v195
    v_cndmask_b32 v200, v198, v196, s[24:25]
    v_fmamk_f32 v201, v192, 0x3f800000, v198
    v_mfma_f32_32x32x16_bf16 v[64:79], a[80:83], a[16:19], v[64:79]
    ds_read_b64_tr_b16 a[88:89], v8 offset:22528
    ds_read_b64_tr_b16 a[90:91], v8 offset:23552
    v_fmamk_f32 v202, v192, 0x40000000, v198
    v_fmamk_f32 v203, v192, 0x40400000, v198
    v_cos_f32_e64 v204, v200
    v_mfma_f32_32x32x16_bf16 v[96:111], a[80:83], a[20:23], v[96:111]
    s_waitcnt lgkmcnt(2)
    s_add_u32 m0, s53, 16384
    s_lshl_b32 s55, s88, 16
    s_add_u32 s55, s55, 32768
    ds_read_b64_tr_b16 a[92:93], v9 offset:22528
    ds_read_b64_tr_b16 a[94:95], v9 offset:23552
    buffer_load_dwordx4 v20, s[16:19], s55 offen lds
    v_mfma_f32_32x32x16_bf16 v[80:95], a[84:87], a[16:19], v[80:95]
    buffer_load_dwordx4 v21, s[16:19], s55 offen offset:1024 lds
    v_cos_f32_e64 v205, v201
    v_cos_f32 v206, v202
    v_mfma_f32_32x32x16_bf16 v[112:127], a[84:87], a[20:23], v[112:127]
    s_waitcnt lgkmcnt(2)
    buffer_load_dwordx4 v22, s[16:19], s55 offen offset:2048 lds
    v_cos_f32_e64 v207, v203
    v_mfma_f32_32x32x16_bf16 v[64:79], a[88:91], a[24:27], v[64:79]
    ds_read_b64_tr_b16 a[64:65], v8 offset:24576
    ds_read_b64_tr_b16 a[66:67], v8 offset:25600
    v_sin_f32_e64 v200, -v200
    v_mfma_f32_32x32x16_bf16 v[96:111], a[88:91], a[28:31], v[96:111]
    s_waitcnt lgkmcnt(2)
    ds_read_b64_tr_b16 a[68:69], v9 offset:24576
    ds_read_b64_tr_b16 a[70:71], v9 offset:25600
    v_sin_f32_e64 v201, -v201
    v_mfma_f32_32x32x16_bf16 v[80:95], a[92:95], a[24:27], v[80:95]
    buffer_load_dwordx4 v23, s[16:19], s55 offen offset:3072 lds
    v_sin_f32_e64 v202, -v202
    v_mfma_f32_32x32x16_bf16 v[112:127], a[92:95], a[28:31], v[112:127]
    s_waitcnt lgkmcnt(2)
    v_sin_f32_e64 v203, -v203
    v_cvt_pk_bf16_f32 v160, v204, v205
    v_mfma_f32_32x32x16_bf16 v[64:79], a[64:67], a[32:35], v[64:79]
    ds_read_b64_tr_b16 a[72:73], v8 offset:26624
    ds_read_b64_tr_b16 a[74:75], v8 offset:27648
    v_cvt_pk_bf16_f32 v161, v206, v207
    v_cvt_pk_bf16_f32 v162, v200, v201
    v_cvt_pk_bf16_f32 v163, v202, v203
    v_cndmask_b32 v208, v199, v197, s[24:25]
    v_mfma_f32_32x32x16_bf16 v[96:111], a[64:67], a[36:39], v[96:111]
    s_waitcnt lgkmcnt(2)
    ds_read_b64_tr_b16 a[76:77], v9 offset:26624
    ds_read_b64_tr_b16 a[78:79], v9 offset:27648
    s_waitcnt vmcnt(10)
    buffer_atomic_add v5, v4, s[28:31], s22 offen sc1
    v_fmamk_f32 v209, v193, 0x3f800000, v199
    v_mfma_f32_32x32x16_bf16 v[80:95], a[68:71], a[32:35], v[80:95]
    s_add_u32 m0, s53, 20480
    s_lshl_b32 s55, s89, 16
    buffer_load_dwordx4 v20, s[16:19], s55 offen lds
    v_fmamk_f32 v210, v193, 0x40000000, v199
    v_mfma_f32_32x32x16_bf16 v[112:127], a[68:71], a[36:39], v[112:127]
    s_waitcnt lgkmcnt(2)
    buffer_load_dwordx4 v21, s[16:19], s55 offen offset:1024 lds
    v_fmamk_f32 v211, v193, 0x40400000, v199
    v_cos_f32_e64 v212, v208
    v_mfma_f32_32x32x16_bf16 v[64:79], a[72:75], a[40:43], v[64:79]
    ds_read_b64_tr_b16 a[80:81], v8 offset:4096
    ds_read_b64_tr_b16 a[82:83], v8 offset:5120
    v_cos_f32_e64 v213, v209
    v_cos_f32 v214, v210
    v_mfma_f32_32x32x16_bf16 v[96:111], a[72:75], a[44:47], v[96:111]
    s_waitcnt lgkmcnt(2)
    ds_read_b64_tr_b16 a[84:85], v9 offset:4096
    ds_read_b64_tr_b16 a[86:87], v9 offset:5120
    buffer_load_dword v25, v24, s[28:31], s51 offen sc1
    v_mfma_f32_32x32x16_bf16 v[80:95], a[76:79], a[40:43], v[80:95]
    buffer_load_dwordx4 v22, s[16:19], s55 offen offset:2048 lds
    v_cos_f32 v215, v211
    v_sin_f32_e64 v208, -v208
    v_mfma_f32_32x32x16_bf16 v[112:127], a[76:79], a[44:47], v[112:127]
    s_waitcnt lgkmcnt(2)
    buffer_load_dwordx4 v23, s[16:19], s55 offen offset:3072 lds
    v_sin_f32_e64 v209, -v209
    v_mfma_f32_32x32x16_bf16 v[64:79], a[80:83], a[48:51], v[64:79]
    ds_read_b64_tr_b16 a[88:89], v8 offset:6144
    ds_read_b64_tr_b16 a[90:91], v8 offset:7168
    v_sin_f32_e64 v210, -v210
    v_sin_f32_e64 v211, -v211
    v_mfma_f32_32x32x16_bf16 v[96:111], a[80:83], a[52:55], v[96:111]
    s_waitcnt lgkmcnt(2)
    s_add_u32 m0, s53, 24576
    s_lshl_b32 s55, s89, 16
    s_add_u32 s55, s55, 32768
    ds_read_b64_tr_b16 a[92:93], v9 offset:6144
    ds_read_b64_tr_b16 a[94:95], v9 offset:7168
    buffer_load_dwordx4 v20, s[16:19], s55 offen lds
    v_mfma_f32_32x32x16_bf16 v[80:95], a[84:87], a[48:51], v[80:95]
    buffer_load_dwordx4 v21, s[16:19], s55 offen offset:1024 lds
    v_cvt_pk_bf16_f32 v164, v212, v213
    v_cvt_pk_bf16_f32 v165, v214, v215
    v_mfma_f32_32x32x16_bf16 v[112:127], a[84:87], a[52:55], v[112:127]
    s_waitcnt lgkmcnt(2)
    buffer_load_dwordx4 v22, s[16:19], s55 offen offset:2048 lds
    v_cvt_pk_bf16_f32 v166, v208, v209
    v_cvt_pk_bf16_f32 v167, v210, v211
    v_fmamk_f32 v200, v192, 0x41000000, v198
    v_mfma_f32_32x32x16_bf16 v[64:79], a[88:91], a[56:59], v[64:79]
    ds_read_b64_tr_b16 a[64:65], v8 offset:8192
    ds_read_b64_tr_b16 a[66:67], v8 offset:9216
    v_fmamk_f32 v201, v192, 0x41100000, v198
    v_fmamk_f32 v202, v192, 0x41200000, v198
    v_mfma_f32_32x32x16_bf16 v[96:111], a[88:91], a[60:63], v[96:111]
    s_waitcnt lgkmcnt(2)
    ds_read_b64_tr_b16 a[68:69], v9 offset:8192
    ds_read_b64_tr_b16 a[70:71], v9 offset:9216
    v_fmamk_f32 v203, v192, 0x41300000, v198
    v_cos_f32_e64 v204, v200
    v_mfma_f32_32x32x16_bf16 v[80:95], a[92:95], a[56:59], v[80:95]
    buffer_load_dwordx4 v23, s[16:19], s55 offen offset:3072 lds
    v_mfma_f32_32x32x16_bf16 v[112:127], a[92:95], a[60:63], v[112:127]
    s_waitcnt lgkmcnt(2)
    v_cos_f32 v205, v201
    v_cos_f32 v206, v202
    v_mfma_f32_32x32x16_bf16 v[64:79], a[64:67], a[196:199], v[64:79]
    s_add_u32 m0, s53, 4096
    s_lshl_b32 s55, s90, 16
    ds_read_b64_tr_b16 a[72:73], v8 offset:10240
    ds_read_b64_tr_b16 a[74:75], v8 offset:11264
    buffer_load_dwordx4 v20, s[16:19], s55 offen lds
    s_waitcnt vmcnt(7)
    v_cmp_gt_u32 vcc, 16, v25
    v_mfma_f32_32x32x16_bf16 v[96:111], a[64:67], a[200:203], v[96:111]
    s_waitcnt lgkmcnt(2)
    ds_read_b64_tr_b16 a[76:77], v9 offset:10240
    ds_read_b64_tr_b16 a[78:79], v9 offset:11264
    buffer_load_dwordx4 v21, s[16:19], s55 offen offset:1024 lds
    s_cbranch_vccnz L_slow_h2f_4
L_ret_h2f_4:
    v_cos_f32 v207, v203
    v_mfma_f32_32x32x16_bf16 v[80:95], a[68:71], a[196:199], v[80:95]
    buffer_load_dwordx4 v22, s[16:19], s55 offen offset:2048 lds
    v_sin_f32_e64 v200, -v200
    v_sin_f32_e64 v201, -v201
    v_mfma_f32_32x32x16_bf16 v[112:127], a[68:71], a[200:203], v[112:127]
    s_waitcnt lgkmcnt(2)
    buffer_load_dwordx4 v23, s[16:19], s55 offen offset:3072 lds
    v_sin_f32_e64 v202, -v202
    v_sin_f32_e64 v203, -v203
    v_mfma_f32_32x32x16_bf16 v[64:79], a[72:75], a[204:207], v[64:79]
    s_lshl_b32 s57, s87, 12
    s_add_u32 s57, s57, s91
    ds_read_b64_tr_b16 a[80:81], v8 offset:12288
    ds_read_b64_tr_b16 a[82:83], v8 offset:13312
    buffer_load_dwordx4 a[228:231], v16, s[28:31], s57 offen sc1
    v_min_u32 v24, 31, v1
    v_add_u32 v24, 160, v24
    v_mfma_f32_32x32x16_bf16 v[96:111], a[72:75], a[208:211], v[96:111]
    s_waitcnt lgkmcnt(2)
    ds_read_b64_tr_b16 a[84:85], v9 offset:12288
    ds_read_b64_tr_b16 a[86:87], v9 offset:13312
    buffer_load_dwordx4 a[232:235], v17, s[28:31], s57 offen sc1
    v_lshlrev_b32_e64 v24, 8, v24
    v_mfma_f32_32x32x16_bf16 v[80:95], a[76:79], a[204:207], v[80:95]
    buffer_load_dwordx4 a[236:239], v16, s[28:31], s57 offen offset:1024 sc1
    s_cmp_eq_u32 s52, 0
    s_cselect_b32 s23, 32, 0
    s_cselect_b32 s27, 0, 0x7f000000
    v_cvt_pk_bf16_f32 v168, v204, v205
    v_cvt_pk_bf16_f32 v169, v206, v207
    v_cvt_pk_bf16_f32 v170, v200, v201
    v_cvt_pk_bf16_f32 v171, v202, v203
    v_fmamk_f32 v208, v193, 0x41000000, v199
    v_mfma_f32_32x32x16_bf16 v[112:127], a[76:79], a[208:211], v[112:127]
    s_waitcnt lgkmcnt(2)
    buffer_load_dwordx4 a[240:243], v17, s[28:31], s57 offen offset:1024 sc1
    v_fmamk_f32 v209, v193, 0x41100000, v199
    v_fmamk_f32 v210, v193, 0x41200000, v199
    v_fmamk_f32 v211, v193, 0x41300000, v199
    v_cos_f32 v212, v208
    v_mfma_f32_32x32x16_bf16 v[64:79], a[80:83], a[212:215], v[64:79]
    ds_read_b64_tr_b16 a[88:89], v8 offset:14336
    ds_read_b64_tr_b16 a[90:91], v8 offset:15360
    buffer_load_dwordx4 a[244:247], v16, s[28:31], s57 offen offset:2048 sc1
    v_cos_f32 v213, v209
    v_mfma_f32_32x32x16_bf16 v[96:111], a[80:83], a[216:219], v[96:111]
    s_waitcnt lgkmcnt(2)
    ds_read_b64_tr_b16 a[92:93], v9 offset:14336
    ds_read_b64_tr_b16 a[94:95], v9 offset:15360
    buffer_load_dwordx4 a[248:251], v17, s[28:31], s57 offen offset:2048 sc1
    v_mfma_f32_32x32x16_bf16 v[80:95], a[84:87], a[212:215], v[80:95]
    buffer_load_dwordx4 a[252:255], v16, s[28:31], s57 offen offset:3072 sc1
    v_cos_f32_e64 v214, v210
    v_cos_f32 v215, v211
    v_mfma_f32_32x32x16_bf16 v[112:127], a[84:87], a[216:219], v[112:127]
    s_waitcnt lgkmcnt(2)
    buffer_load_dwordx4 a[176:179], v17, s[28:31], s57 offen offset:3072 sc1
    v_sin_f32_e64 v208, -v208
    v_mfma_f32_32x32x16_bf16 v[64:79], a[88:91], a[220:223], v[64:79]
    s_lshl_b32 s57, s88, 12
    s_add_u32 s57, s57, s91
    ds_read_b64_tr_b16 a[64:65], v8 offset:28672
    ds_read_b64_tr_b16 a[66:67], v8 offset:29696
    buffer_load_dwordx4 a[180:183], v16, s[28:31], s57 offen sc1
    v_mfma_f32_32x32x16_bf16 v[96:111], a[88:91], a[224:227], v[96:111]
    s_waitcnt lgkmcnt(2)
    ds_read_b64_tr_b16 a[68:69], v9 offset:28672
    ds_read_b64_tr_b16 a[70:71], v9 offset:29696
    buffer_load_dwordx4 a[184:187], v17, s[28:31], s57 offen sc1
    v_sin_f32_e64 v209, -v209
    v_mfma_f32_32x32x16_bf16 v[80:95], a[92:95], a[220:223], v[80:95]
    buffer_load_dwordx4 a[188:191], v16, s[28:31], s57 offen offset:1024 sc1
    v_sin_f32_e64 v210, -v210
    v_sin_f32_e64 v211, -v211
    v_mfma_f32_32x32x16_bf16 v[112:127], a[92:95], a[224:227], v[112:127]
    s_waitcnt vmcnt(9) lgkmcnt(2)
    buffer_load_dwordx4 a[192:195], v17, s[28:31], s57 offen offset:1024 sc1
    v_cvt_pk_bf16_f32 v172, v212, v213
    v_cvt_pk_bf16_f32 v173, v214, v215
    v_cvt_pk_bf16_f32 v174, v208, v209
    v_cvt_pk_bf16_f32 v175, v210, v211
    v_mfma_f32_32x32x16_bf16 v[64:79], a[64:67], a[228:231], v[64:79]
    ds_read_b64_tr_b16 a[72:73], v8 offset:30720
    ds_read_b64_tr_b16 a[74:75], v8 offset:31744
    s_add_u32 s26, s80, 3
    s_and_b32 s26, s26, 3
    s_cselect_b64 s[24:25], 0, -1
    s_lshl_b32 s26, s26, 4
    v_mfma_f32_32x32x16_bf16 v[96:111], a[64:67], a[232:235], v[96:111]
    s_waitcnt lgkmcnt(2)
    ds_read_b64_tr_b16 a[76:77], v9 offset:30720
    ds_read_b64_tr_b16 a[78:79], v9 offset:31744
    buffer_load_dwordx4 a[96:99], v16, s[28:31], s57 offen offset:2048 sc1
    v_mfma_f32_32x32x16_bf16 v[80:95], a[68:71], a[228:231], v[80:95]
    buffer_load_dwordx4 a[100:103], v17, s[28:31], s57 offen offset:2048 sc1
    v_cvt_f32_u32_e64 v199, s26
    v_fma_f32 v198, v199, v192, v194
    v_fma_f32 v199, v199, v193, v195
    v_mfma_f32_32x32x16_bf16 v[112:127], a[68:71], a[232:235], v[112:127]
    s_waitcnt vmcnt(10) lgkmcnt(2)
    buffer_load_dwordx4 a[104:107], v16, s[28:31], s57 offen offset:3072 sc1
    v_cndmask_b32 v200, v198, v196, s[24:25]
    v_fmamk_f32 v201, v192, 0x3f800000, v198
    v_mfma_f32_32x32x16_bf16 v[64:79], a[72:75], a[236:239], v[64:79]
    ds_read_b64_tr_b16 a[80:81], v8
    ds_read_b64_tr_b16 a[82:83], v8 offset:1024
    v_fmamk_f32 v202, v192, 0x40000000, v198
    v_fmamk_f32 v203, v192, 0x40400000, v198
    v_cos_f32 v204, v200
    v_mfma_f32_32x32x16_bf16 v[96:111], a[72:75], a[240:243], v[96:111]
    s_waitcnt lgkmcnt(2)
    ds_read_b64_tr_b16 a[84:85], v9
    ds_read_b64_tr_b16 a[86:87], v9 offset:1024
    buffer_load_dwordx4 a[108:111], v17, s[28:31], s57 offen offset:3072 sc1
    v_cos_f32_e64 v205, v201
    v_mfma_f32_32x32x16_bf16 v[80:95], a[76:79], a[236:239], v[80:95]
    s_lshl_b32 s57, s89, 12
    s_add_u32 s57, s57, s91
    buffer_load_dwordx4 a[112:115], v16, s[28:31], s57 offen sc1
    v_mfma_f32_32x32x16_bf16 v[112:127], a[76:79], a[240:243], v[112:127]
    s_waitcnt vmcnt(11) lgkmcnt(2)
    buffer_load_dwordx4 a[116:119], v17, s[28:31], s57 offen sc1
    v_cos_f32 v206, v202
    v_cos_f32_e64 v207, v203
    v_mfma_f32_32x32x16_bf16 v[64:79], a[80:83], a[244:247], v[64:79]
    ds_read_b64_tr_b16 a[88:89], v8 offset:2048
    ds_read_b64_tr_b16 a[90:91], v8 offset:3072
    v_sin_f32_e64 v200, -v200
    v_sin_f32_e64 v201, -v201
    v_mfma_f32_32x32x16_bf16 v[96:111], a[80:83], a[248:251], v[96:111]
    s_waitcnt lgkmcnt(2)
    ds_read_b64_tr_b16 a[92:93], v9 offset:2048
    ds_read_b64_tr_b16 a[94:95], v9 offset:3072
    buffer_load_dwordx4 a[120:123], v16, s[28:31], s57 offen offset:1024 sc1
    v_mfma_f32_32x32x16_bf16 v[80:95], a[84:87], a[244:247], v[80:95]
    buffer_load_dwordx4 a[124:127], v17, s[28:31], s57 offen offset:1024 sc1
    v_sin_f32_e64 v202, -v202
    v_mfma_f32_32x32x16_bf16 v[112:127], a[84:87], a[248:251], v[112:127]
    s_waitcnt vmcnt(12) lgkmcnt(2)
    buffer_load_dwordx4 a[128:131], v16, s[28:31], s57 offen offset:2048 sc1
    v_sin_f32_e64 v203, -v203
    v_cvt_pk_bf16_f32 v176, v204, v205
    v_mfma_f32_32x32x16_bf16 v[64:79], a[88:91], a[252:255], v[64:79]
    ds_read_b64_tr_b16 a[64:65], v8 offset:32768
    ds_read_b64_tr_b16 a[66:67], v8 offset:33792
    v_cvt_pk_bf16_f32 v177, v206, v207
    v_cvt_pk_bf16_f32 v178, v200, v201
    v_cvt_pk_bf16_f32 v179, v202, v203
    v_mfma_f32_32x32x16_bf16 v[96:111], a[88:91], a[176:179], v[96:111]
    s_waitcnt lgkmcnt(2)
    ds_read_b64_tr_b16 a[68:69], v9 offset:32768
    ds_read_b64_tr_b16 a[70:71], v9 offset:33792
    buffer_load_dword v25, v24, s[28:31], s27 offen sc1
    v_cndmask_b32 v208, v199, v197, s[24:25]
    v_mfma_f32_32x32x16_bf16 v[80:95], a[92:95], a[252:255], v[80:95]
    buffer_load_dwordx4 a[132:135], v17, s[28:31], s57 offen offset:2048 sc1
    v_fmamk_f32 v209, v193, 0x3f800000, v199
    v_fmamk_f32 v210, v193, 0x40000000, v199
    v_fmamk_f32 v211, v193, 0x40400000, v199
    v_mfma_f32_32x32x16_bf16 v[112:127], a[92:95], a[176:179], v[112:127]
    s_waitcnt vmcnt(13) lgkmcnt(2)
    buffer_load_dwordx4 a[136:139], v16, s[28:31], s57 offen offset:3072 sc1
    v_cos_f32_e64 v212, v208
    v_mfma_f32_32x32x16_bf16 v[64:79], a[64:67], a[180:183], v[64:79]
    ds_read_b64_tr_b16 a[72:73], v8 offset:34816
    ds_read_b64_tr_b16 a[74:75], v8 offset:35840
    buffer_load_dwordx4 a[140:143], v17, s[28:31], s57 offen offset:3072 sc1
    v_cos_f32 v213, v209
    v_mfma_f32_32x32x16_bf16 v[96:111], a[64:67], a[184:187], v[96:111]
    s_waitcnt lgkmcnt(2)
    s_lshl_b32 s57, s90, 12
    s_add_u32 s57, s57, s91
    ds_read_b64_tr_b16 a[76:77], v9 offset:34816
    ds_read_b64_tr_b16 a[78:79], v9 offset:35840
    buffer_load_dwordx4 a[144:147], v16, s[28:31], s57 offen sc1
    v_mfma_f32_32x32x16_bf16 v[80:95], a[68:71], a[180:183], v[80:95]
    buffer_load_dwordx4 a[148:151], v17, s[28:31], s57 offen sc1
    v_cos_f32_e64 v214, v210
    v_cos_f32 v215, v211
    v_mfma_f32_32x32x16_bf16 v[112:127], a[68:71], a[184:187], v[112:127]
    s_waitcnt vmcnt(15) lgkmcnt(2)
    buffer_load_dwordx4 a[152:155], v16, s[28:31], s57 offen offset:1024 sc1
    v_sin_f32_e64 v208, -v208
    v_sin_f32_e64 v209, -v209
    v_mfma_f32_32x32x16_bf16 v[64:79], a[72:75], a[188:191], v[64:79]
    ds_read_b64_tr_b16 a[80:81], v8 offset:16384
    ds_read_b64_tr_b16 a[82:83], v8 offset:17408
    v_sin_f32_e64 v210, -v210
    v_sin_f32_e64 v211, -v211
    v_mfma_f32_32x32x16_bf16 v[96:111], a[72:75], a[192:195], v[96:111]
    s_waitcnt lgkmcnt(2)
    ds_read_b64_tr_b16 a[84:85], v9 offset:16384
    ds_read_b64_tr_b16 a[86:87], v9 offset:17408
    buffer_load_dwordx4 a[156:159], v17, s[28:31], s57 offen offset:1024 sc1
    v_mfma_f32_32x32x16_bf16 v[80:95], a[76:79], a[188:191], v[80:95]
    buffer_load_dwordx4 a[160:163], v16, s[28:31], s57 offen offset:2048 sc1
    v_cvt_pk_bf16_f32 v180, v212, v213
    v_cvt_pk_bf16_f32 v181, v214, v215
    v_cvt_pk_bf16_f32 v182, v208, v209
    v_mfma_f32_32x32x16_bf16 v[112:127], a[76:79], a[192:195], v[112:127]
    s_waitcnt vmcnt(16) lgkmcnt(2)
    buffer_load_dwordx4 a[164:167], v17, s[28:31], s57 offen offset:2048 sc1
    v_cvt_pk_bf16_f32 v183, v210, v211
    v_fmamk_f32 v200, v192, 0x41000000, v198
    v_mfma_f32_32x32x16_bf16 v[64:79], a[80:83], a[96:99], v[64:79]
    ds_read_b64_tr_b16 a[88:89], v8 offset:18432
    ds_read_b64_tr_b16 a[90:91], v8 offset:19456
    s_waitcnt vmcnt(9)
    v_cmp_gt_u32 vcc, s23, v25
    v_mfma_f32_32x32x16_bf16 v[96:111], a[80:83], a[100:103], v[96:111]
    s_waitcnt lgkmcnt(2)
    ds_read_b64_tr_b16 a[92:93], v9 offset:18432
    ds_read_b64_tr_b16 a[94:95], v9 offset:19456
    buffer_load_dwordx4 a[168:171], v16, s[28:31], s57 offen offset:3072 sc1
    s_cbranch_vccnz L_slow_zf_5
L_ret_zf_5:
    v_fmamk_f32 v201, v192, 0x41100000, v198
    v_fmamk_f32 v202, v192, 0x41200000, v198
    v_fmamk_f32 v203, v192, 0x41300000, v198
    v_cos_f32_e64 v204, v200
    v_mfma_f32_32x32x16_bf16 v[80:95], a[84:87], a[96:99], v[80:95]
    buffer_load_dwordx4 a[172:175], v17, s[28:31], s57 offen offset:3072 sc1
    v_cos_f32_e64 v205, v201
    v_cos_f32 v206, v202
    v_mfma_f32_32x32x16_bf16 v[112:127], a[84:87], a[100:103], v[112:127]
    s_waitcnt lgkmcnt(2)
    s_add_u32 m0, s53, 8192
    s_lshl_b32 s55, s90, 16
    s_add_u32 s55, s55, 32768
    buffer_load_dwordx4 v20, s[16:19], s55 offen lds
    v_mfma_f32_32x32x16_bf16 v[64:79], a[88:91], a[104:107], v[64:79]
    s_barrier
    ds_read_b64_tr_b16 a[64:65], v8 offset:20480
    ds_read_b64_tr_b16 a[66:67], v8 offset:21504
    v_cos_f32_e64 v207, v203
    v_mfma_f32_32x32x16_bf16 v[96:111], a[88:91], a[108:111], v[96:111]
    s_waitcnt lgkmcnt(2)
    ds_read_b64_tr_b16 a[68:69], v9 offset:20480
    ds_read_b64_tr_b16 a[70:71], v9 offset:21504
    buffer_load_dwordx4 v21, s[16:19], s55 offen offset:1024 lds
    v_sin_f32_e64 v200, -v200
    v_mfma_f32_32x32x16_bf16 v[80:95], a[92:95], a[104:107], v[80:95]
    buffer_load_dwordx4 v22, s[16:19], s55 offen offset:2048 lds
    v_sin_f32_e64 v201, -v201
    v_sin_f32_e64 v202, -v202
    v_mfma_f32_32x32x16_bf16 v[112:127], a[92:95], a[108:111], v[112:127]
    s_waitcnt lgkmcnt(2)
    buffer_load_dwordx4 v23, s[16:19], s55 offen offset:3072 lds
    v_sin_f32_e64 v203, -v203
    v_mfma_f32_32x32x16_bf16 v[64:79], a[64:67], a[112:115], v[64:79]
    ds_read_b64_tr_b16 a[72:73], v8 offset:22528
    ds_read_b64_tr_b16 a[74:75], v8 offset:23552
    v_cvt_pk_bf16_f32 v184, v204, v205
    v_cvt_pk_bf16_f32 v185, v206, v207
    v_cvt_pk_bf16_f32 v186, v200, v201
    v_mfma_f32_32x32x16_bf16 v[96:111], a[64:67], a[116:119], v[96:111]
    s_waitcnt lgkmcnt(2)
    s_add_u32 m0, s53, 12288
    s_add_u32 s55, s80, 0
    s_and_b32 s55, s55, 3
    s_mul_i32 s55, s55, 135168
    s_add_u32 s55, s55, s93
    ds_read_b64_tr_b16 a[76:77], v9 offset:22528
    ds_read_b64_tr_b16 a[78:79], v9 offset:23552
    buffer_load_dwordx4 v12, s[28:31], s55 offen sc1 lds
    v_mfma_f32_32x32x16_bf16 v[80:95], a[68:71], a[112:115], v[80:95]
    v_cvt_pk_bf16_f32 v187, v202, v203
    v_fmamk_f32 v208, v193, 0x41000000, v199
    v_fmamk_f32 v209, v193, 0x41100000, v199
    v_fmamk_f32 v210, v193, 0x41200000, v199
    v_fmamk_f32 v211, v193, 0x41300000, v199
    v_mfma_f32_32x32x16_bf16 v[112:127], a[68:71], a[116:119], v[112:127]
    s_waitcnt lgkmcnt(2)
    buffer_load_dwordx4 v13, s[28:31], s55 offen offset:1024 sc1 lds
    v_cos_f32 v212, v208
    v_mfma_f32_32x32x16_bf16 v[64:79], a[72:75], a[120:123], v[64:79]
    ds_read_b64_tr_b16 a[80:81], v8 offset:24576
    ds_read_b64_tr_b16 a[82:83], v8 offset:25600
    v_cos_f32 v213, v209
    v_mfma_f32_32x32x16_bf16 v[96:111], a[72:75], a[124:127], v[96:111]
    s_waitcnt lgkmcnt(2)
    ds_read_b64_tr_b16 a[84:85], v9 offset:24576
    ds_read_b64_tr_b16 a[86:87], v9 offset:25600
    buffer_load_dwordx4 v14, s[28:31], s55 offen offset:2048 sc1 lds
    v_mfma_f32_32x32x16_bf16 v[80:95], a[76:79], a[120:123], v[80:95]
    v_cos_f32_e64 v214, v210
    v_cos_f32 v215, v211
    v_mfma_f32_32x32x16_bf16 v[112:127], a[76:79], a[124:127], v[112:127]
    s_waitcnt vmcnt(17) lgkmcnt(2)
    buffer_load_dwordx4 v15, s[28:31], s55 offen offset:3072 sc1 lds
    v_sin_f32_e64 v208, -v208
    v_mfma_f32_32x32x16_bf16 v[64:79], a[80:83], a[128:131], v[64:79]
    ds_read_b64_tr_b16 a[88:89], v8 offset:26624
    ds_read_b64_tr_b16 a[90:91], v8 offset:27648
    v_sin_f32_e64 v209, -v209
    v_sin_f32_e64 v210, -v210
    v_sin_f32_e64 v211, -v211
    v_cvt_pk_bf16_f32 v188, v212, v213
    v_mfma_f32_32x32x16_bf16 v[96:111], a[80:83], a[132:135], v[96:111]
    s_waitcnt lgkmcnt(2)
    s_add_u32 m0, s53, 28672
    s_add_u32 s55, s80, 1
    s_and_b32 s55, s55, 3
    s_mul_i32 s55, s55, 135168
    s_add_u32 s55, s55, s93
    ds_read_b64_tr_b16 a[92:93], v9 offset:26624
    ds_read_b64_tr_b16 a[94:95], v9 offset:27648
    buffer_load_dwordx4 v12, s[28:31], s55 offen sc1 lds
    v_mfma_f32_32x32x16_bf16 v[80:95], a[84:87], a[128:131], v[80:95]
    ds_read_b64_tr_b16 a[68:69], v9 offset:4096
    ds_read_b64_tr_b16 a[70:71], v9 offset:5120
    v_cvt_pk_bf16_f32 v189, v214, v215
    v_cvt_pk_bf16_f32 v190, v208, v209
    v_cvt_pk_bf16_f32 v191, v210, v211
    v_add_u32_e64 v33, s53, v2
    v_mfma_f32_32x32x16_bf16 v[112:127], a[84:87], a[132:135], v[112:127]
    s_waitcnt vmcnt(17) lgkmcnt(4)
    buffer_load_dwordx4 v13, s[28:31], s55 offen offset:1024 sc1 lds
    s_xor_b32 s56, s52, 1
    s_mul_i32 s56, s56, 40960
    v_add_u32_e64 v60, s56, v2
    v_mfma_f32_32x32x16_bf16 v[64:79], a[88:91], a[136:139], v[64:79]
    ds_read_b64_tr_b16 a[76:77], v9 offset:6144
    ds_read_b64_tr_b16 a[78:79], v9 offset:7168
    s_xor_b32 s56, s52, 2
    s_mul_i32 s56, s56, 40960
    v_add_u32 v61, s56, v2
    s_xor_b32 s56, s52, 3
    s_mul_i32 s56, s56, 40960
    v_add_u32 v62, s56, v2
    v_mfma_f32_32x32x16_bf16 v[96:111], a[88:91], a[140:143], v[96:111]
    s_waitcnt lgkmcnt(4)
    buffer_load_dwordx4 v14, s[28:31], s55 offen offset:2048 sc1 lds
    v_mfma_f32_32x32x16_bf16 v[80:95], a[92:95], a[136:139], v[80:95]
    s_waitcnt vmcnt(7)
    ds_read_b64_tr_b16 a[84:85], v9 offset:8192
    ds_read_b64_tr_b16 a[86:87], v9 offset:9216
    v_mfma_f32_32x32x16_bf16 v[112:127], a[92:95], a[140:143], v[112:127]
    s_waitcnt lgkmcnt(4)
    buffer_load_dwordx4 v15, s[28:31], s55 offen offset:3072 sc1 lds
    v_mfma_f32_32x32x16_bf16 v[80:95], a[68:71], a[144:147], v[80:95]
    s_waitcnt lgkmcnt(2)
    s_add_u32 m0, s53, 0
    s_add_u32 s55, s80, 2
    s_and_b32 s55, s55, 3
    s_mul_i32 s55, s55, 135168
    s_add_u32 s55, s55, s93
    ds_read_b64_tr_b16 a[92:93], v9 offset:10240
    ds_read_b64_tr_b16 a[94:95], v9 offset:11264
    buffer_load_dwordx4 v12, s[28:31], s55 offen sc1 lds
    v_mfma_f32_32x32x16_bf16 v[80:95], a[76:79], a[152:155], v[80:95]
    s_waitcnt lgkmcnt(2)
    ds_read_b64_tr_b16 a[64:65], v8 offset:4096
    ds_read_b64_tr_b16 a[66:67], v8 offset:5120
    v_mfma_f32_32x32x16_bf16 v[80:95], a[84:87], a[160:163], v[80:95]
    s_waitcnt lgkmcnt(2)
    ds_read_b64_tr_b16 a[72:73], v8 offset:6144
    ds_read_b64_tr_b16 a[74:75], v8 offset:7168
    buffer_load_dwordx4 v13, s[28:31], s55 offen offset:1024 sc1 lds
    v_mfma_f32_32x32x16_bf16 v[80:95], a[92:95], a[168:171], v[80:95]
    ds_read_b64_tr_b16 a[80:81], v8 offset:8192
    ds_read_b64_tr_b16 a[82:83], v8 offset:9216
    v_mfma_f32_32x32x16_bf16 v[112:127], a[68:71], a[148:151], v[112:127]
    ds_read_b64_tr_b16 a[88:89], v8 offset:10240
    ds_read_b64_tr_b16 a[90:91], v8 offset:11264
    buffer_load_dwordx4 v14, s[28:31], s55 offen offset:2048 sc1 lds
    v_mfma_f32_32x32x16_bf16 v[112:127], a[76:79], a[156:159], v[112:127]
    v_mfma_f32_32x32x16_bf16 v[112:127], a[84:87], a[164:167], v[112:127]
    s_nop 3
    ds_write_b128 v33, v[80:83] offset:16384
    buffer_load_dwordx4 v15, s[28:31], s55 offen offset:3072 sc1 lds
    v_mfma_f32_32x32x16_bf16 v[112:127], a[92:95], a[172:175], v[112:127]
    s_waitcnt lgkmcnt(7)
    ds_write_b128 v33, v[84:87] offset:17408
    v_mfma_f32_32x32x16_bf16 v[96:111], a[64:67], a[148:151], v[96:111]
    s_waitcnt lgkmcnt(6)
    s_add_u32 m0, s53, 32768
    s_add_u32 s55, s80, 3
    s_and_b32 s55, s55, 3
    s_mul_i32 s55, s55, 135168
    s_add_u32 s55, s55, s93
    ds_write_b128 v33, v[88:91] offset:18432
    buffer_load_dwordx4 v12, s[28:31], s55 offen sc1 lds
    v_mfma_f32_32x32x16_bf16 v[96:111], a[72:75], a[156:159], v[96:111]
    s_waitcnt lgkmcnt(5)
    ds_write_b128 v33, v[92:95] offset:19456
    v_mfma_f32_32x32x16_bf16 v[96:111], a[80:83], a[164:167], v[96:111]
    s_waitcnt lgkmcnt(4)
    ds_write_b128 v33, v[112:115] offset:24576
    buffer_load_dwordx4 v13, s[28:31], s55 offen offset:1024 sc1 lds
    v_mfma_f32_32x32x16_bf16 v[96:111], a[88:91], a[172:175], v[96:111]
    ds_write_b128 v33, v[116:119] offset:25600
    s_waitcnt vmcnt(10)
    ds_read_b64_tr_b16 a[0:1], v10 offset:12288
    ds_read_b64_tr_b16 a[2:3], v10 offset:12296
    v_mfma_f32_32x32x16_bf16 v[64:79], a[64:67], a[144:147], v[64:79]
    ds_write_b128 v33, v[120:123] offset:26624
    ds_read_b64_tr_b16 a[4:5], v11 offset:12288
    ds_read_b64_tr_b16 a[6:7], v11 offset:12296
    buffer_load_dwordx4 v14, s[28:31], s55 offen offset:2048 sc1 lds
    v_mfma_f32_32x32x16_bf16 v[64:79], a[72:75], a[152:155], v[64:79]
    ds_write_b128 v33, v[124:127] offset:27648
    v_mfma_f32_32x32x16_bf16 v[64:79], a[80:83], a[160:163], v[64:79]
    s_nop 0
    ds_write_b128 v33, v[96:99] offset:20480
    buffer_load_dwordx4 v15, s[28:31], s55 offen offset:3072 sc1 lds
    v_mfma_f32_32x32x16_bf16 v[64:79], a[88:91], a[168:171], v[64:79]
    s_waitcnt lgkmcnt(5)
    ds_write_b128 v33, v[100:103] offset:21504
    v_mfma_f32_32x32x16_bf16 v[192:207], v[128:131], a[0:3], 0
    ds_read_b64_tr_b16 a[8:9], v10 offset:14336
    ds_read_b64_tr_b16 a[10:11], v10 offset:14344
    ds_write_b128 v33, v[104:107] offset:22528
    v_mfma_f32_32x32x16_bf16 v[208:223], v[132:135], a[0:3], 0
    s_waitcnt lgkmcnt(6)
    ds_read_b64_tr_b16 a[12:13], v11 offset:14336
    ds_read_b64_tr_b16 a[14:15], v11 offset:14344
    ds_write_b128 v33, v[108:111] offset:23552
    v_mfma_f32_32x32x16_bf16 v[224:239], v[128:131], a[4:7], 0
    v_mfma_f32_32x32x16_bf16 v[240:255], v[132:135], a[4:7], 0
    s_waitcnt lgkmcnt(4)
    s_waitcnt lgkmcnt(0)
    s_barrier
    ds_read_b128 v[80:83], v60 offset:16384
    ds_read_b128 v[84:87], v60 offset:17408
    v_mfma_f32_32x32x16_bf16 v[192:207], v[136:139], a[8:11], v[192:207]
    s_waitcnt vmcnt(8)
    ds_read_b64_tr_b16 a[16:17], v10 offset:28672
    ds_read_b64_tr_b16 a[18:19], v10 offset:28680
    ds_read_b128 v[88:91], v60 offset:18432
    ds_read_b128 v[92:95], v60 offset:19456
    v_mfma_f32_32x32x16_bf16 v[208:223], v[140:143], a[8:11], v[208:223]
    ds_read_b64_tr_b16 a[20:21], v11 offset:28672
    ds_read_b64_tr_b16 a[22:23], v11 offset:28680
    ds_read_b128 v[96:99], v61 offset:20480
    ds_read_b128 v[100:103], v61 offset:21504
    v_mfma_f32_32x32x16_bf16 v[224:239], v[136:139], a[12:15], v[224:239]
    ds_read_b128 v[104:107], v61 offset:22528
    ds_read_b128 v[108:111], v61 offset:23552
    ds_read_b128 v[112:115], v62 offset:24576
    v_mfma_f32_32x32x16_bf16 v[240:255], v[140:143], a[12:15], v[240:255]
    s_waitcnt lgkmcnt(9)
    ds_read_b128 v[116:119], v62 offset:25600
    ds_read_b128 v[120:123], v62 offset:26624
    ds_read_b128 v[124:127], v62 offset:27648
    v_mfma_f32_32x32x16_bf16 v[192:207], v[144:147], a[16:19], v[192:207]
    ds_read_b64_tr_b16 a[24:25], v10 offset:30720
    ds_read_b64_tr_b16 a[26:27], v10 offset:30728
    s_waitcnt lgkmcnt(12)
    v_add_f32 v64, v64, v80
    v_add_f32 v65, v65, v81
    v_add_f32_e64 v66, v66, v82
    v_add_f32 v67, v67, v83
    v_mfma_f32_32x32x16_bf16 v[208:223], v[148:151], a[16:19], v[208:223]
    s_waitcnt lgkmcnt(10)
    ds_read_b64_tr_b16 a[28:29], v11 offset:30720
    ds_read_b64_tr_b16 a[30:31], v11 offset:30728
    ds_read_b128 v[36:39], v28
    ds_read_b128 v[40:43], v29
    v_add_f32 v68, v68, v84
    v_add_f32 v69, v69, v85
    v_add_f32 v70, v70, v86
    v_mfma_f32_32x32x16_bf16 v[224:239], v[144:147], a[20:23], v[224:239]
    s_waitcnt vmcnt(4)
    ds_read_b64_tr_b16 a[4:5], v11
    ds_read_b64_tr_b16 a[6:7], v11 offset:8
    v_add_f32 v71, v71, v87
    v_add_f32 v72, v72, v88
    v_add_f32 v73, v73, v89
    v_add_f32 v74, v74, v90
    v_mfma_f32_32x32x16_bf16 v[240:255], v[148:151], a[20:23], v[240:255]
    s_waitcnt lgkmcnt(6)
    v_add_f32 v75, v75, v91
    v_add_f32 v76, v76, v92
    v_add_f32 v77, v77, v93
    v_add_f32 v78, v78, v94
    v_add_f32 v79, v79, v95
    v_mfma_f32_32x32x16_bf16 v[192:207], v[152:155], a[24:27], v[192:207]
    ds_read_b64_tr_b16 a[12:13], v11 offset:2048
    ds_read_b64_tr_b16 a[14:15], v11 offset:2056
    v_add_f32 v64, v64, v96
    v_add_f32 v65, v65, v97
    v_add_f32 v66, v66, v98
    v_add_f32 v67, v67, v99
    v_mfma_f32_32x32x16_bf16 v[208:223], v[156:159], a[24:27], v[208:223]
    s_waitcnt lgkmcnt(6)
    v_add_f32 v68, v68, v100
    v_add_f32 v69, v69, v101
    v_add_f32 v70, v70, v102
    v_add_f32_e64 v71, v71, v103
    v_add_f32 v72, v72, v104
    v_mfma_f32_32x32x16_bf16 v[224:239], v[152:155], a[28:31], v[224:239]
    s_waitcnt vmcnt(0)
    ds_read_b64_tr_b16 a[20:21], v11 offset:32768
    ds_read_b64_tr_b16 a[22:23], v11 offset:32776
    v_add_f32 v73, v73, v105
    v_add_f32 v74, v74, v106
    v_add_f32 v75, v75, v107
    v_add_f32 v76, v76, v108
    v_mfma_f32_32x32x16_bf16 v[240:255], v[156:159], a[28:31], v[240:255]
    s_waitcnt lgkmcnt(4)
    v_add_f32 v77, v77, v109
    v_add_f32_e64 v78, v78, v110
    v_add_f32 v79, v79, v111
    v_mfma_f32_32x32x16_bf16 v[224:239], v[160:163], a[4:7], v[224:239]
    s_waitcnt lgkmcnt(2)
    ds_read_b64_tr_b16 a[28:29], v11 offset:34816
    ds_read_b64_tr_b16 a[30:31], v11 offset:34824
    v_add_f32 v64, v64, v112
    v_add_f32 v65, v65, v113
    v_add_f32_e64 v66, v66, v114
    v_add_f32 v67, v67, v115
    v_mfma_f32_32x32x16_bf16 v[224:239], v[168:171], a[12:15], v[224:239]
    s_waitcnt lgkmcnt(2)
    ds_read_b64_tr_b16 a[0:1], v10
    ds_read_b64_tr_b16 a[2:3], v10 offset:8
    v_add_f32 v68, v68, v116
    v_add_f32 v69, v69, v117
    v_add_f32_e64 v70, v70, v118
    v_add_f32 v71, v71, v119
    v_mfma_f32_32x32x16_bf16 v[224:239], v[176:179], a[20:23], v[224:239]
    s_waitcnt lgkmcnt(2)
    ds_read_b64_tr_b16 a[8:9], v10 offset:2048
    ds_read_b64_tr_b16 a[10:11], v10 offset:2056
    v_add_f32 v72, v72, v120
    v_add_f32 v73, v73, v121
    v_add_f32_e64 v74, v74, v122
    v_mfma_f32_32x32x16_bf16 v[224:239], v[184:187], a[28:31], v[224:239]
    ds_read_b64_tr_b16 a[16:17], v10 offset:32768
    ds_read_b64_tr_b16 a[18:19], v10 offset:32776
    v_add_f32 v75, v75, v123
    v_add_f32 v76, v76, v124
    v_add_f32 v77, v77, v125
    v_add_f32 v78, v78, v126
    v_mfma_f32_32x32x16_bf16 v[240:255], v[164:167], a[4:7], v[240:255]
    ds_read_b64_tr_b16 a[24:25], v10 offset:34816
    ds_read_b64_tr_b16 a[26:27], v10 offset:34824
    v_add_f32_e64 v79, v79, v127
    v_mul_f32 v44, 0xbfb8aa3b, v64
    v_mul_f32 v45, 0xbfb8aa3b, v65
    v_mul_f32 v46, 0xbfb8aa3b, v66
    v_mfma_f32_32x32x16_bf16 v[240:255], v[172:175], a[12:15], v[240:255]
    v_mul_f32 v47, 0xbfb8aa3b, v67
    v_mul_f32 v48, 0xbfb8aa3b, v68
    v_mul_f32 v49, 0xbfb8aa3b, v69
    v_mul_f32 v50, 0xbfb8aa3b, v70
    v_mul_f32 v51, 0xbfb8aa3b, v71
    v_mfma_f32_32x32x16_bf16 v[240:255], v[180:183], a[20:23], v[240:255]
    ds_write_b128 v33, v[224:227] offset:8192
    v_exp_f32 v44, v44
    v_exp_f32 v45, v45
    v_exp_f32 v46, v46
    v_mfma_f32_32x32x16_bf16 v[240:255], v[188:191], a[28:31], v[240:255]
    s_waitcnt lgkmcnt(7)
    ds_write_b128 v33, v[228:231] offset:9216
    v_exp_f32_e64 v47, v47
    v_exp_f32 v48, v48
    v_mfma_f32_32x32x16_bf16 v[208:223], v[164:167], a[0:3], v[208:223]
    s_waitcnt lgkmcnt(6)
    ds_write_b128 v33, v[232:235] offset:10240
    v_exp_f32_e64 v49, v49
    v_exp_f32 v50, v50
    v_mfma_f32_32x32x16_bf16 v[208:223], v[172:175], a[8:11], v[208:223]
    s_waitcnt lgkmcnt(5)
    ds_write_b128 v33, v[236:239] offset:11264
    v_exp_f32 v51, v51
    v_add_f32 v44, 1.0, v44
    v_add_f32 v45, 1.0, v45
    v_add_f32 v46, 1.0, v46
    v_add_f32 v47, 1.0, v47
    v_mfma_f32_32x32x16_bf16 v[208:223], v[180:183], a[16:19], v[208:223]
    s_waitcnt lgkmcnt(4)
    ds_write_b128 v33, v[240:243] offset:12288
    v_add_f32 v48, 1.0, v48
    v_add_f32 v49, 1.0, v49
    v_add_f32 v50, 1.0, v50
    v_add_f32 v51, 1.0, v51
    v_mfma_f32_32x32x16_bf16 v[208:223], v[188:191], a[24:27], v[208:223]
    ds_write_b128 v33, v[244:247] offset:13312
    v_rcp_f32 v44, v44
    v_rcp_f32 v45, v45
    v_rcp_f32_e64 v46, v46
    v_mfma_f32_32x32x16_bf16 v[192:207], v[160:163], a[0:3], v[192:207]
    ds_write_b128 v33, v[248:251] offset:14336
    v_rcp_f32 v47, v47
    v_rcp_f32 v48, v48
    v_mfma_f32_32x32x16_bf16 v[192:207], v[168:171], a[8:11], v[192:207]
    ds_write_b128 v33, v[252:255] offset:15360
    v_rcp_f32 v49, v49
    v_rcp_f32 v50, v50
    v_mfma_f32_32x32x16_bf16 v[192:207], v[176:179], a[16:19], v[192:207]
    ds_write_b128 v33, v[208:211] offset:4096
    v_rcp_f32 v51, v51
    v_mul_f32 v64, v64, v44
    v_mul_f32 v65, v65, v45
    v_mul_f32 v66, v66, v46
    v_mfma_f32_32x32x16_bf16 v[192:207], v[184:187], a[24:27], v[192:207]
    ds_write_b128 v33, v[212:215] offset:5120
    v_mul_f32 v67, v67, v47
    v_mul_f32 v68, v68, v48
    v_mul_f32 v69, v69, v49
    v_mul_f32 v70, v70, v50
    v_mul_f32_e64 v71, v71, v51
    v_mul_f32 v52, 0xbfb8aa3b, v72
    v_mul_f32 v53, 0xbfb8aa3b, v73
    v_mul_f32 v54, 0xbfb8aa3b, v74
    v_mul_f32 v55, 0xbfb8aa3b, v75
    v_mul_f32 v56, 0xbfb8aa3b, v76
    v_mul_f32 v57, 0xbfb8aa3b, v77
    v_mul_f32 v58, 0xbfb8aa3b, v78
    v_mul_f32 v59, 0xbfb8aa3b, v79
    v_exp_f32 v52, v52
    v_exp_f32 v53, v53
    v_exp_f32 v54, v54
    v_exp_f32 v55, v55
    v_exp_f32 v56, v56
    v_exp_f32 v57, v57
    v_exp_f32 v58, v58
    v_exp_f32 v59, v59
    v_add_f32 v52, 1.0, v52
    v_add_f32 v53, 1.0, v53
    v_add_f32 v54, 1.0, v54
    v_add_f32 v55, 1.0, v55
    v_add_f32 v56, 1.0, v56
    v_add_f32 v57, 1.0, v57
    v_add_f32 v58, 1.0, v58
    v_add_f32 v59, 1.0, v59
    v_rcp_f32 v52, v52
    v_rcp_f32 v53, v53
    ds_write_b128 v33, v[216:219] offset:6144
    ds_write_b128 v33, v[220:223] offset:7168
    v_rcp_f32 v54, v54
    v_rcp_f32 v55, v55
    v_rcp_f32 v56, v56
    v_rcp_f32 v57, v57
    v_rcp_f32 v58, v58
    v_rcp_f32 v59, v59
    v_mul_f32 v72, v72, v52
    v_mul_f32 v73, v73, v53
    v_mul_f32 v74, v74, v54
    v_mul_f32 v75, v75, v55
    v_mul_f32 v76, v76, v56
    v_mul_f32 v77, v77, v57
    v_mul_f32 v78, v78, v58
    v_mul_f32 v79, v79, v59
    v_lshlrev_b32 v44, 16, v36
    v_and_b32 v45, s82, v36
    v_lshlrev_b32 v46, 16, v37
    v_and_b32 v47, s82, v37
    v_lshlrev_b32 v48, 16, v38
    v_and_b32 v49, s82, v38
    v_lshlrev_b32 v50, 16, v39
    v_and_b32 v51, s82, v39
    v_lshlrev_b32 v52, 16, v40
    v_and_b32 v53, s82, v40
    v_lshlrev_b32 v54, 16, v41
    v_and_b32 v55, s82, v41
    v_lshlrev_b32 v56, 16, v42
    v_and_b32 v57, s82, v42
    v_lshlrev_b32 v58, 16, v43
    v_and_b32 v59, s82, v43
    s_waitcnt lgkmcnt(0)
    s_barrier
    ds_read_b128 v[128:131], v60 offset:4096
    ds_read_b128 v[144:147], v61 offset:8192
    ds_read_b128 v[160:163], v62 offset:12288
    ds_read_b128 v[132:135], v60 offset:5120
    ds_read_b128 v[148:151], v61 offset:9216
    ds_read_b128 v[164:167], v62 offset:13312
    ds_read_b128 v[136:139], v60 offset:6144
    ds_read_b128 v[152:155], v61 offset:10240
    ds_read_b128 v[168:171], v62 offset:14336
    ds_read_b128 v[140:143], v60 offset:7168
    ds_read_b128 v[156:159], v61 offset:11264
    ds_read_b128 v[172:175], v62 offset:15360
    s_waitcnt lgkmcnt(10)
    v_pk_add_f32 v[128:129], v[128:129], v[144:145]
    s_waitcnt lgkmcnt(9)
    v_pk_add_f32 v[192:193], v[192:193], v[160:161]
    v_pk_add_f32 v[130:131], v[130:131], v[146:147]
    v_pk_add_f32 v[194:195], v[194:195], v[162:163]
    s_waitcnt lgkmcnt(7)
    v_pk_add_f32 v[132:133], v[132:133], v[148:149]
    s_waitcnt lgkmcnt(6)
    v_pk_add_f32 v[196:197], v[196:197], v[164:165]
    v_pk_add_f32 v[134:135], v[134:135], v[150:151]
    v_pk_add_f32 v[198:199], v[198:199], v[166:167]
    v_pk_add_f32 v[192:193], v[192:193], v[128:129]
    v_pk_add_f32 v[194:195], v[194:195], v[130:131]
    v_pk_add_f32 v[196:197], v[196:197], v[132:133]
    v_pk_add_f32 v[198:199], v[198:199], v[134:135]
    v_pk_fma_f32 v[44:45], v[64:65], v[192:193], v[44:45]
    v_pk_fma_f32 v[46:47], v[66:67], v[194:195], v[46:47]
    v_pk_fma_f32 v[48:49], v[68:69], v[196:197], v[48:49]
    v_pk_fma_f32 v[50:51], v[70:71], v[198:199], v[50:51]
    v_cvt_pk_bf16_f32 v36, v44, v45
    v_cvt_pk_bf16_f32 v37, v46, v47
    v_cvt_pk_bf16_f32 v38, v48, v49
    v_cvt_pk_bf16_f32 v39, v50, v51
    buffer_store_dwordx4 v[36:39], v32, s[32:35], 0 offen
    s_waitcnt lgkmcnt(4)
    v_pk_add_f32 v[136:137], v[136:137], v[152:153]
    s_waitcnt lgkmcnt(3)
    v_pk_add_f32 v[200:201], v[200:201], v[168:169]
    v_pk_add_f32 v[138:139], v[138:139], v[154:155]
    v_pk_add_f32 v[202:203], v[202:203], v[170:171]
    s_waitcnt lgkmcnt(1)
    v_pk_add_f32 v[140:141], v[140:141], v[156:157]
    s_waitcnt lgkmcnt(0)
    v_pk_add_f32 v[204:205], v[204:205], v[172:173]
    v_pk_add_f32 v[142:143], v[142:143], v[158:159]
    v_pk_add_f32 v[206:207], v[206:207], v[174:175]
    v_pk_add_f32 v[200:201], v[200:201], v[136:137]
    v_pk_add_f32 v[202:203], v[202:203], v[138:139]
    v_pk_add_f32 v[204:205], v[204:205], v[140:141]
    v_pk_add_f32 v[206:207], v[206:207], v[142:143]
    v_pk_fma_f32 v[52:53], v[72:73], v[200:201], v[52:53]
    v_pk_fma_f32 v[54:55], v[74:75], v[202:203], v[54:55]
    v_pk_fma_f32 v[56:57], v[76:77], v[204:205], v[56:57]
    v_pk_fma_f32 v[58:59], v[78:79], v[206:207], v[58:59]
    v_cvt_pk_bf16_f32 v40, v52, v53
    v_cvt_pk_bf16_f32 v41, v54, v55
    v_cvt_pk_bf16_f32 v42, v56, v57
    v_cvt_pk_bf16_f32 v43, v58, v59
    buffer_store_dwordx4 v[40:43], v32, s[32:35], 0 offen offset:32
    s_endpgm
L_dft:
    s_lshl_b32 s55, s52, 4
    v_add_u32 v31, s55, v28
    s_mul_i32 s56, s77, 540672
    s_add_u32 s71, s71, s56
    s_add_u32 s56, s77, 24
    s_lshl_b32 s57, s77, 17
    v_lshl_add_u32 v16, v31, 8, v30
    v_add_u32 v16, s57, v16
    v_add_u32 v17, 1024, v16
    s_lshl_b32 s57, s56, 7
    v_mul_u32_u24 v31, 3584, v31
    v_add3_u32 v18, v31, v30, s57
    v_add_u32 v19, 27648, v18
    s_lshl_b32 s57, s56, 12
    s_add_u32 s70, s69, s57
    s_sub_u32 s69, s70, 4096
    s_lshl_b32 s57, s80, 7
    v_lshl_add_u32 v20, v28, 10, v30
    v_add_u32 v20, s57, v20
    v_add_u32 v21, 7168, v20
    v_add_u32 v22, 14336, v20
    v_add_u32 v23, 21504, v20
    v_lshrrev_b32_e64 v36, 5, v1
    v_mul_u32_u24 v36, 8, v36
    s_waitcnt vmcnt(14)
    v_bfe_u32 v39, v1, 2, 2
    v_add_u32 v36, v36, v39
    v_lshlrev_b32 v36, 7, v36
    v_bfe_u32 v37, v1, 4, 1
    v_lshlrev_b32 v37, 5, v37
    v_and_b32 v38, 3, v1
    v_lshlrev_b32_e64 v38, 3, v38
    v_add3_u32 v36, v36, v37, v38
    v_bfe_u32 v39, v1, 3, 1
    v_lshl_add_u32 v36, v39, 6, v36
    v_add_u32 v8, 0, v36
    v_xor_b32 v9, 64, v8
    v_add_u32 v10, 40960, v36
    v_xor_b32_e64 v11, 64, v10
    v_add_u32 v12, 81920, v36
    v_xor_b32_e64 v13, 64, v12
    v_add_u32 v14, 122880, v36
    v_xor_b32 v15, 64, v14
    s_and_b32 s55, s78, 3
    s_lshl_b32 s55, s55, 2
    s_add_u32 s55, s55, s52
    s_lshl_b32 s55, s55, 4
    v_and_b32 v36, 15, v1
    v_add_u32_e64 v37, s55, v36
    v_mov_b32 v38, 256
    v_cmp_eq_u32 vcc, 0, v37
    v_lshrrev_b32 v39, 4, v1
    s_nop 0
    v_cndmask_b32 v37, v37, v38, vcc
    v_mul_u32_u24 v40, 2056, v39
    v_lshl_add_u32 v40, v37, 1, v40
    v_mul_u32_u24 v41, 8448, v36
    v_lshl_add_u32 v41, v39, 4, v41
    s_lshr_b32 s56, s2, 5
    s_lshl_b32 s56, s56, 3
    s_and_b32 s57, s2, 7
    s_add_u32 s56, s56, s57
    s_mul_i32 s72, s56, 16448
    s_add_u32 s73, s72, 8224
    s_mul_i32 s74, s55, 8448
    s_lshl_b32 s57, s56, 7
    s_add_u32 s74, s74, s57
    s_add_u32 s74, s74, 12582912
    s_lshr_b32 s56, s56, 4
    s_and_b32 s55, s78, 3
    s_lshl_b32 s55, s55, 2
    s_add_u32 s55, s55, s56
    s_add_u32 s55, s55, 16
    s_lshl_b32 s75, s55, 8
    s_mul_i32 s92, s2, 8448
    s_mov_b32 s81, 1065369472
    s_mov_b32 s82, 4294901760
    v_mov_b32 v6, 0xc0135761
    v_and_b32_e64 v36, 31, v1
    v_bfe_u32 v37, v1, 1, 3
    v_lshrrev_b32 v38, 5, v1
    v_xor_b32 v37, v37, v38
    v_lshlrev_b32_e64 v37, 4, v37
    v_lshl_add_u32 v36, v36, 7, v37
    v_add_u32 v44, s53, v36
    v_xor_b32 v45, 32, v44
    v_xor_b32_e64 v46, 64, v44
    v_xor_b32 v47, 96, v44
    v_mov_b32 v48, 0
    v_mov_b32 v49, 0
    v_mov_b32 v50, 0
    v_mov_b32 v51, 0
    v_mov_b32 v52, 0
    v_mov_b32 v53, 0
    v_mov_b32 v54, 0
    v_mov_b32 v55, 0
    v_and_b32 v72, 15, v1
    v_lshrrev_b32 v73, 4, v1
    s_lshl_b32 s55, s52, 4
    v_add_u32 v74, s55, v72
    v_cvt_f32_u32 v74, v74
    v_cvt_f32_u32 v80, v72
    v_mul_f32 v75, 0x3c800000, v74
    v_lshrrev_b32 v79, 1, v73
    v_lshlrev_b32 v79, 4, v79
    v_and_b32_e64 v77, 1, v73
    v_lshl_add_u32 v79, v77, 2, v79
    v_cvt_f32_u32 v79, v79
    v_mul_f32 v77, v79, v75
    v_fmamk_f32 v64, v75, 0x00000000, v77
    v_fmamk_f32 v65, v75, 0x3f800000, v77
    v_fmamk_f32 v66, v75, 0x40000000, v77
    v_fmamk_f32 v67, v75, 0x40400000, v77
    v_cos_f32 v68, v64
    v_cos_f32 v69, v65
    v_cos_f32 v70, v66
    v_cos_f32 v71, v67
    v_sin_f32 v64, v64
    v_sin_f32 v65, v65
    v_sin_f32 v66, v66
    v_sin_f32 v67, v67
    v_cvt_pk_bf16_f32 v68, v68, v69
    v_cvt_pk_bf16_f32 v70, v70, v71
    v_cvt_pk_bf16_f32 v64, v64, v65
    v_cvt_pk_bf16_f32 v66, v66, v67
    v_accvgpr_write_b32 a96, v68
    v_xor_b32 v65, 2147516416, v64
    v_accvgpr_write_b32 a97, v70
    v_xor_b32 v67, 2147516416, v66
    v_accvgpr_write_b32 a104, v64
    v_accvgpr_write_b32 a112, v65
    v_accvgpr_write_b32 a105, v66
    v_accvgpr_write_b32 a113, v67
    v_fmamk_f32 v64, v75, 0x41000000, v77
    v_fmamk_f32 v65, v75, 0x41100000, v77
    v_fmamk_f32 v66, v75, 0x41200000, v77
    v_fmamk_f32 v67, v75, 0x41300000, v77
    v_cos_f32 v68, v64
    v_cos_f32 v69, v65
    v_cos_f32 v70, v66
    v_cos_f32 v71, v67
    v_sin_f32 v64, v64
    v_sin_f32 v65, v65
    v_sin_f32 v66, v66
    v_sin_f32 v67, v67
    v_cvt_pk_bf16_f32 v68, v68, v69
    v_cvt_pk_bf16_f32 v70, v70, v71
    v_cvt_pk_bf16_f32 v64, v64, v65
    v_cvt_pk_bf16_f32 v66, v66, v67
    v_accvgpr_write_b32 a98, v68
    v_xor_b32 v65, 2147516416, v64
    v_accvgpr_write_b32 a99, v70
    v_xor_b32 v67, 2147516416, v66
    v_accvgpr_write_b32 a106, v64
    v_accvgpr_write_b32 a114, v65
    v_accvgpr_write_b32 a107, v66
    v_accvgpr_write_b32 a115, v67
    v_fmamk_f32 v64, v75, 0x42000000, v77
    v_fmamk_f32 v65, v75, 0x42040000, v77
    v_fmamk_f32 v66, v75, 0x42080000, v77
    v_fmamk_f32 v67, v75, 0x420c0000, v77
    v_cos_f32 v68, v64
    v_cos_f32 v69, v65
    v_cos_f32 v70, v66
    v_cos_f32 v71, v67
    v_sin_f32 v64, v64
    v_sin_f32 v65, v65
    v_sin_f32 v66, v66
    v_sin_f32 v67, v67
    v_cvt_pk_bf16_f32 v68, v68, v69
    v_cvt_pk_bf16_f32 v70, v70, v71
    v_cvt_pk_bf16_f32 v64, v64, v65
    v_cvt_pk_bf16_f32 v66, v66, v67
    v_accvgpr_write_b32 a100, v68
    v_xor_b32 v65, 2147516416, v64
    v_accvgpr_write_b32 a101, v70
    v_xor_b32 v67, 2147516416, v66
    v_accvgpr_write_b32 a108, v64
    v_accvgpr_write_b32 a116, v65
    v_accvgpr_write_b32 a109, v66
    v_accvgpr_write_b32 a117, v67
    v_fmamk_f32 v64, v75, 0x42200000, v77
    v_fmamk_f32 v65, v75, 0x42240000, v77
    v_fmamk_f32 v66, v75, 0x42280000, v77
    v_fmamk_f32 v67, v75, 0x422c0000, v77
    v_cos_f32 v68, v64
    v_cos_f32 v69, v65
    v_cos_f32 v70, v66
    v_cos_f32 v71, v67
    v_sin_f32 v64, v64
    v_sin_f32 v65, v65
    v_sin_f32 v66, v66
    v_sin_f32 v67, v67
    v_cvt_pk_bf16_f32 v68, v68, v69
    v_cvt_pk_bf16_f32 v70, v70, v71
    v_cvt_pk_bf16_f32 v64, v64, v65
    v_cvt_pk_bf16_f32 v66, v66, v67
    v_accvgpr_write_b32 a102, v68
    v_xor_b32 v65, 2147516416, v64
    v_accvgpr_write_b32 a103, v70
    v_xor_b32 v67, 2147516416, v66
    v_accvgpr_write_b32 a110, v64
    v_accvgpr_write_b32 a118, v65
    v_accvgpr_write_b32 a111, v66
    v_accvgpr_write_b32 a119, v67
    v_lshlrev_b32 v81, 2, v73
    v_cvt_f32_u32 v81, v81
    v_mul_f32 v75, 0x3a000000, v74
    v_mul_f32_e64 v77, v81, v75
    v_fmamk_f32 v64, v75, 0x00000000, v77
    v_fmamk_f32 v65, v75, 0x3f800000, v77
    v_fmamk_f32 v66, v75, 0x40000000, v77
    v_fmamk_f32 v67, v75, 0x40400000, v77
    v_cos_f32 v68, v64
    v_cos_f32 v69, v65
    v_cos_f32 v70, v66
    v_cos_f32 v71, v67
    v_sin_f32 v64, v64
    v_sin_f32 v65, v65
    v_sin_f32 v66, v66
    v_sin_f32 v67, v67
    v_accvgpr_write_b32 a144, v68
    v_accvgpr_write_b32 a145, v69
    v_accvgpr_write_b32 a146, v70
    v_accvgpr_write_b32 a147, v71
    v_accvgpr_write_b32 a152, v64
    v_accvgpr_write_b32 a153, v65
    v_accvgpr_write_b32 a154, v66
    v_accvgpr_write_b32 a155, v67
    v_fmamk_f32 v64, v75, 0x41800000, v77
    v_fmamk_f32 v65, v75, 0x41880000, v77
    v_fmamk_f32 v66, v75, 0x41900000, v77
    v_fmamk_f32 v67, v75, 0x41980000, v77
    v_cos_f32 v68, v64
    v_cos_f32 v69, v65
    v_cos_f32 v70, v66
    v_cos_f32 v71, v67
    v_sin_f32 v64, v64
    v_sin_f32 v65, v65
    v_sin_f32 v66, v66
    v_sin_f32 v67, v67
    v_accvgpr_write_b32 a148, v68
    v_accvgpr_write_b32 a149, v69
    v_accvgpr_write_b32 a150, v70
    v_accvgpr_write_b32 a151, v71
    v_accvgpr_write_b32 a156, v64
    v_accvgpr_write_b32 a157, v65
    v_accvgpr_write_b32 a158, v66
    v_accvgpr_write_b32 a159, v67
    v_cvt_f32_u32 v79, s55
    v_add_f32 v79, v79, v81
    v_mul_f32 v75, 0x3a000000, v80
    v_add_f32 v76, 0x3c000000, v75
    v_mul_f32 v77, v79, v75
    v_mul_f32 v78, v79, v76
    v_fmamk_f32 v64, v75, 0x00000000, v77
    v_fmamk_f32 v65, v75, 0x3f800000, v77
    v_fmamk_f32 v66, v75, 0x40000000, v77
    v_fmamk_f32 v67, v75, 0x40400000, v77
    v_cos_f32 v68, v64
    v_cos_f32 v69, v65
    v_cos_f32 v70, v66
    v_cos_f32 v71, v67
    v_sin_f32 v64, v64
    v_sin_f32 v65, v65
    v_sin_f32 v66, v66
    v_sin_f32 v67, v67
    v_mul_f32 v68, 0x36000000, v68
    v_mul_f32 v69, 0x36000000, v69
    v_mul_f32 v70, 0x36000000, v70
    v_mul_f32 v71, 0x36000000, v71
    v_mul_f32 v64, 0x36000000, v64
    v_mul_f32 v65, 0x36000000, v65
    v_mul_f32 v66, 0x36000000, v66
    v_mul_f32 v67, 0x36000000, v67
    v_accvgpr_write_b32 a160, v68
    v_accvgpr_write_b32 a161, v69
    v_accvgpr_write_b32 a162, v70
    v_accvgpr_write_b32 a163, v71
    v_accvgpr_write_b32 a168, v64
    v_accvgpr_write_b32 a169, v65
    v_accvgpr_write_b32 a170, v66
    v_accvgpr_write_b32 a171, v67
    v_fmamk_f32 v64, v76, 0x00000000, v78
    v_fmamk_f32 v65, v76, 0x3f800000, v78
    v_fmamk_f32 v66, v76, 0x40000000, v78
    v_fmamk_f32 v67, v76, 0x40400000, v78
    v_cos_f32 v68, v64
    v_cos_f32 v69, v65
    v_cos_f32 v70, v66
    v_cos_f32 v71, v67
    v_sin_f32 v64, v64
    v_sin_f32 v65, v65
    v_sin_f32 v66, v66
    v_sin_f32 v67, v67
    v_mul_f32 v68, 0x36000000, v68
    v_mul_f32 v69, 0x36000000, v69
    v_mul_f32 v70, 0x36000000, v70
    v_mul_f32 v71, 0x36000000, v71
    v_mul_f32 v64, 0x36000000, v64
    v_mul_f32 v65, 0x36000000, v65
    v_mul_f32 v66, 0x36000000, v66
    v_mul_f32 v67, 0x36000000, v67
    v_accvgpr_write_b32 a164, v68
    v_accvgpr_write_b32 a165, v69
    v_accvgpr_write_b32 a166, v70
    v_accvgpr_write_b32 a167, v71
    v_accvgpr_write_b32 a172, v64
    v_accvgpr_write_b32 a173, v65
    v_accvgpr_write_b32 a174, v66
    v_accvgpr_write_b32 a175, v67
    s_and_b32 s58, s78, 3
    s_mul_i32 s57, s52, 3
    s_add_u32 s57, s57, s80
    s_add_u32 s57, s57, s58
    s_add_u32 s55, s57, 0
    s_cmp_ge_u32 s55, 12
    s_cselect_b32 s56, 12, 0
    s_sub_u32 s55, s55, s56
    s_lshl_b32 s84, s55, 1
    s_add_u32 s55, s57, 1
    s_cmp_ge_u32 s55, 12
    s_cselect_b32 s56, 12, 0
    s_sub_u32 s55, s55, s56
    s_lshl_b32 s85, s55, 1
    s_add_u32 s55, s57, 2
    s_cmp_ge_u32 s55, 12
    s_cselect_b32 s56, 12, 0
    s_sub_u32 s55, s55, s56
    s_lshl_b32 s86, s55, 1
    s_lshl_b32 s55, s52, 2
    s_lshl_b32 s56, s80, 1
    s_add_u32 s55, s55, s56
    s_add_u32 s58, s58, s55
    s_add_u32 s55, s58, 0
    s_and_b32 s55, s55, 15
    s_lshl_b32 s56, s55, 1
    s_add_u32 s56, s56, 1
    s_add_u32 s57, s55, 12
    s_cmp_lt_u32 s55, 12
    s_cselect_b32 s87, s56, s57
    s_add_u32 s55, s58, 1
    s_and_b32 s55, s55, 15
    s_lshl_b32 s56, s55, 1
    s_add_u32 s56, s56, 1
    s_add_u32 s57, s55, 12
    s_cmp_lt_u32 s55, 12
    s_cselect_b32 s88, s56, s57
    s_add_u32 s55, s58, 2
    s_and_b32 s55, s55, 15
    s_lshl_b32 s56, s55, 1
    s_add_u32 s56, s56, 1
    s_add_u32 s57, s55, 12
    s_cmp_lt_u32 s55, 12
    s_cselect_b32 s89, s56, s57
    s_add_u32 s55, s58, 3
    s_and_b32 s55, s55, 15
    s_lshl_b32 s56, s55, 1
    s_add_u32 s56, s56, 1
    s_add_u32 s57, s55, 12
    s_cmp_lt_u32 s55, 12
    s_cselect_b32 s90, s56, s57
    v_lshrrev_b32 v81, 4, v1
    v_and_b32 v80, 15, v1
    s_lshl_b32 s55, s52, 3
    v_add_u32 v82, s55, v81
    v_add_u32 v83, 0, v82
    v_and_b32 v83, 15, v83
    v_xor_b32 v83, v83, v80
    v_lshlrev_b32_e64 v83, 4, v83
    v_lshl_add_u32 v83, v82, 8, v83
    v_accvgpr_write_b32 a176, v83
    v_add_u32 v83, 4, v82
    v_and_b32 v83, 15, v83
    v_xor_b32 v83, v83, v80
    v_lshlrev_b32 v83, 4, v83
    v_lshl_add_u32 v83, v82, 8, v83
    v_accvgpr_write_b32 a177, v83
    s_lshl_b32 s55, s52, 6
    v_lshrrev_b32 v83, 1, v81
    v_mul_u32_u24 v83, 40960, v83
    v_and_b32_e64 v84, 1, v81
    v_lshl_add_u32 v83, v84, 10, v83
    v_lshl_add_u32 v83, v80, 2, v83
    v_add_u32 v83, 32768, v83
    v_add_u32_e64 v83, s55, v83
    v_accvgpr_write_b32 a178, v83
    v_lshlrev_b32_e64 v83, 8, v80
    v_lshl_add_u32 v83, v81, 4, v83
    v_add_u32_e64 v83, s55, v83
    v_accvgpr_write_b32 a181, v83
    v_lshrrev_b32_e64 v83, 3, v80
    v_mul_u32_u24 v83, 40960, v83
    v_and_b32_e64 v84, 7, v80
    v_lshl_add_u32 v83, v84, 8, v83
    v_and_b32 v84, 2, v81
    v_add_u32 v84, v84, v81
    v_xor_b32_e64 v84, v84, v80
    v_lshl_add_u32 v83, v84, 4, v83
    v_add_u32 v83, 36864, v83
    v_accvgpr_write_b32 a179, v83
    s_lshl_b32 s55, s52, 9
    s_add_u32 s55, s55, 38912
    v_and_b32 v83, 1, v81
    v_lshlrev_b32_e64 v83, 8, v83
    v_lshl_add_u32 v83, v80, 4, v83
    v_lshrrev_b32_e64 v84, 1, v81
    v_lshl_add_u32 v83, v84, 3, v83
    v_add_u32_e64 v83, s55, v83
    v_accvgpr_write_b32 a180, v83
    v_lshrrev_b32 v86, 5, v1
    v_mul_u32_u24 v86, 4, v86
    v_bfe_u32 v89, v1, 2, 2
    v_add_u32 v86, v86, v89
    v_lshlrev_b32 v86, 7, v86
    v_bfe_u32 v87, v1, 4, 1
    v_lshlrev_b32 v87, 5, v87
    v_and_b32 v88, 1, v1
    v_lshlrev_b32 v88, 4, v88
    v_and_b32 v89, 2, v1
    v_lshl_add_u32 v88, v89, 2, v88
    v_add3_u32 v86, v86, v87, v88
    v_bfe_u32 v89, v1, 3, 1
    v_lshl_add_u32 v86, v89, 6, v86
    s_and_b32 s55, s52, 1
    s_lshl_b32 s56, s55, 6
    v_xor_b32 v86, s56, v86
    v_add_u32 v86, s53, v86
    v_accvgpr_write_b32 a182, v86
    s_lshr_b32 s56, s52, 1
    s_mul_i32 s58, s56, 115712
    v_add_u32 v83, s58, v2
    s_add_u32 s59, s54, 2
    s_and_b32 s59, s59, 7
    s_lshl_b32 s59, s59, 7
    s_add_u32 m0, s53, 16384
    s_add_u32 s59, s59, s68
    buffer_load_dwordx4 v32, s[4:7], s59 offen lds
    v_accvgpr_write_b32 a185, v83
    s_sub_u32 s58, 115712, s58
    v_add_u32_e64 v83, s58, v2
    v_accvgpr_write_b32 a186, v83
    s_mul_i32 s91, s79, 231424
    s_add_u32 s91, s91, 1048576
    v_lshrrev_b32_e64 v82, 5, v1
    v_bfe_u32 v83, v1, 2, 2
    v_lshl_add_u32 v84, v82, 2, v83
    buffer_load_dwordx4 v33, s[4:7], s59 offen offset:1024 lds
    v_lshlrev_b32_e64 v84, 8, v84
    v_bfe_u32 v85, v1, 4, 1
    v_lshl_add_u32 v84, v85, 6, v84
    v_and_b32_e64 v85, 3, v1
    v_lshl_add_u32 v84, v85, 4, v84
    v_and_b32 v85, 1, v83
    v_xor_b32 v85, s56, v85
    v_lshl_add_u32 v84, v85, 7, v84
    v_add_u32_e64 v84, s53, v84
    v_accvgpr_write_b32 a183, v84
    buffer_load_dwordx4 v34, s[4:7], s59 offen offset:2048 lds
    v_and_b32 v84, 1, v81
    v_lshlrev_b32 v84, 3, v84
    v_xor_b32_e64 v84, v84, v80
    v_mul_u32_u24 v83, 8448, v81
    v_lshl_add_u32 v83, v84, 4, v83
    v_accvgpr_write_b32 a184, v83
    s_mul_i32 s93, s52, 540672
    s_lshl_b32 s58, s79, 8
    s_add_u32 s93, s93, s58
    buffer_load_dwordx4 v35, s[4:7], s59 offen offset:3072 lds
    s_add_u32 s93, s93, 15728640
    v_and_b32 v83, 19, v1
    v_and_b32 v84, 4, v1
    v_lshl_add_u32 v83, v84, 1, v83
    v_bfe_u32 v84, v1, 3, 1
    v_lshl_add_u32 v83, v84, 2, v83
    s_lshl_b32 s58, s80, 1
    s_add_u32 s58, s58, s55
    s_lshl_b32 s58, s58, 5
    v_add_u32 v83, s58, v83
    s_add_u32 s59, s54, 3
    s_and_b32 s59, s59, 7
    s_lshl_b32 s59, s59, 7
    s_add_u32 m0, s53, 20480
    s_add_u32 s59, s59, s68
    buffer_load_dwordx4 v32, s[4:7], s59 offen lds
    v_xor_b32 v84, 32, v83
    s_lshl_b32 s83, s52, 6
    v_lshl_add_u32 v85, v82, 2, s83
    v_cmp_eq_u32 vcc, 0, v85
    v_cvt_f32_u32 v85, v85
    v_cvt_f32_u32_e64 v83, v83
    v_mul_f32 v83, 0x3b000000, v83
    v_accvgpr_write_b32 a187, v83
    v_mul_f32_e64 v86, v85, v83
    buffer_load_dwordx4 v33, s[4:7], s59 offen offset:1024 lds
    v_mul_f32 v87, 0x43800000, v83
    v_accvgpr_write_b32 a189, v86
    v_cndmask_b32 v87, v86, v87, vcc
    v_accvgpr_write_b32 a191, v87
    v_cvt_f32_u32 v84, v84
    v_mul_f32 v84, 0x3b000000, v84
    v_accvgpr_write_b32 a188, v84
    v_mul_f32_e64 v86, v85, v84
    v_mul_f32 v87, 0x43800000, v84
    v_accvgpr_write_b32 a190, v86
    buffer_load_dwordx4 v34, s[4:7], s59 offen offset:2048 lds
    v_cndmask_b32 v87, v86, v87, vcc
    v_accvgpr_write_b32 a192, v87
    v_and_b32 v83, 31, v1
    v_lshlrev_b32_e64 v83, 15, v83
    v_lshl_add_u32 v83, v82, 4, v83
    s_lshl_b32 s56, s56, 20
    s_lshl_b32 s58, s58, 1
    s_add_u32 s56, s56, s58
    s_lshl_b32 s58, s79, 10
    buffer_load_dwordx4 v35, s[4:7], s59 offen offset:3072 lds
    s_add_u32 s56, s56, s58
    v_add_u32_e64 v83, s56, v83
    v_accvgpr_write_b32 a193, v83
    s_and_b32 s56, s52, 2
    s_mul_i32 s56, s56, 40960
    s_add_u32 s56, s56, 36864
    v_bfe_u32 v83, v1, 4, 1
    v_mul_u32_u24 v83, 40960, v83
    v_lshl_add_u32 v83, v80, 7, v83
    s_add_u32 s59, s54, 4
    s_and_b32 s59, s59, 7
    s_lshl_b32 s59, s59, 7
    s_add_u32 m0, s53, 24576
    s_add_u32 s59, s59, s68
    buffer_load_dwordx4 v32, s[4:7], s59 offen lds
    s_lshl_b32 s55, s55, 2
    v_bfe_u32 v84, v1, 1, 3
    v_xor_b32 v84, v84, v82
    v_xor_b32_e64 v84, s55, v84
    v_lshl_add_u32 v83, v84, 4, v83
    v_add_u32_e64 v83, s56, v83
    v_accvgpr_write_b32 a195, v83
    s_lshr_b32 s55, s2, 6
    s_lshl_b32 s55, s55, 2
    v_and_b32_e64 v83, 3, v1
    buffer_load_dwordx4 v33, s[4:7], s59 offen offset:1024 lds
    v_and_b32_e64 v84, 4, v1
    v_lshl_add_u32 v83, v84, 2, v83
    v_add_u32 v83, s55, v83
    s_lshl_b32 s51, s79, 1
    s_add_u32 s51, s51, 32
    s_lshl_b32 s51, s51, 8
    v_lshlrev_b32_e64 v83, 8, v83
    v_accvgpr_write_b32 a194, v83
    s_lshl_b32 s0, s2, 2
    buffer_load_dwordx4 v34, s[4:7], s59 offen offset:2048 lds
    s_add_u32 s0, s0, s52
    v_mov_b32 v60, 2147483648
    s_and_b32 s1, s0, 1
    s_lshl_b32 s1, s1, 3
    v_add_u32_e64 v61, s1, v1
    v_lshl_or_b32 v62, v61, 1, 1
    v_add_u32_e64 v63, 12, v61
    v_cmp_gt_u32 vcc, 12, v61
    s_lshr_b32 s1, s0, 1
    s_mul_i32 s1, s1, 3584
    buffer_load_dwordx4 v35, s[4:7], s59 offen offset:3072 lds
    s_add_u32 s49, s1, 2048
    v_cndmask_b32 v62, v63, v62, vcc
    v_cmp_gt_u32 vcc, 8, v1
    v_lshlrev_b32 v62, 7, v62
    v_lshlrev_b32 v61, 7, v1
    v_cndmask_b32 v62, v60, v62, vcc
    v_cmp_gt_u32 vcc, 14, v1
    s_mul_i32 s50, s0, 1792
    s_nop 0
    v_cndmask_b32 v63, v60, v61, vcc
    s_waitcnt vmcnt(19)
    ds_read_b128 v[128:131], v44 offset:8192
    ds_read_b128 v[132:135], v45 offset:8192
    ds_read_b128 v[136:139], v46 offset:8192
    ds_read_b128 v[140:143], v47 offset:8192
    s_cmp_eq_u32 s2, 0
    s_cselect_b32 s57, 0, 4096
    buffer_store_dword v5, v3, s[36:39], s57 offen sc1
    s_add_u32 s59, s54, 5
    s_and_b32 s59, s59, 7
    s_lshl_b32 s59, s59, 7
    s_add_u32 m0, s53, 28672
    s_add_u32 s59, s59, s68
    buffer_load_dwordx4 v32, s[4:7], s59 offen lds
    buffer_load_dwordx4 v33, s[4:7], s59 offen offset:1024 lds
    buffer_load_dwordx4 v34, s[4:7], s59 offen offset:2048 lds
    buffer_load_dwordx4 v35, s[4:7], s59 offen offset:3072 lds
    s_waitcnt vmcnt(20)
    ds_read_b128 v[144:147], v44 offset:12288
    ds_read_b128 v[148:151], v45 offset:12288
    ds_read_b128 v[152:155], v46 offset:12288
    ds_read_b128 v[156:159], v47 offset:12288
    s_add_u32 s59, s54, 6
    s_and_b32 s59, s59, 7
    s_lshl_b32 s59, s59, 7
    s_add_u32 m0, s53, 32768
    s_add_u32 s59, s59, s68
    buffer_load_dwordx4 v32, s[4:7], s59 offen lds
    s_waitcnt lgkmcnt(7)
    v_dot2c_f32_bf16 v48, s81, v128
    v_dot2c_f32_bf16 v52, v128, v128
    v_dot2c_f32_bf16 v49, s81, v129
    v_dot2c_f32_bf16 v53, v129, v129
    v_dot2c_f32_bf16 v50, s81, v130
    v_dot2c_f32_bf16 v54, v130, v130
    v_dot2c_f32_bf16 v51, s81, v131
    v_dot2c_f32_bf16 v55, v131, v131
    buffer_load_dwordx4 v33, s[4:7], s59 offen offset:1024 lds
    s_waitcnt lgkmcnt(6)
    v_dot2c_f32_bf16 v48, s81, v132
    v_dot2c_f32_bf16 v52, v132, v132
    v_dot2c_f32_bf16 v49, s81, v133
    v_dot2c_f32_bf16 v53, v133, v133
    v_dot2c_f32_bf16 v50, s81, v134
    v_dot2c_f32_bf16 v54, v134, v134
    v_dot2c_f32_bf16 v51, s81, v135
    v_dot2c_f32_bf16 v55, v135, v135
    buffer_load_dwordx4 v34, s[4:7], s59 offen offset:2048 lds
    s_waitcnt lgkmcnt(5)
    v_dot2c_f32_bf16 v48, s81, v136
    v_dot2c_f32_bf16 v52, v136, v136
    v_dot2c_f32_bf16 v49, s81, v137
    v_dot2c_f32_bf16 v53, v137, v137
    v_dot2c_f32_bf16 v50, s81, v138
    v_dot2c_f32_bf16 v54, v138, v138
    v_dot2c_f32_bf16 v51, s81, v139
    v_dot2c_f32_bf16 v55, v139, v139
    buffer_load_dwordx4 v35, s[4:7], s59 offen offset:3072 lds
    s_waitcnt lgkmcnt(4)
    v_dot2c_f32_bf16 v48, s81, v140
    v_dot2c_f32_bf16 v52, v140, v140
    v_dot2c_f32_bf16 v49, s81, v141
    v_dot2c_f32_bf16 v53, v141, v141
    v_dot2c_f32_bf16 v50, s81, v142
    v_dot2c_f32_bf16 v54, v142, v142
    v_dot2c_f32_bf16 v51, s81, v143
    v_dot2c_f32_bf16 v55, v143, v143
    s_waitcnt vmcnt(17)
    ds_read_b128 v[160:163], v44 offset:16384
    ds_read_b128 v[164:167], v45 offset:16384
    ds_read_b128 v[168:171], v46 offset:16384
    ds_read_b128 v[172:175], v47 offset:16384
    s_add_u32 s59, s54, 7
    s_and_b32 s59, s59, 7
    s_lshl_b32 s59, s59, 7
    s_add_u32 m0, s53, 36864
    s_add_u32 s59, s59, s68
    buffer_load_dwordx4 v32, s[4:7], s59 offen lds
    s_waitcnt lgkmcnt(7)
    v_dot2c_f32_bf16 v48, s81, v144
    v_dot2c_f32_bf16 v52, v144, v144
    v_dot2c_f32_bf16 v49, s81, v145
    v_dot2c_f32_bf16 v53, v145, v145
    v_dot2c_f32_bf16 v50, s81, v146
    v_dot2c_f32_bf16 v54, v146, v146
    v_dot2c_f32_bf16 v51, s81, v147
    v_dot2c_f32_bf16 v55, v147, v147
    buffer_load_dwordx4 v33, s[4:7], s59 offen offset:1024 lds
    s_waitcnt lgkmcnt(6)
    v_dot2c_f32_bf16 v48, s81, v148
    v_dot2c_f32_bf16 v52, v148, v148
    v_dot2c_f32_bf16 v49, s81, v149
    v_dot2c_f32_bf16 v53, v149, v149
    v_dot2c_f32_bf16 v50, s81, v150
    v_dot2c_f32_bf16 v54, v150, v150
    v_dot2c_f32_bf16 v51, s81, v151
    v_dot2c_f32_bf16 v55, v151, v151
    buffer_load_dwordx4 v34, s[4:7], s59 offen offset:2048 lds
    s_waitcnt lgkmcnt(5)
    v_dot2c_f32_bf16 v48, s81, v152
    v_dot2c_f32_bf16 v52, v152, v152
    v_dot2c_f32_bf16 v49, s81, v153
    v_dot2c_f32_bf16 v53, v153, v153
    v_dot2c_f32_bf16 v50, s81, v154
    v_dot2c_f32_bf16 v54, v154, v154
    v_dot2c_f32_bf16 v51, s81, v155
    v_dot2c_f32_bf16 v55, v155, v155
    buffer_load_dwordx4 v35, s[4:7], s59 offen offset:3072 lds
    s_waitcnt lgkmcnt(4)
    v_dot2c_f32_bf16 v48, s81, v156
    v_dot2c_f32_bf16 v52, v156, v156
    v_dot2c_f32_bf16 v49, s81, v157
    v_dot2c_f32_bf16 v53, v157, v157
    v_dot2c_f32_bf16 v50, s81, v158
    v_dot2c_f32_bf16 v54, v158, v158
    v_dot2c_f32_bf16 v51, s81, v159
    v_dot2c_f32_bf16 v55, v159, v159
    s_waitcnt vmcnt(17)
    ds_read_b128 v[176:179], v44 offset:20480
    ds_read_b128 v[180:183], v45 offset:20480
    ds_read_b128 v[184:187], v46 offset:20480
    ds_read_b128 v[188:191], v47 offset:20480
    s_add_u32 s59, s54, 0
    s_and_b32 s59, s59, 7
    s_add_u32 m0, s53, 0
    s_lshl_b32 s59, s59, 14
    buffer_load_dwordx4 v16, s[40:43], s59 offen lds
    s_waitcnt lgkmcnt(7)
    v_dot2c_f32_bf16 v48, s81, v160
    v_dot2c_f32_bf16 v52, v160, v160
    v_dot2c_f32_bf16 v49, s81, v161
    v_dot2c_f32_bf16 v53, v161, v161
    v_dot2c_f32_bf16 v50, s81, v162
    v_dot2c_f32_bf16 v54, v162, v162
    v_dot2c_f32_bf16 v51, s81, v163
    v_dot2c_f32_bf16 v55, v163, v163
    buffer_load_dwordx4 v17, s[40:43], s59 offen offset:1024 lds
    s_waitcnt lgkmcnt(6)
    v_dot2c_f32_bf16 v48, s81, v164
    v_dot2c_f32_bf16 v52, v164, v164
    v_dot2c_f32_bf16 v49, s81, v165
    v_dot2c_f32_bf16 v53, v165, v165
    v_dot2c_f32_bf16 v50, s81, v166
    v_dot2c_f32_bf16 v54, v166, v166
    v_dot2c_f32_bf16 v51, s81, v167
    v_dot2c_f32_bf16 v55, v167, v167
    buffer_load_dwordx4 v16, s[44:47], s59 offen offset:2048 lds
    s_waitcnt lgkmcnt(5)
    v_dot2c_f32_bf16 v48, s81, v168
    v_dot2c_f32_bf16 v52, v168, v168
    v_dot2c_f32_bf16 v49, s81, v169
    v_dot2c_f32_bf16 v53, v169, v169
    v_dot2c_f32_bf16 v50, s81, v170
    v_dot2c_f32_bf16 v54, v170, v170
    v_dot2c_f32_bf16 v51, s81, v171
    v_dot2c_f32_bf16 v55, v171, v171
    buffer_load_dwordx4 v17, s[44:47], s59 offen offset:3072 lds
    s_waitcnt lgkmcnt(4)
    v_dot2c_f32_bf16 v48, s81, v172
    v_dot2c_f32_bf16 v52, v172, v172
    v_dot2c_f32_bf16 v49, s81, v173
    v_dot2c_f32_bf16 v53, v173, v173
    v_dot2c_f32_bf16 v50, s81, v174
    v_dot2c_f32_bf16 v54, v174, v174
    v_dot2c_f32_bf16 v51, s81, v175
    v_dot2c_f32_bf16 v55, v175, v175
    s_waitcnt vmcnt(17)
    ds_read_b128 v[192:195], v44 offset:24576
    ds_read_b128 v[196:199], v45 offset:24576
    ds_read_b128 v[200:203], v46 offset:24576
    ds_read_b128 v[204:207], v47 offset:24576
    s_add_u32 s59, s54, 1
    s_and_b32 s59, s59, 7
    s_add_u32 m0, s53, 4096
    s_lshl_b32 s59, s59, 14
    buffer_load_dwordx4 v16, s[40:43], s59 offen lds
    s_waitcnt lgkmcnt(7)
    v_dot2c_f32_bf16 v48, s81, v176
    v_dot2c_f32_bf16 v52, v176, v176
    v_dot2c_f32_bf16 v49, s81, v177
    v_dot2c_f32_bf16 v53, v177, v177
    v_dot2c_f32_bf16 v50, s81, v178
    v_dot2c_f32_bf16 v54, v178, v178
    v_dot2c_f32_bf16 v51, s81, v179
    v_dot2c_f32_bf16 v55, v179, v179
    buffer_load_dwordx4 v17, s[40:43], s59 offen offset:1024 lds
    s_waitcnt lgkmcnt(6)
    v_dot2c_f32_bf16 v48, s81, v180
    v_dot2c_f32_bf16 v52, v180, v180
    v_dot2c_f32_bf16 v49, s81, v181
    v_dot2c_f32_bf16 v53, v181, v181
    v_dot2c_f32_bf16 v50, s81, v182
    v_dot2c_f32_bf16 v54, v182, v182
    v_dot2c_f32_bf16 v51, s81, v183
    v_dot2c_f32_bf16 v55, v183, v183
    buffer_load_dwordx4 v16, s[44:47], s59 offen offset:2048 lds
    s_waitcnt lgkmcnt(5)
    v_dot2c_f32_bf16 v48, s81, v184
    v_dot2c_f32_bf16 v52, v184, v184
    v_dot2c_f32_bf16 v49, s81, v185
    v_dot2c_f32_bf16 v53, v185, v185
    v_dot2c_f32_bf16 v50, s81, v186
    v_dot2c_f32_bf16 v54, v186, v186
    v_dot2c_f32_bf16 v51, s81, v187
    v_dot2c_f32_bf16 v55, v187, v187
    buffer_load_dwordx4 v17, s[44:47], s59 offen offset:3072 lds
    s_waitcnt lgkmcnt(4)
    v_dot2c_f32_bf16 v48, s81, v188
    v_dot2c_f32_bf16 v52, v188, v188
    v_dot2c_f32_bf16 v49, s81, v189
    v_dot2c_f32_bf16 v53, v189, v189
    v_dot2c_f32_bf16 v50, s81, v190
    v_dot2c_f32_bf16 v54, v190, v190
    v_dot2c_f32_bf16 v51, s81, v191
    v_dot2c_f32_bf16 v55, v191, v191
    s_waitcnt vmcnt(16)
    ds_read_b128 v[208:211], v44 offset:28672
    ds_read_b128 v[212:215], v45 offset:28672
    ds_read_b128 v[216:219], v46 offset:28672
    ds_read_b128 v[220:223], v47 offset:28672
    s_add_u32 s59, s54, 2
    s_and_b32 s59, s59, 7
    s_add_u32 m0, s53, 8192
    s_lshl_b32 s59, s59, 14
    buffer_load_dwordx4 v16, s[40:43], s59 offen lds
    s_waitcnt lgkmcnt(7)
    v_dot2c_f32_bf16 v48, s81, v192
    v_dot2c_f32_bf16 v52, v192, v192
    v_dot2c_f32_bf16 v49, s81, v193
    v_dot2c_f32_bf16 v53, v193, v193
    v_dot2c_f32_bf16 v50, s81, v194
    v_dot2c_f32_bf16 v54, v194, v194
    v_dot2c_f32_bf16 v51, s81, v195
    v_dot2c_f32_bf16 v55, v195, v195
    buffer_load_dwordx4 v17, s[40:43], s59 offen offset:1024 lds
    s_waitcnt lgkmcnt(6)
    v_dot2c_f32_bf16 v48, s81, v196
    v_dot2c_f32_bf16 v52, v196, v196
    v_dot2c_f32_bf16 v49, s81, v197
    v_dot2c_f32_bf16 v53, v197, v197
    v_dot2c_f32_bf16 v50, s81, v198
    v_dot2c_f32_bf16 v54, v198, v198
    v_dot2c_f32_bf16 v51, s81, v199
    v_dot2c_f32_bf16 v55, v199, v199
    buffer_load_dwordx4 v16, s[44:47], s59 offen offset:2048 lds
    s_waitcnt lgkmcnt(5)
    v_dot2c_f32_bf16 v48, s81, v200
    v_dot2c_f32_bf16 v52, v200, v200
    v_dot2c_f32_bf16 v49, s81, v201
    v_dot2c_f32_bf16 v53, v201, v201
    v_dot2c_f32_bf16 v50, s81, v202
    v_dot2c_f32_bf16 v54, v202, v202
    v_dot2c_f32_bf16 v51, s81, v203
    v_dot2c_f32_bf16 v55, v203, v203
    buffer_load_dwordx4 v17, s[44:47], s59 offen offset:3072 lds
    s_waitcnt lgkmcnt(4)
    v_dot2c_f32_bf16 v48, s81, v204
    v_dot2c_f32_bf16 v52, v204, v204
    v_dot2c_f32_bf16 v49, s81, v205
    v_dot2c_f32_bf16 v53, v205, v205
    v_dot2c_f32_bf16 v50, s81, v206
    v_dot2c_f32_bf16 v54, v206, v206
    v_dot2c_f32_bf16 v51, s81, v207
    v_dot2c_f32_bf16 v55, v207, v207
    s_waitcnt vmcnt(16)
    ds_read_b128 v[224:227], v44 offset:32768
    ds_read_b128 v[228:231], v45 offset:32768
    ds_read_b128 v[232:235], v46 offset:32768
    ds_read_b128 v[236:239], v47 offset:32768
    s_add_u32 s59, s54, 3
    s_and_b32 s59, s59, 7
    s_add_u32 m0, s53, 12288
    s_lshl_b32 s59, s59, 14
    buffer_load_dwordx4 v16, s[40:43], s59 offen lds
    s_waitcnt lgkmcnt(7)
    v_dot2c_f32_bf16 v48, s81, v208
    v_dot2c_f32_bf16 v52, v208, v208
    v_dot2c_f32_bf16 v49, s81, v209
    v_dot2c_f32_bf16 v53, v209, v209
    v_dot2c_f32_bf16 v50, s81, v210
    v_dot2c_f32_bf16 v54, v210, v210
    v_dot2c_f32_bf16 v51, s81, v211
    v_dot2c_f32_bf16 v55, v211, v211
    buffer_load_dwordx4 v17, s[40:43], s59 offen offset:1024 lds
    s_waitcnt lgkmcnt(6)
    v_dot2c_f32_bf16 v48, s81, v212
    v_dot2c_f32_bf16 v52, v212, v212
    v_dot2c_f32_bf16 v49, s81, v213
    v_dot2c_f32_bf16 v53, v213, v213
    v_dot2c_f32_bf16 v50, s81, v214
    v_dot2c_f32_bf16 v54, v214, v214
    v_dot2c_f32_bf16 v51, s81, v215
    v_dot2c_f32_bf16 v55, v215, v215
    buffer_load_dwordx4 v16, s[44:47], s59 offen offset:2048 lds
    s_waitcnt lgkmcnt(5)
    v_dot2c_f32_bf16 v48, s81, v216
    v_dot2c_f32_bf16 v52, v216, v216
    v_dot2c_f32_bf16 v49, s81, v217
    v_dot2c_f32_bf16 v53, v217, v217
    v_dot2c_f32_bf16 v50, s81, v218
    v_dot2c_f32_bf16 v54, v218, v218
    v_dot2c_f32_bf16 v51, s81, v219
    v_dot2c_f32_bf16 v55, v219, v219
    buffer_load_dwordx4 v17, s[44:47], s59 offen offset:3072 lds
    s_waitcnt lgkmcnt(4)
    v_dot2c_f32_bf16 v48, s81, v220
    v_dot2c_f32_bf16 v52, v220, v220
    v_dot2c_f32_bf16 v49, s81, v221
    v_dot2c_f32_bf16 v53, v221, v221
    v_dot2c_f32_bf16 v50, s81, v222
    v_dot2c_f32_bf16 v54, v222, v222
    v_dot2c_f32_bf16 v51, s81, v223
    v_dot2c_f32_bf16 v55, v223, v223
    s_waitcnt vmcnt(16)
    ds_read_b128 v[240:243], v44 offset:36864
    ds_read_b128 v[244:247], v45 offset:36864
    ds_read_b128 v[248:251], v46 offset:36864
    ds_read_b128 v[252:255], v47 offset:36864
    s_waitcnt lgkmcnt(7)
    v_dot2c_f32_bf16 v48, s81, v224
    v_dot2c_f32_bf16 v52, v224, v224
    v_dot2c_f32_bf16 v49, s81, v225
    v_dot2c_f32_bf16 v53, v225, v225
    v_dot2c_f32_bf16 v50, s81, v226
    v_dot2c_f32_bf16 v54, v226, v226
    v_dot2c_f32_bf16 v51, s81, v227
    v_dot2c_f32_bf16 v55, v227, v227
    s_waitcnt lgkmcnt(6)
    v_dot2c_f32_bf16 v48, s81, v228
    v_dot2c_f32_bf16 v52, v228, v228
    v_dot2c_f32_bf16 v49, s81, v229
    v_dot2c_f32_bf16 v53, v229, v229
    v_dot2c_f32_bf16 v50, s81, v230
    v_dot2c_f32_bf16 v54, v230, v230
    v_dot2c_f32_bf16 v51, s81, v231
    v_dot2c_f32_bf16 v55, v231, v231
    s_waitcnt lgkmcnt(5)
    v_dot2c_f32_bf16 v48, s81, v232
    v_dot2c_f32_bf16 v52, v232, v232
    v_dot2c_f32_bf16 v49, s81, v233
    v_dot2c_f32_bf16 v53, v233, v233
    v_dot2c_f32_bf16 v50, s81, v234
    v_dot2c_f32_bf16 v54, v234, v234
    v_dot2c_f32_bf16 v51, s81, v235
    v_dot2c_f32_bf16 v55, v235, v235
    s_waitcnt lgkmcnt(4)
    v_dot2c_f32_bf16 v48, s81, v236
    v_dot2c_f32_bf16 v52, v236, v236
    v_dot2c_f32_bf16 v49, s81, v237
    v_dot2c_f32_bf16 v53, v237, v237
    v_dot2c_f32_bf16 v50, s81, v238
    v_dot2c_f32_bf16 v54, v238, v238
    v_dot2c_f32_bf16 v51, s81, v239
    v_dot2c_f32_bf16 v55, v239, v239
    s_add_u32 s59, s54, 4
    s_and_b32 s59, s59, 7
    s_add_u32 m0, s53, 16384
    s_lshl_b32 s59, s59, 14
    buffer_load_dwordx4 v16, s[40:43], s59 offen lds
    s_waitcnt lgkmcnt(3)
    v_dot2c_f32_bf16 v48, s81, v240
    v_dot2c_f32_bf16 v52, v240, v240
    v_dot2c_f32_bf16 v49, s81, v241
    v_dot2c_f32_bf16 v53, v241, v241
    v_dot2c_f32_bf16 v50, s81, v242
    v_dot2c_f32_bf16 v54, v242, v242
    v_dot2c_f32_bf16 v51, s81, v243
    v_dot2c_f32_bf16 v55, v243, v243
    buffer_load_dwordx4 v17, s[40:43], s59 offen offset:1024 lds
    s_waitcnt lgkmcnt(2)
    v_dot2c_f32_bf16 v48, s81, v244
    v_dot2c_f32_bf16 v52, v244, v244
    v_dot2c_f32_bf16 v49, s81, v245
    v_dot2c_f32_bf16 v53, v245, v245
    v_dot2c_f32_bf16 v50, s81, v246
    v_dot2c_f32_bf16 v54, v246, v246
    v_dot2c_f32_bf16 v51, s81, v247
    v_dot2c_f32_bf16 v55, v247, v247
    buffer_load_dwordx4 v16, s[44:47], s59 offen offset:2048 lds
    s_waitcnt lgkmcnt(1)
    v_dot2c_f32_bf16 v48, s81, v248
    v_dot2c_f32_bf16 v52, v248, v248
    v_dot2c_f32_bf16 v49, s81, v249
    v_dot2c_f32_bf16 v53, v249, v249
    v_dot2c_f32_bf16 v50, s81, v250
    v_dot2c_f32_bf16 v54, v250, v250
    v_dot2c_f32_bf16 v51, s81, v251
    v_dot2c_f32_bf16 v55, v251, v251
    buffer_load_dwordx4 v17, s[44:47], s59 offen offset:3072 lds
    s_waitcnt lgkmcnt(0)
    v_dot2c_f32_bf16 v48, s81, v252
    v_dot2c_f32_bf16 v52, v252, v252
    v_dot2c_f32_bf16 v49, s81, v253
    v_dot2c_f32_bf16 v53, v253, v253
    v_dot2c_f32_bf16 v50, s81, v254
    v_dot2c_f32_bf16 v54, v254, v254
    v_dot2c_f32_bf16 v51, s81, v255
    v_dot2c_f32_bf16 v55, v255, v255
    v_add_f32 v48, v48, v49
    s_nop 0
    v_add_f32 v50, v50, v51
    v_add_f32 v52, v52, v53
    v_add_f32 v54, v54, v55
    v_add_f32 v48, v48, v50
    v_add_f32 v52, v52, v54
    v_mov_b32 v49, v48
    v_mov_b32 v53, v52
    s_nop 0
    v_permlane32_swap_b32 v48, v49
    v_permlane32_swap_b32 v52, v53
    v_add_f32 v48, v48, v49
    v_add_f32_e64 v52, v52, v53
    v_mul_f32 v48, 0x3b000000, v48
    v_mul_f32 v52, 0x3b000000, v52
    v_fma_f32 v52, -v48, v48, v52
    v_max_f32_e64 v52, 0, v52
    v_add_f32 v52, 0x3727c5ac, v52
    v_rsq_f32_e64 v26, v52
    s_waitcnt vmcnt(16)
    s_barrier
    ds_read_b64_tr_b16 a[64:65], v8
    ds_read_b64_tr_b16 a[66:67], v8 offset:512
    ds_read_b64_tr_b16 a[68:69], v8 offset:2048
    ds_read_b64_tr_b16 a[70:71], v8 offset:2560
    ds_read_b64_tr_b16 a[72:73], v9
    ds_read_b64_tr_b16 a[74:75], v9 offset:512
    ds_read_b64_tr_b16 a[76:77], v9 offset:2048
    ds_read_b64_tr_b16 a[78:79], v9 offset:2560
    v_mul_f32_e64 v27, -v48, v26
    v_lshlrev_b32 v28, 16, v128
    v_and_b32 v29, s82, v128
    v_lshlrev_b32 v30, 16, v129
    v_and_b32 v31, s82, v129
    v_lshlrev_b32 v32, 16, v130
    v_and_b32 v33, s82, v130
    v_lshlrev_b32 v34, 16, v131
    v_and_b32 v35, s82, v131
    v_fma_f32 v28, v28, v26, v27
    v_fma_f32 v29, v29, v26, v27
    v_fma_f32 v30, v30, v26, v27
    v_fma_f32 v31, v31, v26, v27
    v_fma_f32 v32, v32, v26, v27
    v_fma_f32 v33, v33, v26, v27
    v_fma_f32 v34, v34, v26, v27
    v_fma_f32 v35, v35, v26, v27
    v_cvt_pk_bf16_f32 v128, v28, v29
    v_cvt_pk_bf16_f32 v129, v30, v31
    v_cvt_pk_bf16_f32 v130, v32, v33
    v_cvt_pk_bf16_f32 v131, v34, v35
    v_lshlrev_b32 v28, 16, v132
    v_and_b32 v29, s82, v132
    v_lshlrev_b32 v30, 16, v133
    v_and_b32 v31, s82, v133
    v_lshlrev_b32 v32, 16, v134
    v_and_b32 v33, s82, v134
    v_lshlrev_b32 v34, 16, v135
    v_and_b32 v35, s82, v135
    v_fma_f32 v28, v28, v26, v27
    v_fma_f32 v29, v29, v26, v27
    v_fma_f32 v30, v30, v26, v27
    v_fma_f32 v31, v31, v26, v27
    v_fma_f32 v32, v32, v26, v27
    v_fma_f32 v33, v33, v26, v27
    v_fma_f32 v34, v34, v26, v27
    v_fma_f32 v35, v35, v26, v27
    v_cvt_pk_bf16_f32 v132, v28, v29
    v_cvt_pk_bf16_f32 v133, v30, v31
    v_cvt_pk_bf16_f32 v134, v32, v33
    v_cvt_pk_bf16_f32 v135, v34, v35
    s_waitcnt lgkmcnt(6)
    v_mfma_f32_32x32x16_bf16 v[64:79], v[128:131], a[64:67], 0
    s_waitcnt lgkmcnt(4)
    ds_read_b64_tr_b16 a[80:81], v10
    ds_read_b64_tr_b16 a[82:83], v10 offset:512
    v_lshlrev_b32 v28, 16, v136
    v_and_b32 v29, s82, v136
    v_lshlrev_b32 v30, 16, v137
    v_and_b32 v31, s82, v137
    v_lshlrev_b32 v32, 16, v138
    v_and_b32 v33, s82, v138
    v_lshlrev_b32 v34, 16, v139
    v_and_b32 v35, s82, v139
    v_mfma_f32_32x32x16_bf16 v[80:95], v[128:131], a[68:71], 0
    s_waitcnt lgkmcnt(4)
    s_add_u32 s55, s54, 5
    s_and_b32 s55, s55, 7
    s_add_u32 m0, s53, 20480
    s_lshl_b32 s55, s55, 14
    ds_read_b64_tr_b16 a[84:85], v10 offset:2048
    ds_read_b64_tr_b16 a[86:87], v10 offset:2560
    buffer_load_dwordx4 v16, s[40:43], s55 offen lds
    v_fma_f32 v28, v28, v26, v27
    v_fma_f32 v29, v29, v26, v27
    v_mfma_f32_32x32x16_bf16 v[96:111], v[128:131], a[72:75], 0
    s_waitcnt lgkmcnt(4)
    ds_read_b64_tr_b16 a[88:89], v11
    ds_read_b64_tr_b16 a[90:91], v11 offset:512
    buffer_load_dwordx4 v17, s[40:43], s55 offen offset:1024 lds
    v_fma_f32 v30, v30, v26, v27
    v_fma_f32 v31, v31, v26, v27
    v_fma_f32 v32, v32, v26, v27
    v_fma_f32 v33, v33, v26, v27
    v_fma_f32 v34, v34, v26, v27
    v_mfma_f32_32x32x16_bf16 v[112:127], v[128:131], a[76:79], 0
    s_waitcnt lgkmcnt(4)
    ds_read_b64_tr_b16 a[92:93], v11 offset:2048
    ds_read_b64_tr_b16 a[94:95], v11 offset:2560
    buffer_load_dwordx4 v16, s[44:47], s55 offen offset:2048 lds
    v_fma_f32 v35, v35, v26, v27
    v_cvt_pk_bf16_f32 v136, v28, v29
    v_cvt_pk_bf16_f32 v137, v30, v31
    v_cvt_pk_bf16_f32 v138, v32, v33
    v_cvt_pk_bf16_f32 v139, v34, v35
    v_mfma_f32_32x32x16_bf16 v[64:79], v[132:135], a[80:83], v[64:79]
    s_waitcnt lgkmcnt(4)
    ds_read_b64_tr_b16 a[64:65], v12
    ds_read_b64_tr_b16 a[66:67], v12 offset:512
    v_mov_b32 v24, 0
    v_lshlrev_b32 v28, 16, v140
    v_and_b32 v29, s82, v140
    v_lshlrev_b32 v30, 16, v141
    v_and_b32 v31, s82, v141
    v_lshlrev_b32 v32, 16, v142
    v_and_b32 v33, s82, v142
    v_lshlrev_b32 v34, 16, v143
    v_mfma_f32_32x32x16_bf16 v[80:95], v[132:135], a[84:87], v[80:95]
    s_waitcnt lgkmcnt(4)
    ds_read_b64_tr_b16 a[68:69], v12 offset:2048
    ds_read_b64_tr_b16 a[70:71], v12 offset:2560
    buffer_load_dwordx4 v17, s[44:47], s55 offen offset:3072 lds
    v_and_b32_e64 v35, s82, v143
    v_fma_f32 v28, v28, v26, v27
    v_fma_f32 v29, v29, v26, v27
    v_fma_f32 v30, v30, v26, v27
    v_fma_f32 v31, v31, v26, v27
    v_fma_f32 v32, v32, v26, v27
    v_mfma_f32_32x32x16_bf16 v[96:111], v[132:135], a[88:91], v[96:111]
    s_waitcnt lgkmcnt(4)
    s_add_u32 s55, s54, 6
    s_and_b32 s55, s55, 7
    s_add_u32 m0, s53, 24576
    s_lshl_b32 s55, s55, 14
    ds_read_b64_tr_b16 a[72:73], v13
    ds_read_b64_tr_b16 a[74:75], v13 offset:512
    buffer_load_dwordx4 v16, s[40:43], s55 offen lds
    v_fma_f32 v33, v33, v26, v27
    v_fma_f32 v34, v34, v26, v27
    v_mfma_f32_32x32x16_bf16 v[112:127], v[132:135], a[92:95], v[112:127]
    s_waitcnt lgkmcnt(4)
    ds_read_b64_tr_b16 a[76:77], v13 offset:2048
    ds_read_b64_tr_b16 a[78:79], v13 offset:2560
    buffer_load_dwordx4 v17, s[40:43], s55 offen offset:1024 lds
    v_fma_f32 v35, v35, v26, v27
    v_cvt_pk_bf16_f32 v140, v28, v29
    v_cvt_pk_bf16_f32 v141, v30, v31
    v_cvt_pk_bf16_f32 v142, v32, v33
    v_cvt_pk_bf16_f32 v143, v34, v35
    v_mfma_f32_32x32x16_bf16 v[64:79], v[136:139], a[64:67], v[64:79]
    s_waitcnt lgkmcnt(4)
    s_waitcnt vmcnt(18)
    s_barrier
    ds_read_b64_tr_b16 a[80:81], v14
    ds_read_b64_tr_b16 a[82:83], v14 offset:512
    v_lshlrev_b32 v28, 16, v144
    v_and_b32 v29, s82, v144
    v_lshlrev_b32 v30, 16, v145
    v_and_b32 v31, s82, v145
    v_lshlrev_b32 v32, 16, v146
    v_mfma_f32_32x32x16_bf16 v[80:95], v[136:139], a[68:71], v[80:95]
    s_waitcnt lgkmcnt(4)
    ds_read_b64_tr_b16 a[84:85], v14 offset:2048
    ds_read_b64_tr_b16 a[86:87], v14 offset:2560
    buffer_load_dwordx4 v16, s[44:47], s55 offen offset:2048 lds
    v_and_b32 v33, s82, v146
    v_lshlrev_b32 v34, 16, v147
    v_and_b32 v35, s82, v147
    v_fma_f32 v28, v28, v26, v27
    v_fma_f32 v29, v29, v26, v27
    v_fma_f32 v30, v30, v26, v27
    v_mfma_f32_32x32x16_bf16 v[96:111], v[136:139], a[72:75], v[96:111]
    s_waitcnt lgkmcnt(4)
    ds_read_b64_tr_b16 a[88:89], v15
    ds_read_b64_tr_b16 a[90:91], v15 offset:512
    buffer_load_dwordx4 v17, s[44:47], s55 offen offset:3072 lds
    v_fma_f32 v31, v31, v26, v27
    v_fma_f32 v32, v32, v26, v27
    v_fma_f32 v33, v33, v26, v27
    v_fma_f32 v34, v34, v26, v27
    v_fma_f32 v35, v35, v26, v27
    v_cvt_pk_bf16_f32 v144, v28, v29
    v_cvt_pk_bf16_f32 v145, v30, v31
    v_mfma_f32_32x32x16_bf16 v[112:127], v[136:139], a[76:79], v[112:127]
    s_waitcnt lgkmcnt(4)
    s_add_u32 s55, s54, 7
    s_and_b32 s55, s55, 7
    s_add_u32 m0, s53, 28672
    s_lshl_b32 s55, s55, 14
    ds_read_b64_tr_b16 a[92:93], v15 offset:2048
    ds_read_b64_tr_b16 a[94:95], v15 offset:2560
    buffer_load_dwordx4 v16, s[40:43], s55 offen lds
    v_cvt_pk_bf16_f32 v146, v32, v33
    v_cvt_pk_bf16_f32 v147, v34, v35
    v_mfma_f32_32x32x16_bf16 v[64:79], v[140:143], a[80:83], v[64:79]
    s_waitcnt lgkmcnt(4)
    ds_read_b64_tr_b16 a[64:65], v8 offset:4096
    ds_read_b64_tr_b16 a[66:67], v8 offset:4608
    v_lshlrev_b32 v28, 16, v148
    v_and_b32 v29, s82, v148
    v_lshlrev_b32 v30, 16, v149
    v_and_b32 v31, s82, v149
    v_lshlrev_b32 v32, 16, v150
    v_and_b32_e64 v33, s82, v150
    v_lshlrev_b32 v34, 16, v151
    v_mfma_f32_32x32x16_bf16 v[80:95], v[140:143], a[84:87], v[80:95]
    s_waitcnt lgkmcnt(4)
    ds_read_b64_tr_b16 a[68:69], v8 offset:6144
    ds_read_b64_tr_b16 a[70:71], v8 offset:6656
    buffer_load_dwordx4 v17, s[40:43], s55 offen offset:1024 lds
    v_and_b32_e64 v35, s82, v151
    v_fma_f32 v28, v28, v26, v27
    v_fma_f32 v29, v29, v26, v27
    v_fma_f32 v30, v30, v26, v27
    v_mfma_f32_32x32x16_bf16 v[96:111], v[140:143], a[88:91], v[96:111]
    s_waitcnt lgkmcnt(4)
    ds_read_b64_tr_b16 a[72:73], v9 offset:4096
    ds_read_b64_tr_b16 a[74:75], v9 offset:4608
    buffer_load_dwordx4 v16, s[44:47], s55 offen offset:2048 lds
    v_fma_f32 v31, v31, v26, v27
    v_fma_f32 v32, v32, v26, v27
    v_fma_f32 v33, v33, v26, v27
    v_fma_f32 v34, v34, v26, v27
    v_fma_f32 v35, v35, v26, v27
    v_mfma_f32_32x32x16_bf16 v[112:127], v[140:143], a[92:95], v[112:127]
    s_waitcnt lgkmcnt(4)
    ds_read_b64_tr_b16 a[76:77], v9 offset:6144
    ds_read_b64_tr_b16 a[78:79], v9 offset:6656
    buffer_load_dwordx4 v17, s[44:47], s55 offen offset:3072 lds
    v_cvt_pk_bf16_f32 v148, v28, v29
    v_cvt_pk_bf16_f32 v149, v30, v31
    v_cvt_pk_bf16_f32 v150, v32, v33
    v_cvt_pk_bf16_f32 v151, v34, v35
    v_mfma_f32_32x32x16_bf16 v[64:79], v[144:147], a[64:67], v[64:79]
    s_waitcnt lgkmcnt(4)
    s_waitcnt vmcnt(20)
    s_barrier
    ds_read_b64_tr_b16 a[80:81], v10 offset:4096
    ds_read_b64_tr_b16 a[82:83], v10 offset:4608
    v_lshlrev_b32 v28, 16, v152
    v_and_b32 v29, s82, v152
    v_lshlrev_b32 v30, 16, v153
    v_and_b32_e64 v31, s82, v153
    v_lshlrev_b32 v32, 16, v154
    v_mfma_f32_32x32x16_bf16 v[80:95], v[144:147], a[68:71], v[80:95]
    s_waitcnt lgkmcnt(4)
    s_add_u32 m0, s53, 32768
    ds_read_b64_tr_b16 a[84:85], v10 offset:6144
    ds_read_b64_tr_b16 a[86:87], v10 offset:6656
    buffer_load_dwordx4 v18, s[8:11], s60 offen lds
    v_and_b32 v33, s82, v154
    v_lshlrev_b32 v34, 16, v155
    v_and_b32 v35, s82, v155
    v_fma_f32 v28, v28, v26, v27
    v_mfma_f32_32x32x16_bf16 v[96:111], v[144:147], a[72:75], v[96:111]
    s_waitcnt lgkmcnt(4)
    ds_read_b64_tr_b16 a[88:89], v11 offset:4096
    ds_read_b64_tr_b16 a[90:91], v11 offset:4608
    buffer_load_dwordx4 v19, s[8:11], s60 offen offset:1024 lds
    v_fma_f32 v29, v29, v26, v27
    v_fma_f32 v30, v30, v26, v27
    v_fma_f32 v31, v31, v26, v27
    v_fma_f32 v32, v32, v26, v27
    v_fma_f32 v33, v33, v26, v27
    v_fma_f32 v34, v34, v26, v27
    v_mfma_f32_32x32x16_bf16 v[112:127], v[144:147], a[76:79], v[112:127]
    s_waitcnt lgkmcnt(4)
    ds_read_b64_tr_b16 a[92:93], v11 offset:6144
    ds_read_b64_tr_b16 a[94:95], v11 offset:6656
    buffer_load_dwordx4 v18, s[12:15], s60 offen offset:2048 lds
    v_fma_f32 v35, v35, v26, v27
    v_cvt_pk_bf16_f32 v152, v28, v29
    v_cvt_pk_bf16_f32 v153, v30, v31
    v_cvt_pk_bf16_f32 v154, v32, v33
    v_cvt_pk_bf16_f32 v155, v34, v35
    v_mfma_f32_32x32x16_bf16 v[64:79], v[148:151], a[80:83], v[64:79]
    s_waitcnt lgkmcnt(4)
    ds_read_b64_tr_b16 a[64:65], v12 offset:4096
    ds_read_b64_tr_b16 a[66:67], v12 offset:4608
    v_lshlrev_b32 v28, 16, v156
    v_and_b32 v29, s82, v156
    v_lshlrev_b32 v30, 16, v157
    v_and_b32 v31, s82, v157
    v_lshlrev_b32_e64 v32, 16, v158
    v_and_b32 v33, s82, v158
    v_mfma_f32_32x32x16_bf16 v[80:95], v[148:151], a[84:87], v[80:95]
    s_waitcnt lgkmcnt(4)
    ds_read_b64_tr_b16 a[68:69], v12 offset:6144
    ds_read_b64_tr_b16 a[70:71], v12 offset:6656
    v_lshlrev_b32 v34, 16, v159
    v_and_b32 v35, s82, v159
    v_fma_f32 v28, v28, v26, v27
    v_fma_f32 v29, v29, v26, v27
    v_fma_f32 v30, v30, v26, v27
    v_mfma_f32_32x32x16_bf16 v[96:111], v[148:151], a[88:91], v[96:111]
    s_waitcnt lgkmcnt(4)
    ds_read_b64_tr_b16 a[72:73], v13 offset:4096
    ds_read_b64_tr_b16 a[74:75], v13 offset:4608
    buffer_load_dwordx4 v19, s[12:15], s60 offen offset:3072 lds
    v_fma_f32 v31, v31, v26, v27
    v_fma_f32 v32, v32, v26, v27
    v_fma_f32 v33, v33, v26, v27
    v_mfma_f32_32x32x16_bf16 v[112:127], v[148:151], a[92:95], v[112:127]
    s_waitcnt lgkmcnt(4)
    ds_read_b64_tr_b16 a[76:77], v13 offset:6144
    ds_read_b64_tr_b16 a[78:79], v13 offset:6656
    v_fma_f32 v34, v34, v26, v27
    v_fma_f32 v35, v35, v26, v27
    v_cvt_pk_bf16_f32 v156, v28, v29
    v_cvt_pk_bf16_f32 v157, v30, v31
    v_cvt_pk_bf16_f32 v158, v32, v33
    v_cvt_pk_bf16_f32 v159, v34, v35
    v_mfma_f32_32x32x16_bf16 v[64:79], v[152:155], a[64:67], v[64:79]
    s_waitcnt lgkmcnt(4)
    ds_read_b64_tr_b16 a[80:81], v14 offset:4096
    ds_read_b64_tr_b16 a[82:83], v14 offset:4608
    v_lshlrev_b32 v28, 16, v160
    v_and_b32 v29, s82, v160
    v_lshlrev_b32 v30, 16, v161
    v_and_b32 v31, s82, v161
    v_lshlrev_b32 v32, 16, v162
    v_and_b32 v33, s82, v162
    v_mfma_f32_32x32x16_bf16 v[80:95], v[152:155], a[68:71], v[80:95]
    s_waitcnt lgkmcnt(4)
    ds_read_b64_tr_b16 a[84:85], v14 offset:6144
    ds_read_b64_tr_b16 a[86:87], v14 offset:6656
    buffer_load_dword v58, v62, s[8:11], s1 offen
    v_lshlrev_b32_e64 v34, 16, v163
    v_and_b32 v35, s82, v163
    v_fma_f32 v28, v28, v26, v27
    v_fma_f32 v29, v29, v26, v27
    v_mfma_f32_32x32x16_bf16 v[96:111], v[152:155], a[72:75], v[96:111]
    s_waitcnt lgkmcnt(4)
    ds_read_b64_tr_b16 a[88:89], v15 offset:4096
    ds_read_b64_tr_b16 a[90:91], v15 offset:4608
    v_fma_f32 v30, v30, v26, v27
    v_fma_f32 v31, v31, v26, v27
    v_fma_f32 v32, v32, v26, v27
    v_fma_f32 v33, v33, v26, v27
    v_fma_f32 v34, v34, v26, v27
    v_fma_f32 v35, v35, v26, v27
    v_mfma_f32_32x32x16_bf16 v[112:127], v[152:155], a[76:79], v[112:127]
    s_waitcnt lgkmcnt(4)
    ds_read_b64_tr_b16 a[92:93], v15 offset:6144
    ds_read_b64_tr_b16 a[94:95], v15 offset:6656
    buffer_load_dword v59, v62, s[12:15], s49 offen
    v_cvt_pk_bf16_f32 v160, v28, v29
    v_cvt_pk_bf16_f32 v161, v30, v31
    v_cvt_pk_bf16_f32 v162, v32, v33
    v_cvt_pk_bf16_f32 v163, v34, v35
    v_mfma_f32_32x32x16_bf16 v[64:79], v[156:159], a[80:83], v[64:79]
    s_waitcnt lgkmcnt(4)
    ds_read_b64_tr_b16 a[64:65], v8 offset:8192
    ds_read_b64_tr_b16 a[66:67], v8 offset:8704
    v_lshlrev_b32 v28, 16, v164
    v_and_b32 v29, s82, v164
    v_lshlrev_b32 v30, 16, v165
    v_and_b32 v31, s82, v165
    v_lshlrev_b32_e64 v32, 16, v166
    v_and_b32 v33, s82, v166
    v_mfma_f32_32x32x16_bf16 v[80:95], v[156:159], a[84:87], v[80:95]
    s_waitcnt lgkmcnt(4)
    ds_read_b64_tr_b16 a[68:69], v8 offset:10240
    ds_read_b64_tr_b16 a[70:71], v8 offset:10752
    buffer_load_dword v7, v63, s[16:19], s50 offen
    v_lshlrev_b32_e64 v34, 16, v167
    v_and_b32 v35, s82, v167
    v_fma_f32 v28, v28, v26, v27
    v_fma_f32 v29, v29, v26, v27
    v_mfma_f32_32x32x16_bf16 v[96:111], v[156:159], a[88:91], v[96:111]
    s_waitcnt lgkmcnt(4)
    ds_read_b64_tr_b16 a[72:73], v9 offset:8192
    ds_read_b64_tr_b16 a[74:75], v9 offset:8704
    v_fma_f32 v30, v30, v26, v27
    v_fma_f32 v31, v31, v26, v27
    v_fma_f32 v32, v32, v26, v27
    v_fma_f32 v33, v33, v26, v27
    v_fma_f32 v34, v34, v26, v27
    v_fma_f32 v35, v35, v26, v27
    v_mfma_f32_32x32x16_bf16 v[112:127], v[156:159], a[92:95], v[112:127]
    s_waitcnt lgkmcnt(4)
    ds_read_b64_tr_b16 a[76:77], v9 offset:10240
    ds_read_b64_tr_b16 a[78:79], v9 offset:10752
    buffer_load_dword v25, v24, s[36:39], 0 offen sc1
    v_cvt_pk_bf16_f32 v164, v28, v29
    v_cvt_pk_bf16_f32 v165, v30, v31
    v_cvt_pk_bf16_f32 v166, v32, v33
    v_cvt_pk_bf16_f32 v167, v34, v35
    v_mfma_f32_32x32x16_bf16 v[64:79], v[160:163], a[64:67], v[64:79]
    s_waitcnt lgkmcnt(4)
    s_waitcnt vmcnt(24)
    s_barrier
    ds_read_b64_tr_b16 a[80:81], v10 offset:8192
    ds_read_b64_tr_b16 a[82:83], v10 offset:8704
    v_lshlrev_b32 v28, 16, v168
    v_and_b32 v29, s82, v168
    v_lshlrev_b32_e64 v30, 16, v169
    v_and_b32 v31, s82, v169
    v_mfma_f32_32x32x16_bf16 v[80:95], v[160:163], a[68:71], v[80:95]
    s_waitcnt lgkmcnt(4)
    ds_read_b64_tr_b16 a[84:85], v10 offset:10240
    ds_read_b64_tr_b16 a[86:87], v10 offset:10752
    buffer_load_ushort v42, v40, s[20:23], s72 offen
    v_lshlrev_b32 v32, 16, v170
    v_and_b32 v33, s82, v170
    v_lshlrev_b32_e64 v34, 16, v171
    v_and_b32 v35, s82, v171
    v_mfma_f32_32x32x16_bf16 v[96:111], v[160:163], a[72:75], v[96:111]
    s_waitcnt lgkmcnt(4)
    ds_read_b64_tr_b16 a[88:89], v11 offset:8192
    ds_read_b64_tr_b16 a[90:91], v11 offset:8704
    v_fma_f32 v28, v28, v26, v27
    v_fma_f32 v29, v29, v26, v27
    v_fma_f32 v30, v30, v26, v27
    v_fma_f32 v31, v31, v26, v27
    v_fma_f32 v32, v32, v26, v27
    v_fma_f32 v33, v33, v26, v27
    v_fma_f32 v34, v34, v26, v27
    v_mfma_f32_32x32x16_bf16 v[112:127], v[160:163], a[76:79], v[112:127]
    s_waitcnt lgkmcnt(4)
    ds_read_b64_tr_b16 a[92:93], v11 offset:10240
    ds_read_b64_tr_b16 a[94:95], v11 offset:10752
    buffer_load_ushort v50, v40, s[24:27], s72 offen
    v_fma_f32 v35, v35, v26, v27
    v_cvt_pk_bf16_f32 v168, v28, v29
    v_cvt_pk_bf16_f32 v169, v30, v31
    v_cvt_pk_bf16_f32 v170, v32, v33
    v_cvt_pk_bf16_f32 v171, v34, v35
    v_mfma_f32_32x32x16_bf16 v[64:79], v[164:167], a[80:83], v[64:79]
    s_waitcnt lgkmcnt(4)
    ds_read_b64_tr_b16 a[64:65], v12 offset:8192
    ds_read_b64_tr_b16 a[66:67], v12 offset:8704
    v_lshlrev_b32 v28, 16, v172
    v_and_b32 v29, s82, v172
    v_lshlrev_b32 v30, 16, v173
    v_and_b32 v31, s82, v173
    v_lshlrev_b32_e64 v32, 16, v174
    v_and_b32 v33, s82, v174
    v_mfma_f32_32x32x16_bf16 v[80:95], v[164:167], a[84:87], v[80:95]
    s_waitcnt lgkmcnt(4)
    ds_read_b64_tr_b16 a[68:69], v12 offset:10240
    ds_read_b64_tr_b16 a[70:71], v12 offset:10752
    buffer_load_ushort v43, v40, s[20:23], s72 offen offset:514
    v_lshlrev_b32_e64 v34, 16, v175
    v_and_b32 v35, s82, v175
    v_fma_f32 v28, v28, v26, v27
    v_fma_f32 v29, v29, v26, v27
    v_mfma_f32_32x32x16_bf16 v[96:111], v[164:167], a[88:91], v[96:111]
    s_waitcnt lgkmcnt(4)
    ds_read_b64_tr_b16 a[72:73], v13 offset:8192
    ds_read_b64_tr_b16 a[74:75], v13 offset:8704
    v_fma_f32 v30, v30, v26, v27
    v_fma_f32 v31, v31, v26, v27
    v_fma_f32 v32, v32, v26, v27
    v_fma_f32 v33, v33, v26, v27
    v_fma_f32 v34, v34, v26, v27
    v_fma_f32 v35, v35, v26, v27
    v_mfma_f32_32x32x16_bf16 v[112:127], v[164:167], a[92:95], v[112:127]
    s_waitcnt lgkmcnt(4)
    ds_read_b64_tr_b16 a[76:77], v13 offset:10240
    ds_read_b64_tr_b16 a[78:79], v13 offset:10752
    buffer_load_ushort v51, v40, s[24:27], s72 offen offset:514
    v_cvt_pk_bf16_f32 v172, v28, v29
    v_cvt_pk_bf16_f32 v173, v30, v31
    v_cvt_pk_bf16_f32 v174, v32, v33
    v_cvt_pk_bf16_f32 v175, v34, v35
    v_mfma_f32_32x32x16_bf16 v[64:79], v[168:171], a[64:67], v[64:79]
    s_waitcnt lgkmcnt(4)
    ds_read_b64_tr_b16 a[80:81], v14 offset:8192
    ds_read_b64_tr_b16 a[82:83], v14 offset:8704
    v_lshlrev_b32 v28, 16, v176
    v_and_b32 v29, s82, v176
    v_lshlrev_b32 v30, 16, v177
    v_and_b32 v31, s82, v177
    v_lshlrev_b32_e64 v32, 16, v178
    v_and_b32 v33, s82, v178
    v_mfma_f32_32x32x16_bf16 v[80:95], v[168:171], a[68:71], v[80:95]
    s_waitcnt lgkmcnt(4)
    ds_read_b64_tr_b16 a[84:85], v14 offset:10240
    ds_read_b64_tr_b16 a[86:87], v14 offset:10752
    buffer_load_ushort v44, v40, s[20:23], s72 offen offset:1028
    v_lshlrev_b32_e64 v34, 16, v179
    v_and_b32 v35, s82, v179
    v_fma_f32 v28, v28, v26, v27
    v_fma_f32 v29, v29, v26, v27
    v_mfma_f32_32x32x16_bf16 v[96:111], v[168:171], a[72:75], v[96:111]
    s_waitcnt lgkmcnt(4)
    ds_read_b64_tr_b16 a[88:89], v15 offset:8192
    ds_read_b64_tr_b16 a[90:91], v15 offset:8704
    v_fma_f32 v30, v30, v26, v27
    v_fma_f32 v31, v31, v26, v27
    v_fma_f32 v32, v32, v26, v27
    v_fma_f32 v33, v33, v26, v27
    v_fma_f32 v34, v34, v26, v27
    v_fma_f32 v35, v35, v26, v27
    v_mfma_f32_32x32x16_bf16 v[112:127], v[168:171], a[76:79], v[112:127]
    s_waitcnt lgkmcnt(4)
    ds_read_b64_tr_b16 a[92:93], v15 offset:10240
    ds_read_b64_tr_b16 a[94:95], v15 offset:10752
    buffer_load_ushort v52, v40, s[24:27], s72 offen offset:1028
    v_cvt_pk_bf16_f32 v176, v28, v29
    v_cvt_pk_bf16_f32 v177, v30, v31
    v_cvt_pk_bf16_f32 v178, v32, v33
    v_cvt_pk_bf16_f32 v179, v34, v35
    v_mfma_f32_32x32x16_bf16 v[64:79], v[172:175], a[80:83], v[64:79]
    s_waitcnt lgkmcnt(4)
    ds_read_b64_tr_b16 a[64:65], v8 offset:12288
    ds_read_b64_tr_b16 a[66:67], v8 offset:12800
    v_lshlrev_b32 v28, 16, v180
    v_and_b32 v29, s82, v180
    v_lshlrev_b32 v30, 16, v181
    v_and_b32 v31, s82, v181
    v_lshlrev_b32_e64 v32, 16, v182
    v_and_b32 v33, s82, v182
    v_mfma_f32_32x32x16_bf16 v[80:95], v[172:175], a[84:87], v[80:95]
    s_waitcnt lgkmcnt(4)
    ds_read_b64_tr_b16 a[68:69], v8 offset:14336
    ds_read_b64_tr_b16 a[70:71], v8 offset:14848
    buffer_load_ushort v45, v40, s[20:23], s72 offen offset:1542
    v_lshlrev_b32_e64 v34, 16, v183
    v_and_b32 v35, s82, v183
    v_fma_f32 v28, v28, v26, v27
    v_fma_f32 v29, v29, v26, v27
    v_mfma_f32_32x32x16_bf16 v[96:111], v[172:175], a[88:91], v[96:111]
    s_waitcnt lgkmcnt(4)
    ds_read_b64_tr_b16 a[72:73], v9 offset:12288
    ds_read_b64_tr_b16 a[74:75], v9 offset:12800
    v_fma_f32 v30, v30, v26, v27
    v_fma_f32 v31, v31, v26, v27
    v_fma_f32 v32, v32, v26, v27
    v_fma_f32 v33, v33, v26, v27
    v_fma_f32 v34, v34, v26, v27
    v_fma_f32 v35, v35, v26, v27
    v_mfma_f32_32x32x16_bf16 v[112:127], v[172:175], a[92:95], v[112:127]
    s_waitcnt lgkmcnt(4)
    ds_read_b64_tr_b16 a[76:77], v9 offset:14336
    ds_read_b64_tr_b16 a[78:79], v9 offset:14848
    buffer_load_ushort v53, v40, s[24:27], s72 offen offset:1542
    v_cvt_pk_bf16_f32 v180, v28, v29
    v_cvt_pk_bf16_f32 v181, v30, v31
    v_cvt_pk_bf16_f32 v182, v32, v33
    v_cvt_pk_bf16_f32 v183, v34, v35
    v_mfma_f32_32x32x16_bf16 v[64:79], v[176:179], a[64:67], v[64:79]
    s_waitcnt lgkmcnt(4)
    s_waitcnt vmcnt(28)
    s_barrier
    ds_read_b64_tr_b16 a[80:81], v10 offset:12288
    ds_read_b64_tr_b16 a[82:83], v10 offset:12800
    v_lshlrev_b32 v28, 16, v184
    v_and_b32 v29, s82, v184
    v_lshlrev_b32_e64 v30, 16, v185
    v_and_b32 v31, s82, v185
    v_mfma_f32_32x32x16_bf16 v[80:95], v[176:179], a[68:71], v[80:95]
    s_waitcnt lgkmcnt(4)
    ds_read_b64_tr_b16 a[84:85], v10 offset:14336
    ds_read_b64_tr_b16 a[86:87], v10 offset:14848
    buffer_load_ushort v46, v40, s[20:23], s73 offen
    v_lshlrev_b32 v32, 16, v186
    v_and_b32 v33, s82, v186
    v_lshlrev_b32_e64 v34, 16, v187
    v_and_b32 v35, s82, v187
    v_mfma_f32_32x32x16_bf16 v[96:111], v[176:179], a[72:75], v[96:111]
    s_waitcnt lgkmcnt(4)
    ds_read_b64_tr_b16 a[88:89], v11 offset:12288
    ds_read_b64_tr_b16 a[90:91], v11 offset:12800
    v_fma_f32 v28, v28, v26, v27
    v_fma_f32 v29, v29, v26, v27
    v_fma_f32 v30, v30, v26, v27
    v_fma_f32 v31, v31, v26, v27
    v_fma_f32 v32, v32, v26, v27
    v_fma_f32 v33, v33, v26, v27
    v_fma_f32 v34, v34, v26, v27
    v_mfma_f32_32x32x16_bf16 v[112:127], v[176:179], a[76:79], v[112:127]
    s_waitcnt lgkmcnt(4)
    ds_read_b64_tr_b16 a[92:93], v11 offset:14336
    ds_read_b64_tr_b16 a[94:95], v11 offset:14848
    buffer_load_ushort v54, v40, s[24:27], s73 offen
    v_fma_f32 v35, v35, v26, v27
    v_cvt_pk_bf16_f32 v184, v28, v29
    v_cvt_pk_bf16_f32 v185, v30, v31
    v_cvt_pk_bf16_f32 v186, v32, v33
    v_cvt_pk_bf16_f32 v187, v34, v35
    v_mfma_f32_32x32x16_bf16 v[64:79], v[180:183], a[80:83], v[64:79]
    s_waitcnt lgkmcnt(4)
    ds_read_b64_tr_b16 a[64:65], v12 offset:12288
    ds_read_b64_tr_b16 a[66:67], v12 offset:12800
    v_lshlrev_b32 v28, 16, v188
    v_and_b32 v29, s82, v188
    v_lshlrev_b32 v30, 16, v189
    v_and_b32 v31, s82, v189
    v_lshlrev_b32_e64 v32, 16, v190
    v_and_b32 v33, s82, v190
    v_mfma_f32_32x32x16_bf16 v[80:95], v[180:183], a[84:87], v[80:95]
    s_waitcnt lgkmcnt(4)
    ds_read_b64_tr_b16 a[68:69], v12 offset:14336
    ds_read_b64_tr_b16 a[70:71], v12 offset:14848
    buffer_load_ushort v47, v40, s[20:23], s73 offen offset:514
    v_lshlrev_b32_e64 v34, 16, v191
    v_and_b32 v35, s82, v191
    v_fma_f32 v28, v28, v26, v27
    v_fma_f32 v29, v29, v26, v27
    v_mfma_f32_32x32x16_bf16 v[96:111], v[180:183], a[88:91], v[96:111]
    s_waitcnt lgkmcnt(4)
    ds_read_b64_tr_b16 a[72:73], v13 offset:12288
    ds_read_b64_tr_b16 a[74:75], v13 offset:12800
    v_fma_f32 v30, v30, v26, v27
    v_fma_f32 v31, v31, v26, v27
    v_fma_f32 v32, v32, v26, v27
    v_fma_f32 v33, v33, v26, v27
    v_fma_f32 v34, v34, v26, v27
    v_fma_f32 v35, v35, v26, v27
    v_mfma_f32_32x32x16_bf16 v[112:127], v[180:183], a[92:95], v[112:127]
    s_waitcnt lgkmcnt(4)
    ds_read_b64_tr_b16 a[76:77], v13 offset:14336
    ds_read_b64_tr_b16 a[78:79], v13 offset:14848
    buffer_load_ushort v55, v40, s[24:27], s73 offen offset:514
    v_cvt_pk_bf16_f32 v188, v28, v29
    v_cvt_pk_bf16_f32 v189, v30, v31
    v_cvt_pk_bf16_f32 v190, v32, v33
    v_cvt_pk_bf16_f32 v191, v34, v35
    v_mfma_f32_32x32x16_bf16 v[64:79], v[184:187], a[64:67], v[64:79]
    s_waitcnt lgkmcnt(4)
    ds_read_b64_tr_b16 a[80:81], v14 offset:12288
    ds_read_b64_tr_b16 a[82:83], v14 offset:12800
    v_lshlrev_b32 v28, 16, v192
    v_and_b32 v29, s82, v192
    v_lshlrev_b32 v30, 16, v193
    v_and_b32 v31, s82, v193
    v_lshlrev_b32_e64 v32, 16, v194
    v_and_b32 v33, s82, v194
    v_mfma_f32_32x32x16_bf16 v[80:95], v[184:187], a[68:71], v[80:95]
    s_waitcnt lgkmcnt(4)
    ds_read_b64_tr_b16 a[84:85], v14 offset:14336
    ds_read_b64_tr_b16 a[86:87], v14 offset:14848
    buffer_load_ushort v48, v40, s[20:23], s73 offen offset:1028
    v_lshlrev_b32_e64 v34, 16, v195
    v_and_b32 v35, s82, v195
    v_fma_f32 v28, v28, v26, v27
    v_fma_f32 v29, v29, v26, v27
    v_mfma_f32_32x32x16_bf16 v[96:111], v[184:187], a[72:75], v[96:111]
    s_waitcnt lgkmcnt(4)
    ds_read_b64_tr_b16 a[88:89], v15 offset:12288
    ds_read_b64_tr_b16 a[90:91], v15 offset:12800
    v_fma_f32 v30, v30, v26, v27
    v_fma_f32 v31, v31, v26, v27
    v_fma_f32 v32, v32, v26, v27
    v_fma_f32 v33, v33, v26, v27
    v_fma_f32 v34, v34, v26, v27
    v_fma_f32 v35, v35, v26, v27
    v_mfma_f32_32x32x16_bf16 v[112:127], v[184:187], a[76:79], v[112:127]
    s_waitcnt lgkmcnt(4)
    ds_read_b64_tr_b16 a[92:93], v15 offset:14336
    ds_read_b64_tr_b16 a[94:95], v15 offset:14848
    buffer_load_ushort v56, v40, s[24:27], s73 offen offset:1028
    v_cvt_pk_bf16_f32 v192, v28, v29
    v_cvt_pk_bf16_f32 v193, v30, v31
    v_cvt_pk_bf16_f32 v194, v32, v33
    v_cvt_pk_bf16_f32 v195, v34, v35
    v_mfma_f32_32x32x16_bf16 v[64:79], v[188:191], a[80:83], v[64:79]
    s_waitcnt lgkmcnt(4)
    ds_read_b64_tr_b16 a[64:65], v8 offset:16384
    ds_read_b64_tr_b16 a[66:67], v8 offset:16896
    v_lshlrev_b32 v28, 16, v196
    v_and_b32 v29, s82, v196
    v_lshlrev_b32 v30, 16, v197
    v_and_b32 v31, s82, v197
    v_lshlrev_b32_e64 v32, 16, v198
    v_and_b32 v33, s82, v198
    v_mfma_f32_32x32x16_bf16 v[80:95], v[188:191], a[84:87], v[80:95]
    s_waitcnt lgkmcnt(4)
    ds_read_b64_tr_b16 a[68:69], v8 offset:18432
    ds_read_b64_tr_b16 a[70:71], v8 offset:18944
    buffer_load_ushort v49, v40, s[20:23], s73 offen offset:1542
    v_lshlrev_b32_e64 v34, 16, v199
    v_and_b32 v35, s82, v199
    v_fma_f32 v28, v28, v26, v27
    v_fma_f32 v29, v29, v26, v27
    v_mfma_f32_32x32x16_bf16 v[96:111], v[188:191], a[88:91], v[96:111]
    s_waitcnt lgkmcnt(4)
    ds_read_b64_tr_b16 a[72:73], v9 offset:16384
    ds_read_b64_tr_b16 a[74:75], v9 offset:16896
    v_fma_f32 v30, v30, v26, v27
    v_fma_f32 v31, v31, v26, v27
    v_fma_f32 v32, v32, v26, v27
    v_fma_f32 v33, v33, v26, v27
    v_fma_f32 v34, v34, v26, v27
    v_fma_f32 v35, v35, v26, v27
    v_mfma_f32_32x32x16_bf16 v[112:127], v[188:191], a[92:95], v[112:127]
    s_waitcnt lgkmcnt(4)
    ds_read_b64_tr_b16 a[76:77], v9 offset:18432
    ds_read_b64_tr_b16 a[78:79], v9 offset:18944
    buffer_load_ushort v57, v40, s[24:27], s73 offen offset:1542
    v_cvt_pk_bf16_f32 v196, v28, v29
    v_cvt_pk_bf16_f32 v197, v30, v31
    v_cvt_pk_bf16_f32 v198, v32, v33
    v_cvt_pk_bf16_f32 v199, v34, v35
    v_mfma_f32_32x32x16_bf16 v[64:79], v[192:195], a[64:67], v[64:79]
    s_waitcnt lgkmcnt(4)
    s_waitcnt vmcnt(32)
    s_barrier
    ds_read_b64_tr_b16 a[80:81], v10 offset:16384
    ds_read_b64_tr_b16 a[82:83], v10 offset:16896
    v_lshlrev_b32 v28, 16, v200
    v_and_b32 v29, s82, v200
    v_lshlrev_b32_e64 v30, 16, v201
    v_and_b32 v31, s82, v201
    v_mfma_f32_32x32x16_bf16 v[80:95], v[192:195], a[68:71], v[80:95]
    s_waitcnt lgkmcnt(4)
    s_mov_b32 s0, 524288
    ds_read_b64_tr_b16 a[84:85], v10 offset:18432
    ds_read_b64_tr_b16 a[86:87], v10 offset:18944
    buffer_load_dwordx4 a[120:123], v2, s[40:43], s0 offen
    v_lshlrev_b32 v32, 16, v202
    v_and_b32 v33, s82, v202
    v_lshlrev_b32_e64 v34, 16, v203
    v_and_b32 v35, s82, v203
    v_mfma_f32_32x32x16_bf16 v[96:111], v[192:195], a[72:75], v[96:111]
    s_waitcnt lgkmcnt(4)
    ds_read_b64_tr_b16 a[88:89], v11 offset:16384
    ds_read_b64_tr_b16 a[90:91], v11 offset:16896
    v_fma_f32 v28, v28, v26, v27
    v_fma_f32 v29, v29, v26, v27
    v_fma_f32 v30, v30, v26, v27
    v_fma_f32 v31, v31, v26, v27
    v_fma_f32 v32, v32, v26, v27
    v_fma_f32 v33, v33, v26, v27
    v_fma_f32 v34, v34, v26, v27
    v_mfma_f32_32x32x16_bf16 v[112:127], v[192:195], a[76:79], v[112:127]
    s_waitcnt lgkmcnt(4)
    ds_read_b64_tr_b16 a[92:93], v11 offset:18432
    ds_read_b64_tr_b16 a[94:95], v11 offset:18944
    buffer_load_dwordx4 a[124:127], v2, s[40:43], s0 offen offset:1024
    v_fma_f32 v35, v35, v26, v27
    v_cvt_pk_bf16_f32 v200, v28, v29
    v_cvt_pk_bf16_f32 v201, v30, v31
    v_cvt_pk_bf16_f32 v202, v32, v33
    v_cvt_pk_bf16_f32 v203, v34, v35
    v_mfma_f32_32x32x16_bf16 v[64:79], v[196:199], a[80:83], v[64:79]
    s_waitcnt lgkmcnt(4)
    ds_read_b64_tr_b16 a[64:65], v12 offset:16384
    ds_read_b64_tr_b16 a[66:67], v12 offset:16896
    v_lshlrev_b32 v28, 16, v204
    v_and_b32 v29, s82, v204
    v_lshlrev_b32 v30, 16, v205
    v_and_b32 v31, s82, v205
    v_lshlrev_b32_e64 v32, 16, v206
    v_and_b32 v33, s82, v206
    v_mfma_f32_32x32x16_bf16 v[80:95], v[196:199], a[84:87], v[80:95]
    s_waitcnt lgkmcnt(4)
    ds_read_b64_tr_b16 a[68:69], v12 offset:18432
    ds_read_b64_tr_b16 a[70:71], v12 offset:18944
    buffer_load_dwordx4 a[128:131], v2, s[40:43], s0 offen offset:2048
    v_lshlrev_b32_e64 v34, 16, v207
    v_and_b32 v35, s82, v207
    v_fma_f32 v28, v28, v26, v27
    v_fma_f32 v29, v29, v26, v27
    v_mfma_f32_32x32x16_bf16 v[96:111], v[196:199], a[88:91], v[96:111]
    s_waitcnt lgkmcnt(4)
    ds_read_b64_tr_b16 a[72:73], v13 offset:16384
    ds_read_b64_tr_b16 a[74:75], v13 offset:16896
    v_fma_f32 v30, v30, v26, v27
    v_fma_f32 v31, v31, v26, v27
    v_fma_f32 v32, v32, v26, v27
    v_fma_f32 v33, v33, v26, v27
    v_fma_f32 v34, v34, v26, v27
    v_fma_f32 v35, v35, v26, v27
    v_mfma_f32_32x32x16_bf16 v[112:127], v[196:199], a[92:95], v[112:127]
    s_waitcnt lgkmcnt(4)
    ds_read_b64_tr_b16 a[76:77], v13 offset:18432
    ds_read_b64_tr_b16 a[78:79], v13 offset:18944
    buffer_load_dwordx4 a[132:135], v2, s[40:43], s0 offen offset:3072
    v_cvt_pk_bf16_f32 v204, v28, v29
    v_cvt_pk_bf16_f32 v205, v30, v31
    v_cvt_pk_bf16_f32 v206, v32, v33
    v_cvt_pk_bf16_f32 v207, v34, v35
    v_mfma_f32_32x32x16_bf16 v[64:79], v[200:203], a[64:67], v[64:79]
    s_waitcnt lgkmcnt(4)
    ds_read_b64_tr_b16 a[80:81], v14 offset:16384
    ds_read_b64_tr_b16 a[82:83], v14 offset:16896
    v_lshlrev_b32 v28, 16, v208
    v_and_b32 v29, s82, v208
    v_lshlrev_b32 v30, 16, v209
    v_and_b32 v31, s82, v209
    v_lshlrev_b32 v32, 16, v210
    v_and_b32 v33, s82, v210
    v_lshlrev_b32 v34, 16, v211
    v_mfma_f32_32x32x16_bf16 v[80:95], v[200:203], a[68:71], v[80:95]
    s_waitcnt lgkmcnt(4)
    s_mov_b32 s0, 528384
    ds_read_b64_tr_b16 a[84:85], v14 offset:18432
    ds_read_b64_tr_b16 a[86:87], v14 offset:18944
    buffer_load_dwordx4 a[136:139], v2, s[40:43], s0 offen
    v_and_b32 v35, s82, v211
    v_fma_f32 v28, v28, v26, v27
    v_fma_f32 v29, v29, v26, v27
    v_mfma_f32_32x32x16_bf16 v[96:111], v[200:203], a[72:75], v[96:111]
    s_waitcnt lgkmcnt(4)
    ds_read_b64_tr_b16 a[88:89], v15 offset:16384
    ds_read_b64_tr_b16 a[90:91], v15 offset:16896
    v_fma_f32 v30, v30, v26, v27
    v_fma_f32 v31, v31, v26, v27
    v_fma_f32 v32, v32, v26, v27
    v_fma_f32 v33, v33, v26, v27
    v_fma_f32 v34, v34, v26, v27
    v_fma_f32 v35, v35, v26, v27
    v_mfma_f32_32x32x16_bf16 v[112:127], v[200:203], a[76:79], v[112:127]
    s_waitcnt lgkmcnt(4)
    ds_read_b64_tr_b16 a[92:93], v15 offset:18432
    ds_read_b64_tr_b16 a[94:95], v15 offset:18944
    buffer_load_dwordx4 a[140:143], v2, s[40:43], s0 offen offset:1024
    v_cvt_pk_bf16_f32 v208, v28, v29
    v_cvt_pk_bf16_f32 v209, v30, v31
    v_cvt_pk_bf16_f32 v210, v32, v33
    v_cvt_pk_bf16_f32 v211, v34, v35
    v_mfma_f32_32x32x16_bf16 v[64:79], v[204:207], a[80:83], v[64:79]
    s_waitcnt lgkmcnt(4)
    ds_read_b64_tr_b16 a[64:65], v8 offset:20480
    ds_read_b64_tr_b16 a[66:67], v8 offset:20992
    v_lshlrev_b32 v28, 16, v212
    v_and_b32 v29, s82, v212
    v_lshlrev_b32 v30, 16, v213
    v_and_b32 v31, s82, v213
    v_lshlrev_b32 v32, 16, v214
    v_mfma_f32_32x32x16_bf16 v[80:95], v[204:207], a[84:87], v[80:95]
    s_waitcnt lgkmcnt(4)
    ds_read_b64_tr_b16 a[68:69], v8 offset:22528
    ds_read_b64_tr_b16 a[70:71], v8 offset:23040
    v_and_b32 v33, s82, v214
    v_lshlrev_b32 v34, 16, v215
    v_and_b32_e64 v35, s82, v215
    v_fma_f32 v28, v28, v26, v27
    v_fma_f32 v29, v29, v26, v27
    v_mfma_f32_32x32x16_bf16 v[96:111], v[204:207], a[88:91], v[96:111]
    s_waitcnt lgkmcnt(4)
    ds_read_b64_tr_b16 a[72:73], v9 offset:20480
    ds_read_b64_tr_b16 a[74:75], v9 offset:20992
    v_fma_f32 v30, v30, v26, v27
    v_fma_f32 v31, v31, v26, v27
    v_fma_f32 v32, v32, v26, v27
    v_fma_f32 v33, v33, v26, v27
    v_fma_f32 v34, v34, v26, v27
    v_mfma_f32_32x32x16_bf16 v[112:127], v[204:207], a[92:95], v[112:127]
    s_waitcnt lgkmcnt(4)
    ds_read_b64_tr_b16 a[76:77], v9 offset:22528
    ds_read_b64_tr_b16 a[78:79], v9 offset:23040
    v_fma_f32 v35, v35, v26, v27
    v_cvt_pk_bf16_f32 v212, v28, v29
    v_cvt_pk_bf16_f32 v213, v30, v31
    v_cvt_pk_bf16_f32 v214, v32, v33
    v_cvt_pk_bf16_f32 v215, v34, v35
    v_mfma_f32_32x32x16_bf16 v[64:79], v[208:211], a[64:67], v[64:79]
    s_waitcnt lgkmcnt(4)
    s_waitcnt vmcnt(34)
    s_barrier
    ds_read_b64_tr_b16 a[80:81], v10 offset:20480
    ds_read_b64_tr_b16 a[82:83], v10 offset:20992
    v_lshlrev_b32 v28, 16, v216
    v_and_b32 v29, s82, v216
    v_mfma_f32_32x32x16_bf16 v[80:95], v[208:211], a[68:71], v[80:95]
    s_waitcnt lgkmcnt(4)
    ds_read_b64_tr_b16 a[84:85], v10 offset:22528
    ds_read_b64_tr_b16 a[86:87], v10 offset:23040
    v_lshlrev_b32 v30, 16, v217
    v_and_b32 v31, s82, v217
    v_lshlrev_b32 v32, 16, v218
    v_and_b32 v33, s82, v218
    v_lshlrev_b32_e64 v34, 16, v219
    v_and_b32 v35, s82, v219
    v_mfma_f32_32x32x16_bf16 v[96:111], v[208:211], a[72:75], v[96:111]
    s_waitcnt lgkmcnt(4)
    ds_read_b64_tr_b16 a[88:89], v11 offset:20480
    ds_read_b64_tr_b16 a[90:91], v11 offset:20992
    v_fma_f32 v28, v28, v26, v27
    v_fma_f32 v29, v29, v26, v27
    v_fma_f32 v30, v30, v26, v27
    v_fma_f32 v31, v31, v26, v27
    v_fma_f32 v32, v32, v26, v27
    v_fma_f32 v33, v33, v26, v27
    v_mfma_f32_32x32x16_bf16 v[112:127], v[208:211], a[76:79], v[112:127]
    s_waitcnt lgkmcnt(4)
    ds_read_b64_tr_b16 a[92:93], v11 offset:22528
    ds_read_b64_tr_b16 a[94:95], v11 offset:23040
    v_fma_f32 v34, v34, v26, v27
    v_fma_f32 v35, v35, v26, v27
    v_cvt_pk_bf16_f32 v216, v28, v29
    v_cvt_pk_bf16_f32 v217, v30, v31
    v_cvt_pk_bf16_f32 v218, v32, v33
    v_cvt_pk_bf16_f32 v219, v34, v35
    v_mfma_f32_32x32x16_bf16 v[64:79], v[212:215], a[80:83], v[64:79]
    s_waitcnt lgkmcnt(4)
    ds_read_b64_tr_b16 a[64:65], v12 offset:20480
    ds_read_b64_tr_b16 a[66:67], v12 offset:20992
    v_lshlrev_b32 v28, 16, v220
    v_and_b32 v29, s82, v220
    v_lshlrev_b32 v30, 16, v221
    v_and_b32 v31, s82, v221
    v_lshlrev_b32 v32, 16, v222
    v_mfma_f32_32x32x16_bf16 v[80:95], v[212:215], a[84:87], v[80:95]
    s_waitcnt lgkmcnt(4)
    ds_read_b64_tr_b16 a[68:69], v12 offset:22528
    ds_read_b64_tr_b16 a[70:71], v12 offset:23040
    v_and_b32 v33, s82, v222
    v_lshlrev_b32 v34, 16, v223
    v_and_b32_e64 v35, s82, v223
    v_fma_f32 v28, v28, v26, v27
    v_fma_f32 v29, v29, v26, v27
    v_mfma_f32_32x32x16_bf16 v[96:111], v[212:215], a[88:91], v[96:111]
    s_waitcnt lgkmcnt(4)
    ds_read_b64_tr_b16 a[72:73], v13 offset:20480
    ds_read_b64_tr_b16 a[74:75], v13 offset:20992
    v_fma_f32 v30, v30, v26, v27
    v_fma_f32 v31, v31, v26, v27
    v_fma_f32 v32, v32, v26, v27
    v_fma_f32 v33, v33, v26, v27
    v_fma_f32 v34, v34, v26, v27
    v_mfma_f32_32x32x16_bf16 v[112:127], v[212:215], a[92:95], v[112:127]
    s_waitcnt lgkmcnt(4)
    ds_read_b64_tr_b16 a[76:77], v13 offset:22528
    ds_read_b64_tr_b16 a[78:79], v13 offset:23040
    v_fma_f32 v35, v35, v26, v27
    v_cvt_pk_bf16_f32 v220, v28, v29
    v_cvt_pk_bf16_f32 v221, v30, v31
    v_cvt_pk_bf16_f32 v222, v32, v33
    v_cvt_pk_bf16_f32 v223, v34, v35
    v_mfma_f32_32x32x16_bf16 v[64:79], v[216:219], a[64:67], v[64:79]
    s_waitcnt lgkmcnt(4)
    ds_read_b64_tr_b16 a[80:81], v14 offset:20480
    ds_read_b64_tr_b16 a[82:83], v14 offset:20992
    v_lshlrev_b32 v28, 16, v224
    v_and_b32 v29, s82, v224
    v_lshlrev_b32 v30, 16, v225
    v_and_b32_e64 v31, s82, v225
    v_lshlrev_b32 v32, 16, v226
    v_mfma_f32_32x32x16_bf16 v[80:95], v[216:219], a[68:71], v[80:95]
    s_waitcnt lgkmcnt(4)
    ds_read_b64_tr_b16 a[84:85], v14 offset:22528
    ds_read_b64_tr_b16 a[86:87], v14 offset:23040
    v_and_b32 v33, s82, v226
    v_lshlrev_b32 v34, 16, v227
    v_and_b32_e64 v35, s82, v227
    v_fma_f32 v28, v28, v26, v27
    v_fma_f32 v29, v29, v26, v27
    v_mfma_f32_32x32x16_bf16 v[96:111], v[216:219], a[72:75], v[96:111]
    s_waitcnt lgkmcnt(4)
    ds_read_b64_tr_b16 a[88:89], v15 offset:20480
    ds_read_b64_tr_b16 a[90:91], v15 offset:20992
    v_fma_f32 v30, v30, v26, v27
    v_fma_f32 v31, v31, v26, v27
    v_fma_f32 v32, v32, v26, v27
    v_fma_f32 v33, v33, v26, v27
    v_fma_f32 v34, v34, v26, v27
    v_mfma_f32_32x32x16_bf16 v[112:127], v[216:219], a[76:79], v[112:127]
    s_waitcnt lgkmcnt(4)
    ds_read_b64_tr_b16 a[92:93], v15 offset:22528
    ds_read_b64_tr_b16 a[94:95], v15 offset:23040
    v_fma_f32 v35, v35, v26, v27
    v_cvt_pk_bf16_f32 v224, v28, v29
    v_cvt_pk_bf16_f32 v225, v30, v31
    v_cvt_pk_bf16_f32 v226, v32, v33
    v_cvt_pk_bf16_f32 v227, v34, v35
    v_mfma_f32_32x32x16_bf16 v[64:79], v[220:223], a[80:83], v[64:79]
    s_waitcnt lgkmcnt(4)
    ds_read_b64_tr_b16 a[64:65], v8 offset:24576
    ds_read_b64_tr_b16 a[66:67], v8 offset:25088
    v_lshlrev_b32 v28, 16, v228
    v_and_b32 v29, s82, v228
    v_lshlrev_b32 v30, 16, v229
    v_and_b32_e64 v31, s82, v229
    v_lshlrev_b32 v32, 16, v230
    v_mfma_f32_32x32x16_bf16 v[80:95], v[220:223], a[84:87], v[80:95]
    s_waitcnt lgkmcnt(4)
    ds_read_b64_tr_b16 a[68:69], v8 offset:26624
    ds_read_b64_tr_b16 a[70:71], v8 offset:27136
    v_and_b32 v33, s82, v230
    v_lshlrev_b32 v34, 16, v231
    v_and_b32_e64 v35, s82, v231
    v_fma_f32 v28, v28, v26, v27
    v_fma_f32 v29, v29, v26, v27
    v_fma_f32 v30, v30, v26, v27
    v_mfma_f32_32x32x16_bf16 v[96:111], v[220:223], a[88:91], v[96:111]
    s_waitcnt lgkmcnt(4)
    ds_read_b64_tr_b16 a[72:73], v9 offset:24576
    ds_read_b64_tr_b16 a[74:75], v9 offset:25088
    v_fma_f32 v31, v31, v26, v27
    v_fma_f32 v32, v32, v26, v27
    v_fma_f32 v33, v33, v26, v27
    v_fma_f32 v34, v34, v26, v27
    v_fma_f32 v35, v35, v26, v27
    v_mfma_f32_32x32x16_bf16 v[112:127], v[220:223], a[92:95], v[112:127]
    s_waitcnt lgkmcnt(4)
    ds_read_b64_tr_b16 a[76:77], v9 offset:26624
    ds_read_b64_tr_b16 a[78:79], v9 offset:27136
    v_cvt_pk_bf16_f32 v228, v28, v29
    v_cvt_pk_bf16_f32 v229, v30, v31
    v_cvt_pk_bf16_f32 v230, v32, v33
    v_cvt_pk_bf16_f32 v231, v34, v35
    v_lshlrev_b32 v28, 16, v232
    v_mfma_f32_32x32x16_bf16 v[64:79], v[224:227], a[64:67], v[64:79]
    s_waitcnt lgkmcnt(4)
    s_waitcnt vmcnt(30)
    s_barrier
    ds_read_b64_tr_b16 a[80:81], v10 offset:24576
    ds_read_b64_tr_b16 a[82:83], v10 offset:25088
    v_and_b32 v29, s82, v232
    v_lshlrev_b32 v30, 16, v233
    v_and_b32 v31, s82, v233
    v_mfma_f32_32x32x16_bf16 v[80:95], v[224:227], a[68:71], v[80:95]
    s_waitcnt lgkmcnt(4)
    ds_read_b64_tr_b16 a[84:85], v10 offset:26624
    ds_read_b64_tr_b16 a[86:87], v10 offset:27136
    v_lshlrev_b32 v32, 16, v234
    v_and_b32 v33, s82, v234
    v_lshlrev_b32 v34, 16, v235
    v_and_b32 v35, s82, v235
    v_fma_f32 v28, v28, v26, v27
    v_fma_f32 v29, v29, v26, v27
    v_fma_f32 v30, v30, v26, v27
    v_mfma_f32_32x32x16_bf16 v[96:111], v[224:227], a[72:75], v[96:111]
    s_waitcnt lgkmcnt(4)
    ds_read_b64_tr_b16 a[88:89], v11 offset:24576
    ds_read_b64_tr_b16 a[90:91], v11 offset:25088
    v_fma_f32 v31, v31, v26, v27
    v_fma_f32 v32, v32, v26, v27
    v_fma_f32 v33, v33, v26, v27
    v_fma_f32 v34, v34, v26, v27
    v_fma_f32 v35, v35, v26, v27
    v_cvt_pk_bf16_f32 v232, v28, v29
    v_mfma_f32_32x32x16_bf16 v[112:127], v[224:227], a[76:79], v[112:127]
    s_waitcnt lgkmcnt(4)
    ds_read_b64_tr_b16 a[92:93], v11 offset:26624
    ds_read_b64_tr_b16 a[94:95], v11 offset:27136
    v_cvt_pk_bf16_f32 v233, v30, v31
    v_cvt_pk_bf16_f32 v234, v32, v33
    v_cvt_pk_bf16_f32 v235, v34, v35
    v_lshlrev_b32 v28, 16, v236
    v_and_b32 v29, s82, v236
    v_lshlrev_b32_e64 v30, 16, v237
    v_and_b32 v31, s82, v237
    v_mfma_f32_32x32x16_bf16 v[64:79], v[228:231], a[80:83], v[64:79]
    s_waitcnt lgkmcnt(4)
    ds_read_b64_tr_b16 a[64:65], v12 offset:24576
    ds_read_b64_tr_b16 a[66:67], v12 offset:25088
    s_waitcnt vmcnt(22)
    v_cmp_gt_u32 vcc, 1, v25
    s_nop 1
    s_cbranch_vccnz L_slow_gated_6
L_ret_gated_6:
    v_mfma_f32_32x32x16_bf16 v[80:95], v[228:231], a[84:87], v[80:95]
    s_waitcnt lgkmcnt(4)
    s_add_u32 m0, s53, 0
    ds_read_b64_tr_b16 a[68:69], v12 offset:26624
    ds_read_b64_tr_b16 a[70:71], v12 offset:27136
    buffer_load_dwordx4 v18, s[8:11], s61 offen lds
    v_lshlrev_b32 v32, 16, v238
    v_and_b32 v33, s82, v238
    v_lshlrev_b32 v34, 16, v239
    v_and_b32 v35, s82, v239
    v_fma_f32 v28, v28, v26, v27
    v_fma_f32 v29, v29, v26, v27
    v_fma_f32 v30, v30, v26, v27
    v_fma_f32 v31, v31, v26, v27
    v_mfma_f32_32x32x16_bf16 v[96:111], v[228:231], a[88:91], v[96:111]
    s_waitcnt lgkmcnt(4)
    ds_read_b64_tr_b16 a[72:73], v13 offset:24576
    ds_read_b64_tr_b16 a[74:75], v13 offset:25088
    v_fma_f32 v32, v32, v26, v27
    v_fma_f32 v33, v33, v26, v27
    v_fma_f32 v34, v34, v26, v27
    v_fma_f32 v35, v35, v26, v27
    v_cvt_pk_bf16_f32 v236, v28, v29
    v_cvt_pk_bf16_f32 v237, v30, v31
    v_mfma_f32_32x32x16_bf16 v[112:127], v[228:231], a[92:95], v[112:127]
    s_waitcnt lgkmcnt(4)
    ds_read_b64_tr_b16 a[76:77], v13 offset:26624
    ds_read_b64_tr_b16 a[78:79], v13 offset:27136
    buffer_load_dwordx4 v19, s[8:11], s61 offen offset:1024 lds
    v_cvt_pk_bf16_f32 v238, v32, v33
    v_cvt_pk_bf16_f32 v239, v34, v35
    v_lshlrev_b32 v28, 16, v240
    v_and_b32 v29, s82, v240
    v_mfma_f32_32x32x16_bf16 v[64:79], v[232:235], a[64:67], v[64:79]
    s_waitcnt lgkmcnt(4)
    ds_read_b64_tr_b16 a[80:81], v14 offset:24576
    ds_read_b64_tr_b16 a[82:83], v14 offset:25088
    s_waitcnt vmcnt(8)
    v_lshl_or_b32 v42, v50, 16, v42
    v_lshl_or_b32 v43, v51, 16, v43
    v_lshl_or_b32 v44, v52, 16, v44
    v_lshl_or_b32 v45, v53, 16, v45
    v_lshl_or_b32 v46, v54, 16, v46
    v_mfma_f32_32x32x16_bf16 v[80:95], v[232:235], a[68:71], v[80:95]
    s_waitcnt lgkmcnt(4)
    ds_read_b64_tr_b16 a[84:85], v14 offset:26624
    ds_read_b64_tr_b16 a[86:87], v14 offset:27136
    buffer_load_dwordx4 v18, s[12:15], s61 offen offset:2048 lds
    v_lshl_or_b32 v47, v55, 16, v47
    v_lshl_or_b32 v48, v56, 16, v48
    v_lshl_or_b32 v49, v57, 16, v49
    v_mfma_f32_32x32x16_bf16 v[96:111], v[232:235], a[72:75], v[96:111]
    s_waitcnt lgkmcnt(4)
    ds_read_b64_tr_b16 a[88:89], v15 offset:24576
    ds_read_b64_tr_b16 a[90:91], v15 offset:25088
    buffer_store_dwordx4 v[42:45], v41, s[28:31], s74 offen sc1
    buffer_store_dwordx4 v[46:49], v41, s[28:31], s74 offen offset:64 sc1
    v_mfma_f32_32x32x16_bf16 v[112:127], v[232:235], a[76:79], v[112:127]
    s_waitcnt lgkmcnt(4)
    ds_read_b64_tr_b16 a[92:93], v15 offset:26624
    ds_read_b64_tr_b16 a[94:95], v15 offset:27136
    buffer_load_dwordx4 v19, s[12:15], s61 offen offset:3072 lds
    v_lshlrev_b32 v30, 16, v241
    v_and_b32 v31, s82, v241
    v_mfma_f32_32x32x16_bf16 v[64:79], v[236:239], a[80:83], v[64:79]
    s_waitcnt lgkmcnt(4)
    ds_read_b64_tr_b16 a[64:65], v8 offset:28672
    ds_read_b64_tr_b16 a[66:67], v8 offset:29184
    v_lshlrev_b32 v32, 16, v242
    v_and_b32 v33, s82, v242
    v_lshlrev_b32 v34, 16, v243
    v_and_b32 v35, s82, v243
    v_fma_f32 v28, v28, v26, v27
    v_fma_f32 v29, v29, v26, v27
    v_fma_f32 v30, v30, v26, v27
    v_mfma_f32_32x32x16_bf16 v[80:95], v[236:239], a[84:87], v[80:95]
    s_waitcnt lgkmcnt(4)
    s_add_u32 m0, s53, 16384
    s_lshl_b32 s55, s84, 16
    ds_read_b64_tr_b16 a[68:69], v8 offset:30720
    ds_read_b64_tr_b16 a[70:71], v8 offset:31232
    buffer_load_dwordx4 v20, s[16:19], s55 offen lds
    v_fma_f32 v31, v31, v26, v27
    v_fma_f32 v32, v32, v26, v27
    v_mfma_f32_32x32x16_bf16 v[96:111], v[236:239], a[88:91], v[96:111]
    s_waitcnt lgkmcnt(4)
    ds_read_b64_tr_b16 a[72:73], v9 offset:28672
    ds_read_b64_tr_b16 a[74:75], v9 offset:29184
    v_fma_f32 v33, v33, v26, v27
    v_fma_f32 v34, v34, v26, v27
    v_fma_f32 v35, v35, v26, v27
    v_cvt_pk_bf16_f32 v240, v28, v29
    v_cvt_pk_bf16_f32 v241, v30, v31
    v_cvt_pk_bf16_f32 v242, v32, v33
    v_mfma_f32_32x32x16_bf16 v[112:127], v[236:239], a[92:95], v[112:127]
    s_waitcnt lgkmcnt(4)
    ds_read_b64_tr_b16 a[76:77], v9 offset:30720
    ds_read_b64_tr_b16 a[78:79], v9 offset:31232
    buffer_load_dwordx4 v21, s[16:19], s55 offen offset:1024 lds
    v_cvt_pk_bf16_f32 v243, v34, v35
    v_lshlrev_b32 v28, 16, v244
    v_and_b32 v29, s82, v244
    v_lshlrev_b32_e64 v30, 16, v245
    v_mfma_f32_32x32x16_bf16 v[64:79], v[240:243], a[64:67], v[64:79]
    s_waitcnt lgkmcnt(4)
    s_barrier
    ds_read_b64_tr_b16 a[80:81], v10 offset:28672
    ds_read_b64_tr_b16 a[82:83], v10 offset:29184
    v_and_b32 v31, s82, v245
    v_lshlrev_b32 v32, 16, v246
    v_and_b32 v33, s82, v246
    v_mfma_f32_32x32x16_bf16 v[80:95], v[240:243], a[68:71], v[80:95]
    s_waitcnt lgkmcnt(4)
    ds_read_b64_tr_b16 a[84:85], v10 offset:30720
    ds_read_b64_tr_b16 a[86:87], v10 offset:31232
    buffer_load_dwordx4 v22, s[16:19], s55 offen offset:2048 lds
    v_lshlrev_b32 v34, 16, v247
    v_and_b32 v35, s82, v247
    v_fma_f32 v28, v28, v26, v27
    v_fma_f32 v29, v29, v26, v27
    v_mfma_f32_32x32x16_bf16 v[96:111], v[240:243], a[72:75], v[96:111]
    s_waitcnt lgkmcnt(4)
    ds_read_b64_tr_b16 a[88:89], v11 offset:28672
    ds_read_b64_tr_b16 a[90:91], v11 offset:29184
    v_fma_f32 v30, v30, v26, v27
    v_fma_f32 v31, v31, v26, v27
    v_fma_f32 v32, v32, v26, v27
    v_fma_f32 v33, v33, v26, v27
    v_fma_f32 v34, v34, v26, v27
    v_fma_f32 v35, v35, v26, v27
    v_mfma_f32_32x32x16_bf16 v[112:127], v[240:243], a[76:79], v[112:127]
    s_waitcnt lgkmcnt(4)
    ds_read_b64_tr_b16 a[92:93], v11 offset:30720
    ds_read_b64_tr_b16 a[94:95], v11 offset:31232
    buffer_load_dwordx4 v23, s[16:19], s55 offen offset:3072 lds
    v_cvt_pk_bf16_f32 v244, v28, v29
    v_cvt_pk_bf16_f32 v245, v30, v31
    v_cvt_pk_bf16_f32 v246, v32, v33
    v_cvt_pk_bf16_f32 v247, v34, v35
    s_nop 1
    v_mfma_f32_32x32x16_bf16 v[64:79], v[244:247], a[80:83], v[64:79]
    s_waitcnt lgkmcnt(4)
    ds_read_b64_tr_b16 a[64:65], v12 offset:28672
    ds_read_b64_tr_b16 a[66:67], v12 offset:29184
    v_lshlrev_b32 v28, 16, v248
    v_and_b32 v29, s82, v248
    v_lshlrev_b32 v30, 16, v249
    v_and_b32 v31, s82, v249
    v_lshlrev_b32 v32, 16, v250
    v_and_b32 v33, s82, v250
    v_lshlrev_b32 v34, 16, v251
    v_mfma_f32_32x32x16_bf16 v[80:95], v[244:247], a[84:87], v[80:95]
    s_waitcnt lgkmcnt(4)
    s_add_u32 m0, s53, 4096
    ds_read_b64_tr_b16 a[68:69], v12 offset:30720
    ds_read_b64_tr_b16 a[70:71], v12 offset:31232
    buffer_load_dwordx4 v18, s[8:11], s62 offen lds
    v_and_b32_e64 v35, s82, v251
    v_fma_f32 v28, v28, v26, v27
    v_fma_f32 v29, v29, v26, v27
    v_mfma_f32_32x32x16_bf16 v[96:111], v[244:247], a[88:91], v[96:111]
    s_waitcnt lgkmcnt(4)
    ds_read_b64_tr_b16 a[72:73], v13 offset:28672
    ds_read_b64_tr_b16 a[74:75], v13 offset:29184
    v_fma_f32 v30, v30, v26, v27
    v_fma_f32 v31, v31, v26, v27
    v_fma_f32 v32, v32, v26, v27
    v_fma_f32 v33, v33, v26, v27
    v_fma_f32 v34, v34, v26, v27
    v_fma_f32 v35, v35, v26, v27
    v_mfma_f32_32x32x16_bf16 v[112:127], v[244:247], a[92:95], v[112:127]
    s_waitcnt lgkmcnt(4)
    ds_read_b64_tr_b16 a[76:77], v13 offset:30720
    ds_read_b64_tr_b16 a[78:79], v13 offset:31232
    buffer_load_dwordx4 v19, s[8:11], s62 offen offset:1024 lds
    v_cvt_pk_bf16_f32 v248, v28, v29
    v_cvt_pk_bf16_f32 v249, v30, v31
    v_cvt_pk_bf16_f32 v250, v32, v33
    v_cvt_pk_bf16_f32 v251, v34, v35
    s_nop 1
    v_mfma_f32_32x32x16_bf16 v[64:79], v[248:251], a[64:67], v[64:79]
    s_waitcnt lgkmcnt(4)
    ds_read_b64_tr_b16 a[80:81], v14 offset:28672
    ds_read_b64_tr_b16 a[82:83], v14 offset:29184
    v_lshlrev_b32 v28, 16, v252
    v_and_b32 v29, s82, v252
    v_lshlrev_b32 v30, 16, v253
    v_and_b32 v31, s82, v253
    v_lshlrev_b32_e64 v32, 16, v254
    v_and_b32 v33, s82, v254
    v_mfma_f32_32x32x16_bf16 v[80:95], v[248:251], a[68:71], v[80:95]
    s_waitcnt lgkmcnt(4)
    ds_read_b64_tr_b16 a[84:85], v14 offset:30720
    ds_read_b64_tr_b16 a[86:87], v14 offset:31232
    buffer_load_dwordx4 v18, s[12:15], s62 offen offset:2048 lds
    v_lshlrev_b32 v34, 16, v255
    v_and_b32 v35, s82, v255
    v_fma_f32 v28, v28, v26, v27
    v_fma_f32 v29, v29, v26, v27
    v_mfma_f32_32x32x16_bf16 v[96:111], v[248:251], a[72:75], v[96:111]
    s_waitcnt lgkmcnt(4)
    ds_read_b64_tr_b16 a[88:89], v15 offset:28672
    ds_read_b64_tr_b16 a[90:91], v15 offset:29184
    v_fma_f32 v30, v30, v26, v27
    v_fma_f32 v31, v31, v26, v27
    v_fma_f32 v32, v32, v26, v27
    v_fma_f32 v33, v33, v26, v27
    v_fma_f32 v34, v34, v26, v27
    v_fma_f32 v35, v35, v26, v27
    v_mfma_f32_32x32x16_bf16 v[112:127], v[248:251], a[76:79], v[112:127]
    s_waitcnt lgkmcnt(4)
    ds_read_b64_tr_b16 a[92:93], v15 offset:30720
    ds_read_b64_tr_b16 a[94:95], v15 offset:31232
    buffer_load_dwordx4 v19, s[12:15], s62 offen offset:3072 lds
    v_cvt_pk_bf16_f32 v252, v28, v29
    v_cvt_pk_bf16_f32 v253, v30, v31
    v_cvt_pk_bf16_f32 v254, v32, v33
    v_cvt_pk_bf16_f32 v255, v34, v35
    s_nop 1
    v_mfma_f32_32x32x16_bf16 v[64:79], v[252:255], a[80:83], v[64:79]
    s_waitcnt lgkmcnt(4)
    ds_read_b64_tr_b16 a[64:65], v8 offset:32768
    ds_read_b64_tr_b16 a[66:67], v8 offset:33280
    s_mov_b32 s20, 0xbdd2d3e8
    s_mov_b32 s21, 0xbdd2d3e8
    v_and_b32 v34, 31, v1
    v_and_b32 v35, 7, v1
    v_lshrrev_b32 v32, 5, v1
    v_xor_b32 v35, v35, v32
    v_lshlrev_b32_e64 v35, 4, v35
    v_mfma_f32_32x32x16_bf16 v[80:95], v[252:255], a[84:87], v[80:95]
    s_waitcnt lgkmcnt(4)
    s_add_u32 m0, s53, 20480
    s_lshl_b32 s55, s84, 16
    s_add_u32 s55, s55, 32768
    ds_read_b64_tr_b16 a[68:69], v8 offset:34816
    ds_read_b64_tr_b16 a[70:71], v8 offset:35328
    buffer_load_dwordx4 v20, s[16:19], s55 offen lds
    v_lshl_add_u32 v34, v34, 7, v35
    v_mfma_f32_32x32x16_bf16 v[96:111], v[252:255], a[88:91], v[96:111]
    s_waitcnt lgkmcnt(4)
    ds_read_b64_tr_b16 a[72:73], v9 offset:32768
    ds_read_b64_tr_b16 a[74:75], v9 offset:33280
    s_add_u32 s56, s53, 28672
    v_add_u32 v28, s56, v34
    v_xor_b32 v29, 32, v28
    v_xor_b32 v30, 64, v28
    v_xor_b32 v31, 96, v28
    v_lshrrev_b32 v34, 3, v1
    v_and_b32 v35, 7, v1
    v_xor_b32 v32, v34, v35
    v_mfma_f32_32x32x16_bf16 v[112:127], v[252:255], a[92:95], v[112:127]
    s_waitcnt lgkmcnt(4)
    ds_read_b64_tr_b16 a[76:77], v9 offset:34816
    ds_read_b64_tr_b16 a[78:79], v9 offset:35328
    buffer_load_dwordx4 v21, s[16:19], s55 offen offset:1024 lds
    v_lshlrev_b32_e64 v32, 4, v32
    v_lshl_add_u32 v32, v34, 7, v32
    v_add_u32_e64 v32, s56, v32
    v_mul_u32_u24 v33, 8448, v34
    v_lshl_add_u32 v33, v35, 4, v33
    v_cvt_pk_bf16_f32 v36, v96, v97
    v_cvt_pk_bf16_f32 v37, v98, v99
    v_cvt_pk_bf16_f32 v38, v100, v101
    v_cvt_pk_bf16_f32 v39, v102, v103
    ds_write_b128 v28, v[36:39] offset:8192
    v_cvt_pk_bf16_f32 v40, v104, v105
    v_cvt_pk_bf16_f32 v41, v106, v107
    v_cvt_pk_bf16_f32 v42, v108, v109
    v_cvt_pk_bf16_f32 v43, v110, v111
    ds_write_b128 v30, v[40:43] offset:8192
    v_cvt_pk_bf16_f32 v44, v112, v113
    v_cvt_pk_bf16_f32 v45, v114, v115
    v_cvt_pk_bf16_f32 v46, v116, v117
    v_cvt_pk_bf16_f32 v47, v118, v119
    ds_write_b128 v29, v[44:47] offset:8192
    v_cvt_pk_bf16_f32 v36, v120, v121
    v_cvt_pk_bf16_f32 v37, v122, v123
    v_cvt_pk_bf16_f32 v38, v124, v125
    v_cvt_pk_bf16_f32 v39, v126, v127
    ds_write_b128 v31, v[36:39] offset:8192
    s_barrier
    ds_read_b128 v[96:99], v32 offset:8192
    ds_read_b128 v[100:103], v32 offset:9216
    ds_read_b128 v[104:107], v32 offset:10240
    ds_read_b128 v[108:111], v32 offset:11264
    v_cvt_pk_bf16_f32 v40, v64, v65
    v_cvt_pk_bf16_f32 v41, v66, v67
    v_cvt_pk_bf16_f32 v42, v68, v69
    v_cvt_pk_bf16_f32 v43, v70, v71
    ds_write_b128 v28, v[40:43]
    v_cvt_pk_bf16_f32 v44, v72, v73
    v_cvt_pk_bf16_f32 v45, v74, v75
    v_cvt_pk_bf16_f32 v46, v76, v77
    v_cvt_pk_bf16_f32 v47, v78, v79
    ds_write_b128 v30, v[44:47]
    s_add_u32 s56, s71, 270336
    s_waitcnt lgkmcnt(5)
    buffer_store_dwordx4 v[96:99], v33, s[28:31], s56 offen sc1
    v_cvt_pk_bf16_f32 v36, v80, v81
    v_cvt_pk_bf16_f32 v37, v82, v83
    v_cvt_pk_bf16_f32 v38, v84, v85
    v_cvt_pk_bf16_f32 v39, v86, v87
    ds_write_b128 v29, v[36:39]
    s_add_u32 s56, s71, 337920
    s_waitcnt lgkmcnt(5)
    buffer_store_dwordx4 v[100:103], v33, s[28:31], s56 offen sc1
    v_cvt_pk_bf16_f32 v40, v88, v89
    v_cvt_pk_bf16_f32 v41, v90, v91
    v_cvt_pk_bf16_f32 v42, v92, v93
    v_cvt_pk_bf16_f32 v43, v94, v95
    ds_write_b128 v31, v[40:43]
    ds_read_b128 v[48:51], v32
    ds_read_b128 v[52:55], v32 offset:1024
    ds_read_b128 v[56:59], v32 offset:2048
    ds_read_b128 v[60:63], v32 offset:3072
    s_add_u32 s56, s71, 405504
    s_waitcnt lgkmcnt(9)
    buffer_store_dwordx4 v[104:107], v33, s[28:31], s56 offen sc1
    s_add_u32 s56, s71, 473088
    s_waitcnt lgkmcnt(8)
    buffer_store_dwordx4 v[108:111], v33, s[28:31], s56 offen sc1
    s_add_u32 s56, s71, 0
    s_waitcnt lgkmcnt(3)
    buffer_store_dwordx4 v[48:51], v33, s[28:31], s56 offen sc1
    s_add_u32 s56, s71, 67584
    s_waitcnt lgkmcnt(2)
    buffer_store_dwordx4 v[52:55], v33, s[28:31], s56 offen sc1
    s_add_u32 s56, s71, 135168
    s_waitcnt lgkmcnt(1)
    buffer_store_dwordx4 v[56:59], v33, s[28:31], s56 offen sc1
    s_add_u32 s56, s71, 202752
    s_waitcnt lgkmcnt(0)
    buffer_store_dwordx4 v[60:63], v33, s[28:31], s56 offen sc1
    v_mfma_f32_32x32x16_bf16 v[64:79], a[64:67], v[128:131], 0
    s_waitcnt vmcnt(18)
    s_barrier
    ds_read_b64_tr_b16 a[80:81], v10 offset:32768
    ds_read_b64_tr_b16 a[82:83], v10 offset:33280
    v_mfma_f32_32x32x16_bf16 v[80:95], a[68:71], v[128:131], 0
    ds_read_b64_tr_b16 a[84:85], v10 offset:34816
    ds_read_b64_tr_b16 a[86:87], v10 offset:35328
    buffer_load_dwordx4 v22, s[16:19], s55 offen offset:2048 lds
    v_accvgpr_read_b32 v28, a187
    v_mfma_f32_32x32x16_bf16 v[96:111], a[72:75], v[128:131], 0
    ds_read_b64_tr_b16 a[88:89], v11 offset:32768
    ds_read_b64_tr_b16 a[90:91], v11 offset:33280
    v_accvgpr_read_b32 v30, a189
    v_accvgpr_read_b32 v32, a191
    v_accvgpr_read_b32 v29, a188
    v_accvgpr_read_b32 v31, a190
    v_mfma_f32_32x32x16_bf16 v[112:127], a[76:79], v[128:131], 0
    s_waitcnt lgkmcnt(4)
    ds_read_b64_tr_b16 a[92:93], v11 offset:34816
    ds_read_b64_tr_b16 a[94:95], v11 offset:35328
    buffer_load_dwordx4 v23, s[16:19], s55 offen offset:3072 lds
    v_accvgpr_read_b32 v33, a192
    v_mfma_f32_32x32x16_bf16 v[64:79], a[80:83], v[132:135], v[64:79]
    s_waitcnt lgkmcnt(4)
    ds_read_b64_tr_b16 a[64:65], v12 offset:32768
    ds_read_b64_tr_b16 a[66:67], v12 offset:33280
    s_add_u32 s26, s80, 0
    s_and_b32 s26, s26, 3
    s_cselect_b64 s[24:25], 0, -1
    s_lshl_b32 s26, s26, 4
    v_mfma_f32_32x32x16_bf16 v[80:95], a[84:87], v[132:135], v[80:95]
    s_waitcnt lgkmcnt(4)
    s_add_u32 m0, s53, 8192
    ds_read_b64_tr_b16 a[68:69], v12 offset:34816
    ds_read_b64_tr_b16 a[70:71], v12 offset:35328
    buffer_load_dwordx4 v18, s[8:11], s63 offen lds
    v_mfma_f32_32x32x16_bf16 v[96:111], a[88:91], v[132:135], v[96:111]
    s_waitcnt lgkmcnt(4)
    ds_read_b64_tr_b16 a[72:73], v13 offset:32768
    ds_read_b64_tr_b16 a[74:75], v13 offset:33280
    v_cvt_f32_u32_e64 v35, s26
    v_fma_f32 v34, v35, v28, v30
    v_fma_f32 v35, v35, v29, v31
    v_cndmask_b32 v44, v34, v32, s[24:25]
    v_mfma_f32_32x32x16_bf16 v[112:127], a[92:95], v[132:135], v[112:127]
    s_waitcnt lgkmcnt(4)
    ds_read_b64_tr_b16 a[76:77], v13 offset:34816
    ds_read_b64_tr_b16 a[78:79], v13 offset:35328
    buffer_load_dwordx4 v19, s[8:11], s63 offen offset:1024 lds
    v_fmamk_f32 v45, v28, 0x3f800000, v34
    v_mfma_f32_32x32x16_bf16 v[64:79], a[64:67], v[136:139], v[64:79]
    s_waitcnt lgkmcnt(4)
    ds_read_b64_tr_b16 a[80:81], v14 offset:32768
    ds_read_b64_tr_b16 a[82:83], v14 offset:33280
    v_fmamk_f32 v46, v28, 0x40000000, v34
    v_fmamk_f32 v47, v28, 0x40400000, v34
    v_cos_f32 v48, v44
    v_mfma_f32_32x32x16_bf16 v[80:95], a[68:71], v[136:139], v[80:95]
    s_waitcnt lgkmcnt(4)
    ds_read_b64_tr_b16 a[84:85], v14 offset:34816
    ds_read_b64_tr_b16 a[86:87], v14 offset:35328
    buffer_load_dwordx4 v18, s[12:15], s63 offen offset:2048 lds
    v_cos_f32 v49, v45
    v_mfma_f32_32x32x16_bf16 v[96:111], a[72:75], v[136:139], v[96:111]
    s_waitcnt lgkmcnt(4)
    ds_read_b64_tr_b16 a[88:89], v15 offset:32768
    ds_read_b64_tr_b16 a[90:91], v15 offset:33280
    v_cos_f32 v50, v46
    v_mfma_f32_32x32x16_bf16 v[112:127], a[76:79], v[136:139], v[112:127]
    s_waitcnt lgkmcnt(4)
    ds_read_b64_tr_b16 a[92:93], v15 offset:34816
    ds_read_b64_tr_b16 a[94:95], v15 offset:35328
    buffer_load_dwordx4 v19, s[12:15], s63 offen offset:3072 lds
    v_cos_f32_e64 v51, v47
    v_mfma_f32_32x32x16_bf16 v[64:79], a[80:83], v[140:143], v[64:79]
    s_waitcnt lgkmcnt(4)
    ds_read_b64_tr_b16 a[64:65], v8
    ds_read_b64_tr_b16 a[66:67], v8 offset:512
    v_sin_f32_e64 v44, -v44
    v_mfma_f32_32x32x16_bf16 v[80:95], a[84:87], v[140:143], v[80:95]
    s_waitcnt lgkmcnt(4)
    s_add_u32 m0, s53, 24576
    s_lshl_b32 s55, s85, 16
    ds_read_b64_tr_b16 a[68:69], v8 offset:2048
    ds_read_b64_tr_b16 a[70:71], v8 offset:2560
    buffer_load_dwordx4 v20, s[16:19], s55 offen lds
    v_mfma_f32_32x32x16_bf16 v[96:111], a[88:91], v[140:143], v[96:111]
    s_waitcnt lgkmcnt(4)
    ds_read_b64_tr_b16 a[72:73], v9
    ds_read_b64_tr_b16 a[74:75], v9 offset:512
    v_sin_f32_e64 v45, -v45
    v_sin_f32_e64 v46, -v46
    v_mfma_f32_32x32x16_bf16 v[112:127], a[92:95], v[140:143], v[112:127]
    s_waitcnt lgkmcnt(4)
    ds_read_b64_tr_b16 a[76:77], v9 offset:2048
    ds_read_b64_tr_b16 a[78:79], v9 offset:2560
    buffer_load_dwordx4 v21, s[16:19], s55 offen offset:1024 lds
    v_mfma_f32_32x32x16_bf16 v[64:79], a[64:67], v[144:147], v[64:79]
    s_waitcnt lgkmcnt(4)
    s_waitcnt vmcnt(18)
    s_barrier
    ds_read_b64_tr_b16 a[80:81], v10
    ds_read_b64_tr_b16 a[82:83], v10 offset:512
    v_mfma_f32_32x32x16_bf16 v[80:95], a[68:71], v[144:147], v[80:95]
    s_waitcnt lgkmcnt(4)
    ds_read_b64_tr_b16 a[84:85], v10 offset:2048
    ds_read_b64_tr_b16 a[86:87], v10 offset:2560
    buffer_load_dwordx4 v22, s[16:19], s55 offen offset:2048 lds
    v_sin_f32_e64 v47, -v47
    v_mfma_f32_32x32x16_bf16 v[96:111], a[72:75], v[144:147], v[96:111]
    s_waitcnt lgkmcnt(4)
    ds_read_b64_tr_b16 a[88:89], v11
    ds_read_b64_tr_b16 a[90:91], v11 offset:512
    v_cvt_pk_bf16_f32 v128, v48, v49
    v_cvt_pk_bf16_f32 v129, v50, v51
    v_cvt_pk_bf16_f32 v130, v44, v45
    v_cvt_pk_bf16_f32 v131, v46, v47
    v_mfma_f32_32x32x16_bf16 v[112:127], a[76:79], v[144:147], v[112:127]
    s_waitcnt lgkmcnt(4)
    ds_read_b64_tr_b16 a[92:93], v11 offset:2048
    ds_read_b64_tr_b16 a[94:95], v11 offset:2560
    buffer_load_dwordx4 v23, s[16:19], s55 offen offset:3072 lds
    v_cndmask_b32 v52, v35, v33, s[24:25]
    v_mfma_f32_32x32x16_bf16 v[64:79], a[80:83], v[148:151], v[64:79]
    s_waitcnt lgkmcnt(4)
    ds_read_b64_tr_b16 a[64:65], v12
    ds_read_b64_tr_b16 a[66:67], v12 offset:512
    v_fmamk_f32 v53, v29, 0x3f800000, v35
    v_fmamk_f32 v54, v29, 0x40000000, v35
    v_fmamk_f32 v55, v29, 0x40400000, v35
    v_mfma_f32_32x32x16_bf16 v[80:95], a[84:87], v[148:151], v[80:95]
    s_waitcnt lgkmcnt(4)
    ds_read_b64_tr_b16 a[68:69], v12 offset:2048
    ds_read_b64_tr_b16 a[70:71], v12 offset:2560
    buffer_atomic_add v5, v3, s[28:31], s75 offen sc1
    v_cos_f32 v56, v52
    v_mfma_f32_32x32x16_bf16 v[96:111], a[88:91], v[148:151], v[96:111]
    s_waitcnt lgkmcnt(4)
    ds_read_b64_tr_b16 a[72:73], v13
    ds_read_b64_tr_b16 a[74:75], v13 offset:512
    v_cos_f32 v57, v53
    v_cos_f32 v58, v54
    v_mfma_f32_32x32x16_bf16 v[112:127], a[92:95], v[148:151], v[112:127]
    s_waitcnt lgkmcnt(4)
    ds_read_b64_tr_b16 a[76:77], v13 offset:2048
    ds_read_b64_tr_b16 a[78:79], v13 offset:2560
    s_lshl_b32 s56, s77, 2
    s_add_u32 s56, s56, s52
    s_lshl_b32 s56, s56, 8
    s_waitcnt vmcnt(11)
    buffer_atomic_add v5, v4, s[28:31], s56 offen sc1
    v_mfma_f32_32x32x16_bf16 v[64:79], a[64:67], v[152:155], v[64:79]
    s_waitcnt lgkmcnt(4)
    ds_read_b64_tr_b16 a[80:81], v14
    ds_read_b64_tr_b16 a[82:83], v14 offset:512
    v_cos_f32 v59, v55
    v_sin_f32_e64 v52, -v52
    v_mfma_f32_32x32x16_bf16 v[80:95], a[68:71], v[152:155], v[80:95]
    s_waitcnt lgkmcnt(4)
    s_add_u32 m0, s53, 12288
    ds_read_b64_tr_b16 a[84:85], v14 offset:2048
    ds_read_b64_tr_b16 a[86:87], v14 offset:2560
    buffer_load_dwordx4 v18, s[8:11], s64 offen lds
    v_mfma_f32_32x32x16_bf16 v[96:111], a[72:75], v[152:155], v[96:111]
    s_waitcnt lgkmcnt(4)
    ds_read_b64_tr_b16 a[88:89], v15
    ds_read_b64_tr_b16 a[90:91], v15 offset:512
    v_sin_f32_e64 v53, -v53
    v_sin_f32_e64 v54, -v54
    v_mfma_f32_32x32x16_bf16 v[112:127], a[76:79], v[152:155], v[112:127]
    s_waitcnt lgkmcnt(4)
    ds_read_b64_tr_b16 a[92:93], v15 offset:2048
    ds_read_b64_tr_b16 a[94:95], v15 offset:2560
    buffer_load_dwordx4 v19, s[8:11], s64 offen offset:1024 lds
    v_mfma_f32_32x32x16_bf16 v[64:79], a[80:83], v[156:159], v[64:79]
    s_waitcnt lgkmcnt(4)
    ds_read_b64_tr_b16 a[64:65], v8 offset:4096
    ds_read_b64_tr_b16 a[66:67], v8 offset:4608
    v_sin_f32_e64 v55, -v55
    v_cvt_pk_bf16_f32 v132, v56, v57
    v_cvt_pk_bf16_f32 v133, v58, v59
    v_mfma_f32_32x32x16_bf16 v[80:95], a[84:87], v[156:159], v[80:95]
    s_waitcnt lgkmcnt(4)
    ds_read_b64_tr_b16 a[68:69], v8 offset:6144
    ds_read_b64_tr_b16 a[70:71], v8 offset:6656
    buffer_load_dwordx4 v18, s[12:15], s64 offen offset:2048 lds
    v_cvt_pk_bf16_f32 v134, v52, v53
    v_mfma_f32_32x32x16_bf16 v[96:111], a[88:91], v[156:159], v[96:111]
    s_waitcnt lgkmcnt(4)
    ds_read_b64_tr_b16 a[72:73], v9 offset:4096
    ds_read_b64_tr_b16 a[74:75], v9 offset:4608
    v_cvt_pk_bf16_f32 v135, v54, v55
    v_fmamk_f32 v44, v28, 0x41000000, v34
    v_fmamk_f32 v45, v28, 0x41100000, v34
    v_mfma_f32_32x32x16_bf16 v[112:127], a[92:95], v[156:159], v[112:127]
    s_waitcnt lgkmcnt(4)
    ds_read_b64_tr_b16 a[76:77], v9 offset:6144
    ds_read_b64_tr_b16 a[78:79], v9 offset:6656
    buffer_load_dwordx4 v19, s[12:15], s64 offen offset:3072 lds
    v_fmamk_f32 v46, v28, 0x41200000, v34
    v_mfma_f32_32x32x16_bf16 v[64:79], a[64:67], v[160:163], v[64:79]
    s_waitcnt lgkmcnt(4)
    s_waitcnt vmcnt(10)
    s_barrier
    ds_read_b64_tr_b16 a[80:81], v10 offset:4096
    ds_read_b64_tr_b16 a[82:83], v10 offset:4608
    v_mfma_f32_32x32x16_bf16 v[80:95], a[68:71], v[160:163], v[80:95]
    s_waitcnt lgkmcnt(4)
    s_add_u32 m0, s53, 28672
    ds_read_b64_tr_b16 a[84:85], v10 offset:6144
    ds_read_b64_tr_b16 a[86:87], v10 offset:6656
    buffer_load_dwordx4 v18, s[8:11], s65 offen lds
    v_mfma_f32_32x32x16_bf16 v[96:111], a[72:75], v[160:163], v[96:111]
    s_waitcnt lgkmcnt(4)
    ds_read_b64_tr_b16 a[88:89], v11 offset:4096
    ds_read_b64_tr_b16 a[90:91], v11 offset:4608
    v_fmamk_f32 v47, v28, 0x41300000, v34
    v_cos_f32 v48, v44
    v_mfma_f32_32x32x16_bf16 v[112:127], a[76:79], v[160:163], v[112:127]
    s_waitcnt lgkmcnt(4)
    ds_read_b64_tr_b16 a[92:93], v11 offset:6144
    ds_read_b64_tr_b16 a[94:95], v11 offset:6656
    buffer_load_dwordx4 v19, s[8:11], s65 offen offset:1024 lds
    v_cos_f32 v49, v45
    v_mfma_f32_32x32x16_bf16 v[64:79], a[80:83], v[164:167], v[64:79]
    s_waitcnt lgkmcnt(4)
    ds_read_b64_tr_b16 a[64:65], v12 offset:4096
    ds_read_b64_tr_b16 a[66:67], v12 offset:4608
    v_cos_f32 v50, v46
    v_cos_f32 v51, v47
    v_mfma_f32_32x32x16_bf16 v[80:95], a[84:87], v[164:167], v[80:95]
    s_waitcnt lgkmcnt(4)
    ds_read_b64_tr_b16 a[68:69], v12 offset:6144
    ds_read_b64_tr_b16 a[70:71], v12 offset:6656
    buffer_load_dwordx4 v18, s[12:15], s65 offen offset:2048 lds
    v_sin_f32_e64 v44, -v44
    v_mfma_f32_32x32x16_bf16 v[96:111], a[88:91], v[164:167], v[96:111]
    s_waitcnt lgkmcnt(4)
    ds_read_b64_tr_b16 a[72:73], v13 offset:4096
    ds_read_b64_tr_b16 a[74:75], v13 offset:4608
    v_sin_f32_e64 v45, -v45
    v_mfma_f32_32x32x16_bf16 v[112:127], a[92:95], v[164:167], v[112:127]
    s_waitcnt lgkmcnt(4)
    ds_read_b64_tr_b16 a[76:77], v13 offset:6144
    ds_read_b64_tr_b16 a[78:79], v13 offset:6656
    buffer_load_dwordx4 v19, s[12:15], s65 offen offset:3072 lds
    v_sin_f32_e64 v46, -v46
    v_mfma_f32_32x32x16_bf16 v[64:79], a[64:67], v[168:171], v[64:79]
    s_waitcnt lgkmcnt(4)
    ds_read_b64_tr_b16 a[80:81], v14 offset:4096
    ds_read_b64_tr_b16 a[82:83], v14 offset:4608
    v_sin_f32_e64 v47, -v47
    v_cvt_pk_bf16_f32 v136, v48, v49
    v_cvt_pk_bf16_f32 v137, v50, v51
    v_mfma_f32_32x32x16_bf16 v[80:95], a[68:71], v[168:171], v[80:95]
    s_waitcnt lgkmcnt(4)
    s_add_u32 m0, s53, 32768
    ds_read_b64_tr_b16 a[84:85], v14 offset:6144
    ds_read_b64_tr_b16 a[86:87], v14 offset:6656
    buffer_load_dwordx4 v18, s[8:11], s66 offen lds
    v_mfma_f32_32x32x16_bf16 v[96:111], a[72:75], v[168:171], v[96:111]
    s_waitcnt lgkmcnt(4)
    ds_read_b64_tr_b16 a[88:89], v15 offset:4096
    ds_read_b64_tr_b16 a[90:91], v15 offset:4608
    v_cvt_pk_bf16_f32 v138, v44, v45
    v_cvt_pk_bf16_f32 v139, v46, v47
    v_fmamk_f32 v52, v29, 0x41000000, v35
    v_fmamk_f32 v53, v29, 0x41100000, v35
    v_mfma_f32_32x32x16_bf16 v[112:127], a[76:79], v[168:171], v[112:127]
    s_waitcnt lgkmcnt(4)
    ds_read_b64_tr_b16 a[92:93], v15 offset:6144
    ds_read_b64_tr_b16 a[94:95], v15 offset:6656
    buffer_load_dwordx4 v19, s[8:11], s66 offen offset:1024 lds
    v_fmamk_f32 v54, v29, 0x41200000, v35
    v_mfma_f32_32x32x16_bf16 v[64:79], a[80:83], v[172:175], v[64:79]
    s_waitcnt lgkmcnt(4)
    ds_read_b64_tr_b16 a[64:65], v8 offset:8192
    ds_read_b64_tr_b16 a[66:67], v8 offset:8704
    v_fmamk_f32 v55, v29, 0x41300000, v35
    v_cos_f32 v56, v52
    v_mfma_f32_32x32x16_bf16 v[80:95], a[84:87], v[172:175], v[80:95]
    s_waitcnt lgkmcnt(4)
    ds_read_b64_tr_b16 a[68:69], v8 offset:10240
    ds_read_b64_tr_b16 a[70:71], v8 offset:10752
    buffer_load_dwordx4 v18, s[12:15], s66 offen offset:2048 lds
    v_cos_f32 v57, v53
    v_mfma_f32_32x32x16_bf16 v[96:111], a[88:91], v[172:175], v[96:111]
    s_waitcnt lgkmcnt(4)
    ds_read_b64_tr_b16 a[72:73], v9 offset:8192
    ds_read_b64_tr_b16 a[74:75], v9 offset:8704
    v_cos_f32_e64 v58, v54
    v_cos_f32 v59, v55
    v_mfma_f32_32x32x16_bf16 v[112:127], a[92:95], v[172:175], v[112:127]
    s_waitcnt lgkmcnt(4)
    ds_read_b64_tr_b16 a[76:77], v9 offset:10240
    ds_read_b64_tr_b16 a[78:79], v9 offset:10752
    buffer_load_dwordx4 v19, s[12:15], s66 offen offset:3072 lds
    v_mfma_f32_32x32x16_bf16 v[64:79], a[64:67], v[176:179], v[64:79]
    s_waitcnt lgkmcnt(4)
    s_waitcnt vmcnt(8)
    s_barrier
    ds_read_b64_tr_b16 a[80:81], v10 offset:8192
    ds_read_b64_tr_b16 a[82:83], v10 offset:8704
    v_mfma_f32_32x32x16_bf16 v[80:95], a[68:71], v[176:179], v[80:95]
    s_waitcnt lgkmcnt(4)
    s_add_u32 m0, s53, 0
    ds_read_b64_tr_b16 a[84:85], v10 offset:10240
    ds_read_b64_tr_b16 a[86:87], v10 offset:10752
    buffer_load_dwordx4 v18, s[8:11], s67 offen lds
    v_mfma_f32_32x32x16_bf16 v[96:111], a[72:75], v[176:179], v[96:111]
    s_waitcnt lgkmcnt(4)
    ds_read_b64_tr_b16 a[88:89], v11 offset:8192
    ds_read_b64_tr_b16 a[90:91], v11 offset:8704
    v_sin_f32_e64 v52, -v52
    v_sin_f32_e64 v53, -v53
    v_mfma_f32_32x32x16_bf16 v[112:127], a[76:79], v[176:179], v[112:127]
    s_waitcnt lgkmcnt(4)
    ds_read_b64_tr_b16 a[92:93], v11 offset:10240
    ds_read_b64_tr_b16 a[94:95], v11 offset:10752
    buffer_load_dwordx4 v19, s[8:11], s67 offen offset:1024 lds
    v_sin_f32_e64 v54, -v54
    v_mfma_f32_32x32x16_bf16 v[64:79], a[80:83], v[180:183], v[64:79]
    s_waitcnt lgkmcnt(4)
    ds_read_b64_tr_b16 a[64:65], v12 offset:8192
    ds_read_b64_tr_b16 a[66:67], v12 offset:8704
    v_sin_f32_e64 v55, -v55
    v_cvt_pk_bf16_f32 v140, v56, v57
    v_cvt_pk_bf16_f32 v141, v58, v59
    v_mfma_f32_32x32x16_bf16 v[80:95], a[84:87], v[180:183], v[80:95]
    s_waitcnt lgkmcnt(4)
    ds_read_b64_tr_b16 a[68:69], v12 offset:10240
    ds_read_b64_tr_b16 a[70:71], v12 offset:10752
    buffer_load_dwordx4 v18, s[12:15], s67 offen offset:2048 lds
    v_cvt_pk_bf16_f32 v142, v52, v53
    v_mfma_f32_32x32x16_bf16 v[96:111], a[88:91], v[180:183], v[96:111]
    s_waitcnt lgkmcnt(4)
    ds_read_b64_tr_b16 a[72:73], v13 offset:8192
    ds_read_b64_tr_b16 a[74:75], v13 offset:8704
    v_cvt_pk_bf16_f32 v143, v54, v55
    v_mfma_f32_32x32x16_bf16 v[112:127], a[92:95], v[180:183], v[112:127]
    s_waitcnt lgkmcnt(4)
    ds_read_b64_tr_b16 a[76:77], v13 offset:10240
    ds_read_b64_tr_b16 a[78:79], v13 offset:10752
    buffer_load_dwordx4 v19, s[12:15], s67 offen offset:3072 lds
    s_add_u32 s26, s80, 1
    s_and_b32 s26, s26, 3
    s_cselect_b64 s[24:25], 0, -1
    s_lshl_b32 s26, s26, 4
    v_mfma_f32_32x32x16_bf16 v[64:79], a[64:67], v[184:187], v[64:79]
    s_waitcnt lgkmcnt(4)
    ds_read_b64_tr_b16 a[80:81], v14 offset:8192
    ds_read_b64_tr_b16 a[82:83], v14 offset:8704
    v_cvt_f32_u32_e64 v35, s26
    v_fma_f32 v34, v35, v28, v30
    v_fma_f32 v35, v35, v29, v31
    v_mfma_f32_32x32x16_bf16 v[80:95], a[68:71], v[184:187], v[80:95]
    s_waitcnt lgkmcnt(4)
    s_add_u32 m0, s53, 4096
    s_lshl_b32 s55, s85, 16
    s_add_u32 s55, s55, 32768
    ds_read_b64_tr_b16 a[84:85], v14 offset:10240
    ds_read_b64_tr_b16 a[86:87], v14 offset:10752
    buffer_load_dwordx4 v20, s[16:19], s55 offen lds
    v_mfma_f32_32x32x16_bf16 v[96:111], a[72:75], v[184:187], v[96:111]
    s_waitcnt lgkmcnt(4)
    ds_read_b64_tr_b16 a[88:89], v15 offset:8192
    ds_read_b64_tr_b16 a[90:91], v15 offset:8704
    v_cndmask_b32 v44, v34, v32, s[24:25]
    v_fmamk_f32 v45, v28, 0x3f800000, v34
    v_fmamk_f32 v46, v28, 0x40000000, v34
    v_mfma_f32_32x32x16_bf16 v[112:127], a[76:79], v[184:187], v[112:127]
    s_waitcnt lgkmcnt(4)
    ds_read_b64_tr_b16 a[92:93], v15 offset:10240
    ds_read_b64_tr_b16 a[94:95], v15 offset:10752
    buffer_load_dwordx4 v21, s[16:19], s55 offen offset:1024 lds
    v_mfma_f32_32x32x16_bf16 v[64:79], a[80:83], v[188:191], v[64:79]
    s_waitcnt lgkmcnt(4)
    ds_read_b64_tr_b16 a[64:65], v8 offset:12288
    ds_read_b64_tr_b16 a[66:67], v8 offset:12800
    v_min_u32 v24, 1, v1
    v_lshlrev_b32_e64 v24, 8, v24
    v_accvgpr_read_b32 v16, a185
    v_accvgpr_read_b32 v17, a186
    v_mfma_f32_32x32x16_bf16 v[80:95], a[84:87], v[188:191], v[80:95]
    s_waitcnt lgkmcnt(4)
    ds_read_b64_tr_b16 a[68:69], v8 offset:14336
    ds_read_b64_tr_b16 a[70:71], v8 offset:14848
    buffer_load_dwordx4 v22, s[16:19], s55 offen offset:2048 lds
    v_fmamk_f32 v47, v28, 0x40400000, v34
    v_mfma_f32_32x32x16_bf16 v[96:111], a[88:91], v[188:191], v[96:111]
    s_waitcnt lgkmcnt(4)
    ds_read_b64_tr_b16 a[72:73], v9 offset:12288
    ds_read_b64_tr_b16 a[74:75], v9 offset:12800
    v_cos_f32_e64 v48, v44
    v_cos_f32 v49, v45
    v_mfma_f32_32x32x16_bf16 v[112:127], a[92:95], v[188:191], v[112:127]
    s_waitcnt lgkmcnt(4)
    ds_read_b64_tr_b16 a[76:77], v9 offset:14336
    ds_read_b64_tr_b16 a[78:79], v9 offset:14848
    buffer_load_dwordx4 v23, s[16:19], s55 offen offset:3072 lds
    v_cos_f32_e64 v50, v46
    v_mfma_f32_32x32x16_bf16 v[64:79], a[64:67], v[192:195], v[64:79]
    s_waitcnt lgkmcnt(4)
    s_waitcnt vmcnt(12)
    s_barrier
    ds_read_b64_tr_b16 a[80:81], v10 offset:12288
    ds_read_b64_tr_b16 a[82:83], v10 offset:12800
    v_mfma_f32_32x32x16_bf16 v[80:95], a[68:71], v[192:195], v[80:95]
    s_waitcnt lgkmcnt(4)
    ds_read_b64_tr_b16 a[84:85], v10 offset:14336
    ds_read_b64_tr_b16 a[86:87], v10 offset:14848
    v_cos_f32 v51, v47
    v_sin_f32_e64 v44, -v44
    v_mfma_f32_32x32x16_bf16 v[96:111], a[72:75], v[192:195], v[96:111]
    s_waitcnt lgkmcnt(4)
    ds_read_b64_tr_b16 a[88:89], v11 offset:12288
    ds_read_b64_tr_b16 a[90:91], v11 offset:12800
    v_sin_f32_e64 v45, -v45
    v_mfma_f32_32x32x16_bf16 v[112:127], a[76:79], v[192:195], v[112:127]
    s_waitcnt lgkmcnt(4)
    ds_read_b64_tr_b16 a[92:93], v11 offset:14336
    ds_read_b64_tr_b16 a[94:95], v11 offset:14848
    v_sin_f32_e64 v46, -v46
    v_sin_f32_e64 v47, -v47
    v_mfma_f32_32x32x16_bf16 v[64:79], a[80:83], v[196:199], v[64:79]
    s_waitcnt lgkmcnt(4)
    ds_read_b64_tr_b16 a[64:65], v12 offset:12288
    ds_read_b64_tr_b16 a[66:67], v12 offset:12800
    v_cvt_pk_bf16_f32 v144, v48, v49
    v_cvt_pk_bf16_f32 v145, v50, v51
    v_cvt_pk_bf16_f32 v146, v44, v45
    v_mfma_f32_32x32x16_bf16 v[80:95], a[84:87], v[196:199], v[80:95]
    s_waitcnt lgkmcnt(4)
    ds_read_b64_tr_b16 a[68:69], v12 offset:14336
    ds_read_b64_tr_b16 a[70:71], v12 offset:14848
    buffer_load_dword v25, v24, s[28:31], s51 offen sc1
    v_cvt_pk_bf16_f32 v147, v46, v47
    v_mfma_f32_32x32x16_bf16 v[96:111], a[88:91], v[196:199], v[96:111]
    s_waitcnt lgkmcnt(4)
    ds_read_b64_tr_b16 a[72:73], v13 offset:12288
    ds_read_b64_tr_b16 a[74:75], v13 offset:12800
    v_cndmask_b32 v52, v35, v33, s[24:25]
    v_fmamk_f32 v53, v29, 0x3f800000, v35
    v_fmamk_f32 v54, v29, 0x40000000, v35
    v_mfma_f32_32x32x16_bf16 v[112:127], a[92:95], v[196:199], v[112:127]
    s_waitcnt lgkmcnt(4)
    s_add_u32 m0, s53, 8192
    s_lshl_b32 s55, s86, 16
    ds_read_b64_tr_b16 a[76:77], v13 offset:14336
    ds_read_b64_tr_b16 a[78:79], v13 offset:14848
    buffer_load_dwordx4 v20, s[16:19], s55 offen lds
    v_mfma_f32_32x32x16_bf16 v[64:79], a[64:67], v[200:203], v[64:79]
    s_waitcnt lgkmcnt(4)
    ds_read_b64_tr_b16 a[80:81], v14 offset:12288
    ds_read_b64_tr_b16 a[82:83], v14 offset:12800
    v_fmamk_f32 v55, v29, 0x40400000, v35
    v_cos_f32_e64 v56, v52
    v_mfma_f32_32x32x16_bf16 v[80:95], a[68:71], v[200:203], v[80:95]
    s_waitcnt lgkmcnt(4)
    ds_read_b64_tr_b16 a[84:85], v14 offset:14336
    ds_read_b64_tr_b16 a[86:87], v14 offset:14848
    buffer_load_dwordx4 v21, s[16:19], s55 offen offset:1024 lds
    v_cos_f32 v57, v53
    v_mfma_f32_32x32x16_bf16 v[96:111], a[72:75], v[200:203], v[96:111]
    s_waitcnt lgkmcnt(4)
    ds_read_b64_tr_b16 a[88:89], v15 offset:12288
    ds_read_b64_tr_b16 a[90:91], v15 offset:12800
    v_cos_f32_e64 v58, v54
    v_cos_f32 v59, v55
    v_mfma_f32_32x32x16_bf16 v[112:127], a[76:79], v[200:203], v[112:127]
    s_waitcnt lgkmcnt(4)
    ds_read_b64_tr_b16 a[92:93], v15 offset:14336
    ds_read_b64_tr_b16 a[94:95], v15 offset:14848
    buffer_load_dwordx4 v22, s[16:19], s55 offen offset:2048 lds
    v_mfma_f32_32x32x16_bf16 v[64:79], a[80:83], v[204:207], v[64:79]
    s_waitcnt lgkmcnt(4)
    ds_read_b64_tr_b16 a[64:65], v8 offset:28672
    ds_read_b64_tr_b16 a[66:67], v8 offset:29184
    v_sin_f32_e64 v52, -v52
    v_sin_f32_e64 v53, -v53
    v_mfma_f32_32x32x16_bf16 v[80:95], a[84:87], v[204:207], v[80:95]
    s_waitcnt lgkmcnt(4)
    ds_read_b64_tr_b16 a[68:69], v8 offset:30720
    ds_read_b64_tr_b16 a[70:71], v8 offset:31232
    v_sin_f32_e64 v54, -v54
    v_sin_f32_e64 v55, -v55
    v_mfma_f32_32x32x16_bf16 v[96:111], a[88:91], v[204:207], v[96:111]
    s_waitcnt lgkmcnt(4)
    ds_read_b64_tr_b16 a[72:73], v9 offset:28672
    ds_read_b64_tr_b16 a[74:75], v9 offset:29184
    buffer_load_dwordx4 v23, s[16:19], s55 offen offset:3072 lds
    v_mfma_f32_32x32x16_bf16 v[112:127], a[92:95], v[204:207], v[112:127]
    s_waitcnt lgkmcnt(4)
    ds_read_b64_tr_b16 a[76:77], v9 offset:30720
    ds_read_b64_tr_b16 a[78:79], v9 offset:31232
    v_cvt_pk_bf16_f32 v148, v56, v57
    v_cvt_pk_bf16_f32 v149, v58, v59
    v_cvt_pk_bf16_f32 v150, v52, v53
    v_cvt_pk_bf16_f32 v151, v54, v55
    v_mfma_f32_32x32x16_bf16 v[64:79], a[64:67], v[208:211], v[64:79]
    s_waitcnt lgkmcnt(4)
    s_waitcnt vmcnt(13)
    s_barrier
    ds_read_b64_tr_b16 a[80:81], v10 offset:28672
    ds_read_b64_tr_b16 a[82:83], v10 offset:29184
    v_mfma_f32_32x32x16_bf16 v[80:95], a[68:71], v[208:211], v[80:95]
    s_waitcnt lgkmcnt(4)
    ds_read_b64_tr_b16 a[84:85], v10 offset:30720
    ds_read_b64_tr_b16 a[86:87], v10 offset:31232
    v_fmamk_f32 v44, v28, 0x41000000, v34
    v_fmamk_f32 v45, v28, 0x41100000, v34
    v_fmamk_f32 v46, v28, 0x41200000, v34
    v_mfma_f32_32x32x16_bf16 v[96:111], a[72:75], v[208:211], v[96:111]
    s_waitcnt lgkmcnt(4)
    ds_read_b64_tr_b16 a[88:89], v11 offset:28672
    ds_read_b64_tr_b16 a[90:91], v11 offset:29184
    v_fmamk_f32 v47, v28, 0x41300000, v34
    v_cos_f32 v48, v44
    v_mfma_f32_32x32x16_bf16 v[112:127], a[76:79], v[208:211], v[112:127]
    s_waitcnt lgkmcnt(4)
    ds_read_b64_tr_b16 a[92:93], v11 offset:30720
    ds_read_b64_tr_b16 a[94:95], v11 offset:31232
    v_cos_f32 v49, v45
    v_cos_f32 v50, v46
    v_mfma_f32_32x32x16_bf16 v[64:79], a[80:83], v[212:215], v[64:79]
    s_waitcnt lgkmcnt(4)
    ds_read_b64_tr_b16 a[64:65], v12 offset:28672
    ds_read_b64_tr_b16 a[66:67], v12 offset:29184
    s_waitcnt vmcnt(4)
    v_cmp_gt_u32 vcc, 12, v25
    v_accvgpr_read_b32 v24, a194
    s_nop 0
    s_cmp_eq_u64 vcc, 0
    s_cselect_b32 s49, s91, 0x7f000000
    s_cselect_b32 s50, 1, 0
    v_mfma_f32_32x32x16_bf16 v[80:95], a[84:87], v[212:215], v[80:95]
    s_waitcnt lgkmcnt(4)
    s_add_u32 m0, s53, 12288
    s_lshl_b32 s55, s86, 16
    s_add_u32 s55, s55, 32768
    ds_read_b64_tr_b16 a[68:69], v12 offset:30720
    ds_read_b64_tr_b16 a[70:71], v12 offset:31232
    buffer_load_dwordx4 v20, s[16:19], s55 offen lds
    v_mfma_f32_32x32x16_bf16 v[96:111], a[88:91], v[212:215], v[96:111]
    s_waitcnt lgkmcnt(4)
    ds_read_b64_tr_b16 a[72:73], v13 offset:28672
    ds_read_b64_tr_b16 a[74:75], v13 offset:29184
    v_accvgpr_read_b32 v192, a176
    v_accvgpr_read_b32 v193, a177
    v_accvgpr_read_b32 v194, a178
    v_accvgpr_read_b32 v195, a179
    v_cos_f32_e64 v51, v47
    v_mfma_f32_32x32x16_bf16 v[112:127], a[92:95], v[212:215], v[112:127]
    s_waitcnt lgkmcnt(4)
    ds_read_b64_tr_b16 a[76:77], v13 offset:30720
    ds_read_b64_tr_b16 a[78:79], v13 offset:31232
    buffer_load_dwordx4 v21, s[16:19], s55 offen offset:1024 lds
    v_sin_f32_e64 v44, -v44
    v_mfma_f32_32x32x16_bf16 v[64:79], a[64:67], v[216:219], v[64:79]
    s_waitcnt lgkmcnt(4)
    ds_read_b64_tr_b16 a[80:81], v14 offset:28672
    ds_read_b64_tr_b16 a[82:83], v14 offset:29184
    v_accvgpr_read_b32 v203, a180
    v_accvgpr_read_b32 v26, a181
    v_add_u32 v199, 81920, v195
    v_add_u32 v207, 81920, v194
    v_xor_b32 v196, 128, v195
    v_mfma_f32_32x32x16_bf16 v[80:95], a[68:71], v[216:219], v[80:95]
    s_waitcnt lgkmcnt(4)
    ds_read_b64_tr_b16 a[84:85], v14 offset:30720
    ds_read_b64_tr_b16 a[86:87], v14 offset:31232
    buffer_load_dwordx4 v22, s[16:19], s55 offen offset:2048 lds
    v_sin_f32_e64 v45, -v45
    v_mfma_f32_32x32x16_bf16 v[96:111], a[72:75], v[216:219], v[96:111]
    s_waitcnt lgkmcnt(4)
    ds_read_b64_tr_b16 a[88:89], v15 offset:28672
    ds_read_b64_tr_b16 a[90:91], v15 offset:29184
    buffer_load_dwordx4 v23, s[16:19], s55 offen offset:3072 lds
    v_sin_f32_e64 v46, -v46
    v_sin_f32_e64 v47, -v47
    v_mfma_f32_32x32x16_bf16 v[112:127], a[76:79], v[216:219], v[112:127]
    s_waitcnt lgkmcnt(4)
    s_lshl_b32 s57, s84, 12
    s_add_u32 s57, s57, s49
    ds_read_b64_tr_b16 a[92:93], v15 offset:30720
    ds_read_b64_tr_b16 a[94:95], v15 offset:31232
    buffer_load_dwordx4 a[0:3], v16, s[28:31], s57 offen sc1
    v_mfma_f32_32x32x16_bf16 v[64:79], a[80:83], v[220:223], v[64:79]
    s_waitcnt lgkmcnt(4)
    ds_read_b64_tr_b16 a[64:65], v8 offset:32768
    ds_read_b64_tr_b16 a[66:67], v8 offset:33280
    v_xor_b32_e64 v197, 32, v195
    v_xor_b32 v198, 160, v195
    v_xor_b32 v200, 128, v199
    v_xor_b32 v201, 32, v199
    v_cvt_pk_bf16_f32 v152, v48, v49
    v_mfma_f32_32x32x16_bf16 v[80:95], a[84:87], v[220:223], v[80:95]
    s_waitcnt lgkmcnt(4)
    ds_read_b64_tr_b16 a[68:69], v8 offset:34816
    ds_read_b64_tr_b16 a[70:71], v8 offset:35328
    buffer_load_dword v25, v24, s[28:31], 0 offen sc1
    v_cvt_pk_bf16_f32 v153, v50, v51
    v_cvt_pk_bf16_f32 v154, v44, v45
    v_mfma_f32_32x32x16_bf16 v[96:111], a[88:91], v[220:223], v[96:111]
    s_waitcnt lgkmcnt(4)
    ds_read_b64_tr_b16 a[72:73], v9 offset:32768
    ds_read_b64_tr_b16 a[74:75], v9 offset:33280
    buffer_load_dwordx4 a[4:7], v17, s[28:31], s57 offen sc1
    v_cvt_pk_bf16_f32 v155, v46, v47
    v_fmamk_f32 v52, v29, 0x41000000, v35
    v_mfma_f32_32x32x16_bf16 v[112:127], a[92:95], v[220:223], v[112:127]
    s_waitcnt lgkmcnt(4)
    ds_read_b64_tr_b16 a[76:77], v9 offset:34816
    ds_read_b64_tr_b16 a[78:79], v9 offset:35328
    buffer_load_dwordx4 a[8:11], v16, s[28:31], s57 offen offset:1024 sc1
    v_fmamk_f32 v53, v29, 0x41100000, v35
    v_fmamk_f32 v54, v29, 0x41200000, v35
    v_mfma_f32_32x32x16_bf16 v[64:79], a[64:67], v[224:227], v[64:79]
    s_waitcnt lgkmcnt(4)
    s_barrier
    ds_read_b64_tr_b16 a[80:81], v10 offset:32768
    ds_read_b64_tr_b16 a[82:83], v10 offset:33280
    v_xor_b32 v202, 160, v199
    v_add_u32 v204, 81920, v203
    v_mfma_f32_32x32x16_bf16 v[80:95], a[68:71], v[224:227], v[80:95]
    s_waitcnt lgkmcnt(4)
    ds_read_b64_tr_b16 a[84:85], v10 offset:34816
    ds_read_b64_tr_b16 a[86:87], v10 offset:35328
    buffer_load_dwordx4 a[12:15], v17, s[28:31], s57 offen offset:1024 sc1
    v_add_u32 v205, 38912, v2
    v_add_u32 v206, 120832, v2
    v_mfma_f32_32x32x16_bf16 v[96:111], a[72:75], v[224:227], v[96:111]
    s_waitcnt lgkmcnt(4)
    ds_read_b64_tr_b16 a[88:89], v11 offset:32768
    ds_read_b64_tr_b16 a[90:91], v11 offset:33280
    buffer_load_dwordx4 a[16:19], v16, s[28:31], s57 offen offset:2048 sc1
    v_fmamk_f32 v55, v29, 0x41300000, v35
    v_cos_f32 v56, v52
    v_mfma_f32_32x32x16_bf16 v[112:127], a[76:79], v[224:227], v[112:127]
    s_waitcnt lgkmcnt(4)
    ds_read_b64_tr_b16 a[92:93], v11 offset:34816
    ds_read_b64_tr_b16 a[94:95], v11 offset:35328
    buffer_load_dwordx4 a[20:23], v17, s[28:31], s57 offen offset:2048 sc1
    v_cos_f32 v57, v53
    v_mfma_f32_32x32x16_bf16 v[64:79], a[80:83], v[228:231], v[64:79]
    s_waitcnt lgkmcnt(4)
    ds_read_b64_tr_b16 a[64:65], v12 offset:32768
    ds_read_b64_tr_b16 a[66:67], v12 offset:33280
    v_cos_f32 v58, v54
    v_cos_f32 v59, v55
    v_mfma_f32_32x32x16_bf16 v[80:95], a[84:87], v[228:231], v[80:95]
    s_waitcnt lgkmcnt(4)
    s_add_u32 m0, s53, 28672
    s_lshl_b32 s55, s87, 16
    ds_read_b64_tr_b16 a[68:69], v12 offset:34816
    ds_read_b64_tr_b16 a[70:71], v12 offset:35328
    buffer_load_dwordx4 v20, s[16:19], s55 offen lds
    v_mfma_f32_32x32x16_bf16 v[96:111], a[88:91], v[228:231], v[96:111]
    s_waitcnt lgkmcnt(4)
    ds_read_b64_tr_b16 a[72:73], v13 offset:32768
    ds_read_b64_tr_b16 a[74:75], v13 offset:33280
    buffer_load_dwordx4 v21, s[16:19], s55 offen offset:1024 lds
    v_mfma_f32_32x32x16_bf16 v[112:127], a[92:95], v[228:231], v[112:127]
    s_waitcnt lgkmcnt(4)
    ds_read_b64_tr_b16 a[76:77], v13 offset:34816
    ds_read_b64_tr_b16 a[78:79], v13 offset:35328
    buffer_load_dwordx4 a[24:27], v16, s[28:31], s57 offen offset:3072 sc1
    v_mfma_f32_32x32x16_bf16 v[64:79], a[64:67], v[232:235], v[64:79]
    s_waitcnt lgkmcnt(4)
    ds_read_b64_tr_b16 a[80:81], v14 offset:32768
    ds_read_b64_tr_b16 a[82:83], v14 offset:33280
    v_sin_f32_e64 v52, -v52
    v_sin_f32_e64 v53, -v53
    v_mfma_f32_32x32x16_bf16 v[80:95], a[68:71], v[232:235], v[80:95]
    s_waitcnt lgkmcnt(4)
    ds_read_b64_tr_b16 a[84:85], v14 offset:34816
    ds_read_b64_tr_b16 a[86:87], v14 offset:35328
    buffer_load_dwordx4 v22, s[16:19], s55 offen offset:2048 lds
    v_sin_f32_e64 v54, -v54
    v_mfma_f32_32x32x16_bf16 v[96:111], a[72:75], v[232:235], v[96:111]
    s_waitcnt lgkmcnt(4)
    ds_read_b64_tr_b16 a[88:89], v15 offset:32768
    ds_read_b64_tr_b16 a[90:91], v15 offset:33280
    buffer_load_dwordx4 v23, s[16:19], s55 offen offset:3072 lds
    v_mfma_f32_32x32x16_bf16 v[112:127], a[76:79], v[232:235], v[112:127]
    s_waitcnt lgkmcnt(4)
    ds_read_b64_tr_b16 a[92:93], v15 offset:34816
    ds_read_b64_tr_b16 a[94:95], v15 offset:35328
    buffer_load_dwordx4 a[28:31], v17, s[28:31], s57 offen offset:3072 sc1
    v_sin_f32_e64 v55, -v55
    v_mfma_f32_32x32x16_bf16 v[64:79], a[80:83], v[236:239], v[64:79]
    s_waitcnt lgkmcnt(4)
    ds_read_b64_tr_b16 a[64:65], v8
    ds_read_b64_tr_b16 a[66:67], v8 offset:512
    s_waitcnt vmcnt(11)
    v_cmp_gt_u32 vcc, 16, v25
    s_nop 1
    s_cbranch_vccnz L_slow_awd_7
L_ret_awd_7:
    v_mfma_f32_32x32x16_bf16 v[80:95], a[84:87], v[236:239], v[80:95]
    s_waitcnt lgkmcnt(4)
    s_lshl_b32 s57, s85, 12
    s_add_u32 s57, s57, s49
    ds_read_b64_tr_b16 a[68:69], v8 offset:2048
    ds_read_b64_tr_b16 a[70:71], v8 offset:2560
    buffer_load_dwordx4 a[32:35], v16, s[28:31], s57 offen sc1
    v_cvt_pk_bf16_f32 v156, v56, v57
    v_cvt_pk_bf16_f32 v157, v58, v59
    v_mfma_f32_32x32x16_bf16 v[96:111], a[88:91], v[236:239], v[96:111]
    s_waitcnt lgkmcnt(4)
    ds_read_b64_tr_b16 a[72:73], v9
    ds_read_b64_tr_b16 a[74:75], v9 offset:512
    buffer_load_dwordx4 a[36:39], v17, s[28:31], s57 offen sc1
    v_cvt_pk_bf16_f32 v158, v52, v53
    v_mfma_f32_32x32x16_bf16 v[112:127], a[92:95], v[236:239], v[112:127]
    s_waitcnt lgkmcnt(4)
    ds_read_b64_tr_b16 a[76:77], v9 offset:2048
    ds_read_b64_tr_b16 a[78:79], v9 offset:2560
    buffer_load_dwordx4 a[40:43], v16, s[28:31], s57 offen offset:1024 sc1
    v_cvt_pk_bf16_f32 v159, v54, v55
    v_mfma_f32_32x32x16_bf16 v[64:79], a[64:67], v[240:243], v[64:79]
    s_waitcnt lgkmcnt(4)
    s_barrier
    ds_read_b64_tr_b16 a[80:81], v10
    ds_read_b64_tr_b16 a[82:83], v10 offset:512
    v_accvgpr_read_b32 v208, a144
    v_accvgpr_read_b32 v209, a145
    v_mfma_f32_32x32x16_bf16 v[80:95], a[68:71], v[240:243], v[80:95]
    s_waitcnt lgkmcnt(4)
    s_add_u32 s56, s92, 9437184
    s_add_u32 m0, s53, 36864
    ds_read_b64_tr_b16 a[84:85], v10 offset:2048
    ds_read_b64_tr_b16 a[86:87], v10 offset:2560
    buffer_load_dwordx4 v192, s[28:31], s56 offen sc1 lds
    v_accvgpr_read_b32 v210, a146
    v_mfma_f32_32x32x16_bf16 v[96:111], a[72:75], v[240:243], v[96:111]
    s_waitcnt lgkmcnt(4)
    ds_read_b64_tr_b16 a[88:89], v11
    ds_read_b64_tr_b16 a[90:91], v11 offset:512
    buffer_load_dwordx4 a[44:47], v17, s[28:31], s57 offen offset:1024 sc1
    v_accvgpr_read_b32 v211, a147
    v_accvgpr_read_b32 v212, a148
    v_mfma_f32_32x32x16_bf16 v[112:127], a[76:79], v[240:243], v[112:127]
    s_waitcnt lgkmcnt(4)
    ds_read_b64_tr_b16 a[92:93], v11 offset:2048
    ds_read_b64_tr_b16 a[94:95], v11 offset:2560
    buffer_load_dwordx4 a[48:51], v16, s[28:31], s57 offen offset:2048 sc1
    v_accvgpr_read_b32 v213, a149
    v_accvgpr_read_b32 v214, a150
    v_accvgpr_read_b32 v215, a151
    v_mfma_f32_32x32x16_bf16 v[64:79], a[80:83], v[244:247], v[64:79]
    s_waitcnt lgkmcnt(4)
    ds_read_b64_tr_b16 a[64:65], v12
    ds_read_b64_tr_b16 a[66:67], v12 offset:512
    v_accvgpr_read_b32 v216, a152
    v_accvgpr_read_b32 v217, a153
    v_accvgpr_read_b32 v218, a154
    v_accvgpr_read_b32 v219, a155
    v_mfma_f32_32x32x16_bf16 v[80:95], a[84:87], v[244:247], v[80:95]
    s_waitcnt lgkmcnt(4)
    ds_read_b64_tr_b16 a[68:69], v12 offset:2048
    ds_read_b64_tr_b16 a[70:71], v12 offset:2560
    buffer_load_dwordx4 v193, s[28:31], s56 offen offset:1024 sc1 lds
    v_accvgpr_read_b32 v220, a156
    v_mfma_f32_32x32x16_bf16 v[96:111], a[88:91], v[244:247], v[96:111]
    s_waitcnt lgkmcnt(4)
    ds_read_b64_tr_b16 a[72:73], v13
    ds_read_b64_tr_b16 a[74:75], v13 offset:512
    buffer_load_dwordx4 a[52:55], v17, s[28:31], s57 offen offset:2048 sc1
    v_accvgpr_read_b32 v221, a157
    v_accvgpr_read_b32 v222, a158
    v_mfma_f32_32x32x16_bf16 v[112:127], a[92:95], v[244:247], v[112:127]
    s_waitcnt lgkmcnt(4)
    ds_read_b64_tr_b16 a[76:77], v13 offset:2048
    ds_read_b64_tr_b16 a[78:79], v13 offset:2560
    buffer_load_dwordx4 a[56:59], v16, s[28:31], s57 offen offset:3072 sc1
    v_accvgpr_read_b32 v223, a159
    v_mfma_f32_32x32x16_bf16 v[64:79], a[64:67], v[248:251], v[64:79]
    s_waitcnt lgkmcnt(4)
    ds_read_b64_tr_b16 a[80:81], v14
    ds_read_b64_tr_b16 a[82:83], v14 offset:512
    v_accvgpr_read_b32 v224, a160
    v_accvgpr_read_b32 v225, a161
    v_accvgpr_read_b32 v226, a162
    v_accvgpr_read_b32 v227, a163
    v_accvgpr_read_b32 v228, a164
    v_mfma_f32_32x32x16_bf16 v[80:95], a[68:71], v[248:251], v[80:95]
    s_waitcnt lgkmcnt(4)
    s_lshl_b32 s55, s52, 11
    s_add_u32 s56, s92, 12582912
    s_add_u32 s56, s56, s55
    s_add_u32 m0, s53, 32768
    ds_read_b64_tr_b16 a[84:85], v14 offset:2048
    ds_read_b64_tr_b16 a[86:87], v14 offset:2560
    buffer_load_dwordx4 v2, s[28:31], s56 offen sc1 lds
    v_mfma_f32_32x32x16_bf16 v[96:111], a[72:75], v[248:251], v[96:111]
    s_waitcnt lgkmcnt(4)
    ds_read_b64_tr_b16 a[88:89], v15
    ds_read_b64_tr_b16 a[90:91], v15 offset:512
    buffer_load_dwordx4 a[60:63], v17, s[28:31], s57 offen offset:3072 sc1
    v_accvgpr_read_b32 v229, a165
    v_accvgpr_read_b32 v230, a166
    v_accvgpr_read_b32 v231, a167
    v_mfma_f32_32x32x16_bf16 v[112:127], a[76:79], v[248:251], v[112:127]
    s_waitcnt lgkmcnt(4)
    s_lshl_b32 s57, s86, 12
    s_add_u32 s57, s57, s49
    ds_read_b64_tr_b16 a[92:93], v15 offset:2048
    ds_read_b64_tr_b16 a[94:95], v15 offset:2560
    buffer_load_dwordx4 a[196:199], v16, s[28:31], s57 offen sc1
    v_mfma_f32_32x32x16_bf16 v[64:79], a[80:83], v[252:255], v[64:79]
    s_waitcnt lgkmcnt(4)
    v_accvgpr_read_b32 v232, a168
    v_accvgpr_read_b32 v233, a169
    v_accvgpr_read_b32 v234, a170
    v_accvgpr_read_b32 v235, a171
    v_mfma_f32_32x32x16_bf16 v[80:95], a[84:87], v[252:255], v[80:95]
    s_waitcnt lgkmcnt(2)
    buffer_load_dwordx4 v2, s[28:31], s56 offen offset:1024 sc1 lds
    v_accvgpr_read_b32 v236, a172
    v_mfma_f32_32x32x16_bf16 v[96:111], a[88:91], v[252:255], v[96:111]
    s_waitcnt lgkmcnt(0)
    buffer_load_dwordx4 a[200:203], v17, s[28:31], s57 offen sc1
    v_accvgpr_read_b32 v237, a173
    v_accvgpr_read_b32 v238, a174
    v_mfma_f32_32x32x16_bf16 v[112:127], a[92:95], v[252:255], v[112:127]
    buffer_load_dwordx4 a[204:207], v16, s[28:31], s57 offen offset:1024 sc1
    v_accvgpr_read_b32 v239, a175
    buffer_load_dwordx4 a[208:211], v17, s[28:31], s57 offen offset:1024 sc1
    v_pk_mul_f32 v[28:29], v[64:65], v[64:65]
    v_pk_mul_f32 v[30:31], v[66:67], v[66:67]
    v_pk_mul_f32 v[32:33], v[68:69], v[68:69]
    v_pk_mul_f32 v[34:35], v[70:71], v[70:71]
    v_pk_fma_f32 v[28:29], v[28:29], s[20:21], v[6:7] op_sel_hi:[1,1,0]
    v_pk_fma_f32 v[30:31], v[30:31], s[20:21], v[6:7] op_sel_hi:[1,1,0]
    v_pk_fma_f32 v[32:33], v[32:33], s[20:21], v[6:7] op_sel_hi:[1,1,0]
    v_pk_fma_f32 v[34:35], v[34:35], s[20:21], v[6:7] op_sel_hi:[1,1,0]
    v_pk_mul_f32 v[28:29], v[28:29], v[64:65]
    v_pk_mul_f32 v[30:31], v[30:31], v[66:67]
    v_pk_mul_f32 v[32:33], v[32:33], v[68:69]
    v_pk_mul_f32 v[34:35], v[34:35], v[70:71]
    v_exp_f32_e64 v28, v28
    v_pk_mul_f32 v[80:81], v[80:81], v[64:65]
    v_exp_f32_e64 v29, v29
    v_pk_mul_f32 v[82:83], v[82:83], v[66:67]
    v_exp_f32_e64 v30, v30
    v_pk_mul_f32 v[84:85], v[84:85], v[68:69]
    v_exp_f32_e64 v31, v31
    v_pk_mul_f32 v[86:87], v[86:87], v[70:71]
    v_exp_f32_e64 v32, v32
    v_pk_mul_f32 v[36:37], v[72:73], v[72:73]
    v_exp_f32_e64 v33, v33
    v_pk_mul_f32 v[38:39], v[74:75], v[74:75]
    v_exp_f32_e64 v34, v34
    v_pk_mul_f32 v[40:41], v[76:77], v[76:77]
    v_exp_f32_e64 v35, v35
    v_pk_mul_f32 v[42:43], v[78:79], v[78:79]
    v_pk_add_f32 v[28:29], v[28:29], 1.0 op_sel_hi:[1,0]
    v_pk_add_f32 v[30:31], v[30:31], 1.0 op_sel_hi:[1,0]
    v_pk_add_f32 v[32:33], v[32:33], 1.0 op_sel_hi:[1,0]
    v_pk_add_f32 v[34:35], v[34:35], 1.0 op_sel_hi:[1,0]
    v_rcp_f32_e64 v28, v28
    v_pk_fma_f32 v[36:37], v[36:37], s[20:21], v[6:7] op_sel_hi:[1,1,0]
    v_rcp_f32_e64 v29, v29
    v_pk_fma_f32 v[38:39], v[38:39], s[20:21], v[6:7] op_sel_hi:[1,1,0]
    v_rcp_f32_e64 v30, v30
    v_pk_fma_f32 v[40:41], v[40:41], s[20:21], v[6:7] op_sel_hi:[1,1,0]
    v_rcp_f32_e64 v31, v31
    v_pk_fma_f32 v[42:43], v[42:43], s[20:21], v[6:7] op_sel_hi:[1,1,0]
    v_rcp_f32_e64 v32, v32
    v_pk_mul_f32 v[36:37], v[36:37], v[72:73]
    v_rcp_f32_e64 v33, v33
    v_pk_mul_f32 v[38:39], v[38:39], v[74:75]
    v_rcp_f32_e64 v34, v34
    v_pk_mul_f32 v[40:41], v[40:41], v[76:77]
    v_rcp_f32_e64 v35, v35
    v_pk_mul_f32 v[42:43], v[42:43], v[78:79]
    v_pk_mul_f32 v[80:81], v[80:81], v[28:29]
    v_pk_mul_f32 v[82:83], v[82:83], v[30:31]
    v_pk_mul_f32 v[84:85], v[84:85], v[32:33]
    v_pk_mul_f32 v[86:87], v[86:87], v[34:35]
    v_cvt_pk_bf16_f32 v48, v80, v81
    v_cvt_pk_bf16_f32 v49, v82, v83
    v_cvt_pk_bf16_f32 v50, v84, v85
    v_cvt_pk_bf16_f32 v51, v86, v87
    buffer_store_dwordx4 v[48:51], v2, s[28:31], s70 offen sc1
    buffer_load_dwordx4 a[212:215], v16, s[28:31], s57 offen offset:2048 sc1
    v_exp_f32_e64 v36, v36
    v_pk_mul_f32 v[88:89], v[88:89], v[72:73]
    v_exp_f32_e64 v37, v37
    v_pk_mul_f32 v[90:91], v[90:91], v[74:75]
    v_exp_f32_e64 v38, v38
    v_pk_mul_f32 v[92:93], v[92:93], v[76:77]
    v_exp_f32_e64 v39, v39
    v_pk_mul_f32 v[94:95], v[94:95], v[78:79]
    v_exp_f32_e64 v40, v40
    v_pk_mul_f32 v[28:29], v[96:97], v[96:97]
    v_exp_f32_e64 v41, v41
    v_pk_mul_f32 v[30:31], v[98:99], v[98:99]
    v_exp_f32_e64 v42, v42
    v_pk_mul_f32 v[32:33], v[100:101], v[100:101]
    v_exp_f32_e64 v43, v43
    v_pk_mul_f32 v[34:35], v[102:103], v[102:103]
    v_pk_add_f32 v[36:37], v[36:37], 1.0 op_sel_hi:[1,0]
    v_pk_add_f32 v[38:39], v[38:39], 1.0 op_sel_hi:[1,0]
    v_pk_add_f32 v[40:41], v[40:41], 1.0 op_sel_hi:[1,0]
    v_pk_add_f32 v[42:43], v[42:43], 1.0 op_sel_hi:[1,0]
    v_rcp_f32_e64 v36, v36
    v_pk_fma_f32 v[28:29], v[28:29], s[20:21], v[6:7] op_sel_hi:[1,1,0]
    v_rcp_f32_e64 v37, v37
    v_pk_fma_f32 v[30:31], v[30:31], s[20:21], v[6:7] op_sel_hi:[1,1,0]
    v_rcp_f32_e64 v38, v38
    v_pk_fma_f32 v[32:33], v[32:33], s[20:21], v[6:7] op_sel_hi:[1,1,0]
    v_rcp_f32_e64 v39, v39
    v_pk_fma_f32 v[34:35], v[34:35], s[20:21], v[6:7] op_sel_hi:[1,1,0]
    v_rcp_f32_e64 v40, v40
    v_pk_mul_f32 v[28:29], v[28:29], v[96:97]
    v_rcp_f32_e64 v41, v41
    v_pk_mul_f32 v[30:31], v[30:31], v[98:99]
    v_rcp_f32_e64 v42, v42
    v_pk_mul_f32 v[32:33], v[32:33], v[100:101]
    v_rcp_f32_e64 v43, v43
    v_pk_mul_f32 v[34:35], v[34:35], v[102:103]
    v_pk_mul_f32 v[88:89], v[88:89], v[36:37]
    v_pk_mul_f32 v[90:91], v[90:91], v[38:39]
    v_pk_mul_f32 v[92:93], v[92:93], v[40:41]
    v_pk_mul_f32 v[94:95], v[94:95], v[42:43]
    v_cvt_pk_bf16_f32 v52, v88, v89
    v_cvt_pk_bf16_f32 v53, v90, v91
    v_cvt_pk_bf16_f32 v54, v92, v93
    v_cvt_pk_bf16_f32 v55, v94, v95
    buffer_store_dwordx4 v[52:55], v2, s[28:31], s70 offen offset:1024 sc1
    buffer_load_dwordx4 a[216:219], v17, s[28:31], s57 offen offset:2048 sc1
    v_exp_f32_e64 v28, v28
    v_pk_mul_f32 v[112:113], v[112:113], v[96:97]
    v_exp_f32_e64 v29, v29
    v_pk_mul_f32 v[114:115], v[114:115], v[98:99]
    v_exp_f32_e64 v30, v30
    v_pk_mul_f32 v[116:117], v[116:117], v[100:101]
    v_exp_f32_e64 v31, v31
    v_pk_mul_f32 v[118:119], v[118:119], v[102:103]
    v_exp_f32_e64 v32, v32
    v_pk_mul_f32 v[36:37], v[104:105], v[104:105]
    v_exp_f32_e64 v33, v33
    v_pk_mul_f32 v[38:39], v[106:107], v[106:107]
    v_exp_f32_e64 v34, v34
    v_pk_mul_f32 v[40:41], v[108:109], v[108:109]
    v_exp_f32_e64 v35, v35
    v_pk_mul_f32 v[42:43], v[110:111], v[110:111]
    v_pk_add_f32 v[28:29], v[28:29], 1.0 op_sel_hi:[1,0]
    v_pk_add_f32 v[30:31], v[30:31], 1.0 op_sel_hi:[1,0]
    v_pk_add_f32 v[32:33], v[32:33], 1.0 op_sel_hi:[1,0]
    v_pk_add_f32 v[34:35], v[34:35], 1.0 op_sel_hi:[1,0]
    v_rcp_f32_e64 v28, v28
    v_pk_fma_f32 v[36:37], v[36:37], s[20:21], v[6:7] op_sel_hi:[1,1,0]
    v_rcp_f32_e64 v29, v29
    v_pk_fma_f32 v[38:39], v[38:39], s[20:21], v[6:7] op_sel_hi:[1,1,0]
    v_rcp_f32_e64 v30, v30
    v_pk_fma_f32 v[40:41], v[40:41], s[20:21], v[6:7] op_sel_hi:[1,1,0]
    v_rcp_f32_e64 v31, v31
    v_pk_fma_f32 v[42:43], v[42:43], s[20:21], v[6:7] op_sel_hi:[1,1,0]
    v_rcp_f32_e64 v32, v32
    v_pk_mul_f32 v[36:37], v[36:37], v[104:105]
    v_rcp_f32_e64 v33, v33
    v_pk_mul_f32 v[38:39], v[38:39], v[106:107]
    v_rcp_f32_e64 v34, v34
    v_pk_mul_f32 v[40:41], v[40:41], v[108:109]
    v_rcp_f32_e64 v35, v35
    v_pk_mul_f32 v[42:43], v[42:43], v[110:111]
    v_pk_mul_f32 v[112:113], v[112:113], v[28:29]
    v_pk_mul_f32 v[114:115], v[114:115], v[30:31]
    v_pk_mul_f32 v[116:117], v[116:117], v[32:33]
    v_pk_mul_f32 v[118:119], v[118:119], v[34:35]
    v_cvt_pk_bf16_f32 v56, v112, v113
    v_cvt_pk_bf16_f32 v57, v114, v115
    v_cvt_pk_bf16_f32 v58, v116, v117
    v_cvt_pk_bf16_f32 v59, v118, v119
    buffer_store_dwordx4 v[56:59], v2, s[28:31], s70 offen offset:2048 sc1
    buffer_load_dwordx4 a[220:223], v16, s[28:31], s57 offen offset:3072 sc1
    v_exp_f32 v36, v36
    v_exp_f32 v37, v37
    v_pk_mul_f32 v[120:121], v[120:121], v[104:105]
    v_exp_f32 v38, v38
    v_exp_f32 v39, v39
    v_pk_mul_f32 v[122:123], v[122:123], v[106:107]
    v_exp_f32 v40, v40
    v_exp_f32 v41, v41
    v_pk_mul_f32 v[124:125], v[124:125], v[108:109]
    v_exp_f32 v42, v42
    v_exp_f32 v43, v43
    v_pk_mul_f32 v[126:127], v[126:127], v[110:111]
    v_pk_add_f32 v[36:37], v[36:37], 1.0 op_sel_hi:[1,0]
    v_pk_add_f32 v[38:39], v[38:39], 1.0 op_sel_hi:[1,0]
    v_pk_add_f32 v[40:41], v[40:41], 1.0 op_sel_hi:[1,0]
    v_pk_add_f32 v[42:43], v[42:43], 1.0 op_sel_hi:[1,0]
    buffer_load_dwordx4 a[224:227], v17, s[28:31], s57 offen offset:3072 sc1
    v_rcp_f32 v36, v36
    v_rcp_f32 v37, v37
    v_rcp_f32 v38, v38
    v_rcp_f32 v39, v39
    v_rcp_f32 v40, v40
    v_rcp_f32 v41, v41
    v_rcp_f32 v42, v42
    v_rcp_f32 v43, v43
    v_pk_mul_f32 v[120:121], v[120:121], v[36:37]
    v_pk_mul_f32 v[122:123], v[122:123], v[38:39]
    v_pk_mul_f32 v[124:125], v[124:125], v[40:41]
    v_pk_mul_f32 v[126:127], v[126:127], v[42:43]
    v_cvt_pk_bf16_f32 v60, v120, v121
    v_cvt_pk_bf16_f32 v61, v122, v123
    v_cvt_pk_bf16_f32 v62, v124, v125
    v_cvt_pk_bf16_f32 v63, v126, v127
    buffer_store_dwordx4 v[60:63], v2, s[28:31], s70 offen offset:3072 sc1
    s_waitcnt vmcnt(11)
    s_barrier
    ds_read_b128 v[80:83], v195
    ds_read_b128 v[84:87], v196
    ds_read_b128 v[88:91], v197
    ds_read_b128 v[92:95], v198
    ds_read_b128 v[96:99], v199
    ds_read_b128 v[100:103], v200
    ds_read_b128 v[104:107], v201
    ds_read_b128 v[108:111], v202
    ds_read2st64_b32 v[240:241], v194 offset0:0 offset1:1
    ds_read2st64_b32 v[242:243], v194 offset0:2 offset1:3
    ds_read2st64_b32 v[244:245], v207 offset0:0 offset1:1
    ds_read2st64_b32 v[246:247], v207 offset0:2 offset1:3
    v_accvgpr_read_b32 v8, a182
    v_accvgpr_read_b32 v10, a183
    v_accvgpr_read_b32 v12, a184
    v_accvgpr_read_b32 v32, a193
    v_accvgpr_read_b32 v28, a195
    s_waitcnt lgkmcnt(11)
    v_mfma_f32_16x16x32_bf16 v[64:67], v[80:83], a[96:99], 0
    v_mfma_f32_16x16x32_bf16 v[72:75], v[80:83], a[112:115], 0
    v_xor_b32_e64 v9, 64, v8
    s_waitcnt lgkmcnt(10)
    v_mfma_f32_16x16x32_bf16 v[64:67], v[84:87], a[100:103], v[64:67]
    v_mfma_f32_16x16x32_bf16 v[72:75], v[84:87], a[116:119], v[72:75]
    v_xor_b32 v11, 128, v10
    s_waitcnt lgkmcnt(9)
    v_mfma_f32_16x16x32_bf16 v[64:67], v[88:91], a[104:107], v[64:67]
    v_mfma_f32_16x16x32_bf16 v[72:75], v[88:91], a[96:99], v[72:75]
    s_waitcnt lgkmcnt(8)
    v_mfma_f32_16x16x32_bf16 v[64:67], v[92:95], a[108:111], v[64:67]
    v_xor_b32_e64 v29, 32, v28
    v_mfma_f32_16x16x32_bf16 v[72:75], v[92:95], a[100:103], v[72:75]
    s_waitcnt lgkmcnt(7)
    v_mfma_f32_16x16x32_bf16 v[68:71], v[96:99], a[96:99], 0
    v_mfma_f32_16x16x32_bf16 v[76:79], v[96:99], a[112:115], 0
    v_add_u32 v13, 32768, v12
    s_waitcnt lgkmcnt(6)
    v_mfma_f32_16x16x32_bf16 v[68:71], v[100:103], a[100:103], v[68:71]
    v_mfma_f32_16x16x32_bf16 v[76:79], v[100:103], a[116:119], v[76:79]
    v_add_u32 v14, 65536, v12
    s_waitcnt lgkmcnt(5)
    v_mfma_f32_16x16x32_bf16 v[68:71], v[104:107], a[104:107], v[68:71]
    v_mfma_f32_16x16x32_bf16 v[76:79], v[104:107], a[96:99], v[76:79]
    s_waitcnt lgkmcnt(4)
    v_mfma_f32_16x16x32_bf16 v[68:71], v[108:111], a[108:111], v[68:71]
    v_add_u32 v15, 98304, v12
    v_mfma_f32_16x16x32_bf16 v[76:79], v[108:111], a[100:103], v[76:79]
    s_waitcnt lgkmcnt(3)
    v_lshlrev_b32 v44, 16, v240
    v_and_b32 v52, s82, v240
    v_lshlrev_b32 v45, 16, v241
    v_and_b32 v53, s82, v241
    s_waitcnt lgkmcnt(2)
    v_lshlrev_b32 v46, 16, v242
    v_and_b32 v54, s82, v242
    v_lshlrev_b32 v47, 16, v243
    v_and_b32 v55, s82, v243
    s_waitcnt lgkmcnt(1)
    v_lshlrev_b32 v48, 16, v244
    v_and_b32 v56, s82, v244
    v_lshlrev_b32 v49, 16, v245
    v_and_b32 v57, s82, v245
    s_waitcnt lgkmcnt(0)
    v_lshlrev_b32 v50, 16, v246
    v_and_b32 v58, s82, v246
    v_lshlrev_b32 v51, 16, v247
    v_and_b32 v59, s82, v247
    v_pk_mul_f32 v[112:113], v[64:65], v[208:209]
    v_pk_mul_f32 v[120:121], v[72:73], v[208:209]
    v_pk_mul_f32 v[114:115], v[66:67], v[210:211]
    v_pk_mul_f32 v[122:123], v[74:75], v[210:211]
    v_pk_mul_f32 v[116:117], v[68:69], v[212:213]
    v_pk_mul_f32 v[124:125], v[76:77], v[212:213]
    v_pk_mul_f32 v[118:119], v[70:71], v[214:215]
    v_pk_mul_f32 v[126:127], v[78:79], v[214:215]
    v_pk_fma_f32 v[112:113], v[72:73], v[216:217], v[112:113]
    v_pk_fma_f32 v[120:121], v[64:65], v[216:217], v[120:121] neg_lo:[1,0,0] neg_hi:[1,0,0]
    v_pk_fma_f32 v[114:115], v[74:75], v[218:219], v[114:115]
    v_pk_fma_f32 v[122:123], v[66:67], v[218:219], v[122:123] neg_lo:[1,0,0] neg_hi:[1,0,0]
    v_pk_fma_f32 v[116:117], v[76:77], v[220:221], v[116:117]
    v_pk_fma_f32 v[124:125], v[68:69], v[220:221], v[124:125] neg_lo:[1,0,0] neg_hi:[1,0,0]
    v_pk_fma_f32 v[118:119], v[78:79], v[222:223], v[118:119]
    v_pk_fma_f32 v[126:127], v[70:71], v[222:223], v[126:127] neg_lo:[1,0,0] neg_hi:[1,0,0]
    v_cvt_pk_bf16_f32 v80, v112, v113
    v_cvt_pk_bf16_f32 v81, v114, v115
    v_cvt_pk_bf16_f32 v82, v116, v117
    v_cvt_pk_bf16_f32 v83, v118, v119
    v_cvt_pk_bf16_f32 v84, v120, v121
    v_cvt_pk_bf16_f32 v85, v122, v123
    v_cvt_pk_bf16_f32 v86, v124, v125
    v_cvt_pk_bf16_f32 v87, v126, v127
    v_mfma_f32_16x16x32_bf16 v[64:67], a[120:123], v[80:83], 0
    s_nop 0
    v_mfma_f32_16x16x32_bf16 v[72:75], a[120:123], v[84:87], 0
    v_mfma_f32_16x16x32_bf16 v[68:71], a[124:127], v[80:83], 0
    v_mfma_f32_16x16x32_bf16 v[76:79], a[124:127], v[84:87], 0
    v_mfma_f32_16x16x32_bf16 v[64:67], a[128:131], v[84:87], v[64:67]
    v_mfma_f32_16x16x32_bf16 v[72:75], a[136:139], v[80:83], v[72:75]
    v_mfma_f32_16x16x32_bf16 v[68:71], a[132:135], v[84:87], v[68:71]
    v_mfma_f32_16x16x32_bf16 v[76:79], a[140:143], v[80:83], v[76:79]
    s_add_u32 s56, s48, 16384
    s_waitcnt vmcnt(0)
    buffer_atomic_add v5, v4, s[28:31], s56 offen sc1
    v_lshrrev_b32 v31, 4, v1
    v_and_b32 v30, 7, v1
    v_xor_b32 v30, v30, v31
    v_lshrrev_b32 v31, 3, v1
    v_lshlrev_b32_e64 v30, 4, v30
    v_lshl_add_u32 v30, v31, 15, v30
    v_xor_b32_e64 v31, 64, v30
    v_add_u32 v31, 261120, v31
    v_min_u32_e64 v24, 1, v1
    v_lshlrev_b32 v24, 8, v24
    v_pk_mul_f32 v[112:113], v[64:65], v[44:45]
    v_pk_mul_f32 v[120:121], v[72:73], v[44:45]
    v_pk_mul_f32 v[114:115], v[66:67], v[46:47]
    v_pk_mul_f32 v[122:123], v[74:75], v[46:47]
    v_pk_mul_f32 v[116:117], v[68:69], v[48:49]
    v_pk_mul_f32 v[124:125], v[76:77], v[48:49]
    v_pk_mul_f32 v[118:119], v[70:71], v[50:51]
    v_pk_mul_f32 v[126:127], v[78:79], v[50:51]
    v_pk_fma_f32 v[112:113], v[72:73], v[52:53], v[112:113] neg_lo:[1,0,0] neg_hi:[1,0,0]
    v_pk_fma_f32 v[120:121], v[64:65], v[52:53], v[120:121]
    v_pk_fma_f32 v[114:115], v[74:75], v[54:55], v[114:115] neg_lo:[1,0,0] neg_hi:[1,0,0]
    v_pk_fma_f32 v[122:123], v[66:67], v[54:55], v[122:123]
    v_pk_fma_f32 v[116:117], v[76:77], v[56:57], v[116:117] neg_lo:[1,0,0] neg_hi:[1,0,0]
    v_pk_fma_f32 v[124:125], v[68:69], v[56:57], v[124:125]
    v_pk_fma_f32 v[118:119], v[78:79], v[58:59], v[118:119] neg_lo:[1,0,0] neg_hi:[1,0,0]
    v_pk_fma_f32 v[126:127], v[70:71], v[58:59], v[126:127]
    v_cvt_pk_bf16_f32 v88, v112, v113
    v_cvt_pk_bf16_f32 v89, v114, v115
    v_cvt_pk_bf16_f32 v90, v116, v117
    v_cvt_pk_bf16_f32 v91, v118, v119
    v_cvt_pk_bf16_f32 v92, v120, v121
    v_cvt_pk_bf16_f32 v93, v122, v123
    v_cvt_pk_bf16_f32 v94, v124, v125
    v_cvt_pk_bf16_f32 v95, v126, v127
    v_mfma_f32_16x16x32_bf16 v[64:67], v[88:91], a[120:123], 0
    s_nop 0
    v_mfma_f32_16x16x32_bf16 v[72:75], v[92:95], a[120:123], 0
    v_mfma_f32_16x16x32_bf16 v[68:71], v[88:91], a[124:127], 0
    v_mfma_f32_16x16x32_bf16 v[76:79], v[92:95], a[124:127], 0
    v_mfma_f32_16x16x32_bf16 v[64:67], v[92:95], a[136:139], v[64:67]
    v_mfma_f32_16x16x32_bf16 v[72:75], v[88:91], a[128:131], v[72:75]
    v_mfma_f32_16x16x32_bf16 v[68:71], v[92:95], a[140:143], v[68:71]
    v_mfma_f32_16x16x32_bf16 v[76:79], v[88:91], a[132:135], v[76:79]
    ds_read_b64_tr_b16 a[64:65], v8 offset:16384
    ds_read_b64_tr_b16 a[66:67], v8 offset:17408
    ds_read_b64_tr_b16 a[68:69], v9 offset:16384
    ds_read_b64_tr_b16 a[70:71], v9 offset:17408
    s_lshr_b32 s22, s2, 3
    s_add_u32 s22, s22, 160
    s_lshl_b32 s22, s22, 8
    s_add_u32 s0, s92, 15728640
    v_pk_mul_f32 v[112:113], v[64:65], v[224:225]
    v_pk_mul_f32 v[120:121], v[72:73], v[224:225]
    v_pk_mul_f32 v[114:115], v[66:67], v[226:227]
    v_pk_mul_f32 v[122:123], v[74:75], v[226:227]
    v_pk_mul_f32 v[116:117], v[68:69], v[228:229]
    v_pk_mul_f32 v[124:125], v[76:77], v[228:229]
    v_pk_mul_f32 v[118:119], v[70:71], v[230:231]
    v_pk_mul_f32 v[126:127], v[78:79], v[230:231]
    v_pk_fma_f32 v[112:113], v[72:73], v[232:233], v[112:113] neg_lo:[1,0,0] neg_hi:[1,0,0]
    v_pk_fma_f32 v[120:121], v[64:65], v[232:233], v[120:121]
    v_pk_fma_f32 v[114:115], v[74:75], v[234:235], v[114:115] neg_lo:[1,0,0] neg_hi:[1,0,0]
    v_pk_fma_f32 v[122:123], v[66:67], v[234:235], v[122:123]
    v_pk_fma_f32 v[116:117], v[76:77], v[236:237], v[116:117] neg_lo:[1,0,0] neg_hi:[1,0,0]
    v_pk_fma_f32 v[124:125], v[68:69], v[236:237], v[124:125]
    v_pk_fma_f32 v[118:119], v[78:79], v[238:239], v[118:119] neg_lo:[1,0,0] neg_hi:[1,0,0]
    v_pk_fma_f32 v[126:127], v[70:71], v[238:239], v[126:127]
    v_cvt_pk_bf16_f32 v80, v112, v113
    v_cvt_pk_bf16_f32 v81, v114, v115
    v_cvt_pk_bf16_f32 v82, v116, v117
    v_cvt_pk_bf16_f32 v83, v118, v119
    v_cvt_pk_bf16_f32 v84, v120, v121
    v_cvt_pk_bf16_f32 v85, v122, v123
    v_cvt_pk_bf16_f32 v86, v124, v125
    v_cvt_pk_bf16_f32 v87, v126, v127
    ds_write_b64 v203, v[80:81]
    ds_write_b64 v203, v[84:85] offset:40960
    ds_write_b64 v204, v[82:83]
    ds_write_b64 v204, v[86:87] offset:40960
    s_waitcnt lgkmcnt(0)
    s_barrier
    ds_read_b128 v[80:83], v205
    ds_read_b128 v[84:87], v205 offset:1024
    ds_read_b128 v[88:91], v205 offset:40960
    ds_read_b128 v[92:95], v205 offset:41984
    ds_read_b128 v[96:99], v206
    ds_read_b128 v[100:103], v206 offset:1024
    ds_read_b128 v[104:107], v206 offset:40960
    ds_read_b128 v[108:111], v206 offset:41984
    s_add_u32 m0, s53, 0
    s_lshl_b32 s55, s87, 16
    s_add_u32 s55, s55, 32768
    buffer_load_dwordx4 v20, s[16:19], s55 offen lds
    buffer_load_dwordx4 v21, s[16:19], s55 offen offset:1024 lds
    s_waitcnt lgkmcnt(7)
    v_mfma_f32_16x16x32_bf16 v[64:67], a[96:99], v[80:83], 0
    v_mfma_f32_16x16x32_bf16 v[72:75], a[104:107], v[80:83], 0
    s_waitcnt lgkmcnt(6)
    v_mfma_f32_16x16x32_bf16 v[64:67], a[100:103], v[84:87], v[64:67]
    v_mfma_f32_16x16x32_bf16 v[72:75], a[108:111], v[84:87], v[72:75]
    s_waitcnt lgkmcnt(5)
    v_mfma_f32_16x16x32_bf16 v[64:67], a[112:115], v[88:91], v[64:67]
    v_mfma_f32_16x16x32_bf16 v[72:75], a[96:99], v[88:91], v[72:75]
    s_waitcnt lgkmcnt(4)
    v_mfma_f32_16x16x32_bf16 v[64:67], a[116:119], v[92:95], v[64:67]
    v_mfma_f32_16x16x32_bf16 v[72:75], a[100:103], v[92:95], v[72:75]
    s_waitcnt lgkmcnt(3)
    v_mfma_f32_16x16x32_bf16 v[68:71], a[96:99], v[96:99], 0
    v_mfma_f32_16x16x32_bf16 v[76:79], a[104:107], v[96:99], 0
    s_waitcnt lgkmcnt(2)
    v_mfma_f32_16x16x32_bf16 v[68:71], a[100:103], v[100:103], v[68:71]
    v_mfma_f32_16x16x32_bf16 v[76:79], a[108:111], v[100:103], v[76:79]
    s_waitcnt lgkmcnt(1)
    v_mfma_f32_16x16x32_bf16 v[68:71], a[112:115], v[104:107], v[68:71]
    v_mfma_f32_16x16x32_bf16 v[76:79], a[96:99], v[104:107], v[76:79]
    s_waitcnt lgkmcnt(0)
    v_mfma_f32_16x16x32_bf16 v[68:71], a[116:119], v[108:111], v[68:71]
    v_mfma_f32_16x16x32_bf16 v[76:79], a[100:103], v[108:111], v[76:79]
    buffer_load_dwordx4 v22, s[16:19], s55 offen offset:2048 lds
    buffer_load_dwordx4 v23, s[16:19], s55 offen offset:3072 lds
    v_cvt_pk_bf16_f32 v248, v64, v65
    v_cvt_pk_bf16_f32 v249, v66, v67
    v_cvt_pk_bf16_f32 v250, v72, v73
    v_cvt_pk_bf16_f32 v251, v74, v75
    s_nop 0
    v_cvt_pk_bf16_f32 v252, v68, v69
    v_cvt_pk_bf16_f32 v253, v70, v71
    v_cvt_pk_bf16_f32 v254, v76, v77
    v_cvt_pk_bf16_f32 v255, v78, v79
    buffer_store_dwordx4 v[248:251], v26, s[28:31], s0 offen sc1
    s_add_u32 s0, s0, 4096
    buffer_store_dwordx4 v[252:255], v26, s[28:31], s0 offen sc1
    s_cmp_eq_u32 s50, 0
    s_cbranch_scc1 L_slow_h1d_8
L_ret_h1d_8:
    s_add_u32 s51, s51, 16384
    v_mfma_f32_32x32x16_bf16 v[64:79], a[64:67], a[0:3], 0
    ds_read_b64_tr_b16 a[72:73], v8 offset:18432
    ds_read_b64_tr_b16 a[74:75], v8 offset:19456
    v_accvgpr_read_b32 v192, a187
    v_accvgpr_read_b32 v194, a189
    v_accvgpr_read_b32 v196, a191
    v_mfma_f32_32x32x16_bf16 v[96:111], a[64:67], a[4:7], 0
    s_add_u32 m0, s53, 32768
    s_lshl_b32 s55, s88, 16
    ds_read_b64_tr_b16 a[76:77], v9 offset:18432
    ds_read_b64_tr_b16 a[78:79], v9 offset:19456
    buffer_load_dwordx4 v20, s[16:19], s55 offen lds
    v_mfma_f32_32x32x16_bf16 v[80:95], a[68:71], a[0:3], 0
    buffer_load_dwordx4 v21, s[16:19], s55 offen offset:1024 lds
    v_accvgpr_read_b32 v193, a188
    v_mfma_f32_32x32x16_bf16 v[112:127], a[68:71], a[4:7], 0
    s_waitcnt lgkmcnt(2)
    buffer_load_dwordx4 v22, s[16:19], s55 offen offset:2048 lds
    v_accvgpr_read_b32 v195, a190
    v_accvgpr_read_b32 v197, a192
    v_mfma_f32_32x32x16_bf16 v[64:79], a[72:75], a[8:11], v[64:79]
    ds_read_b64_tr_b16 a[80:81], v8 offset:20480
    ds_read_b64_tr_b16 a[82:83], v8 offset:21504
    s_add_u32 s26, s80, 2
    s_and_b32 s26, s26, 3
    s_cselect_b64 s[24:25], 0, -1
    s_lshl_b32 s26, s26, 4
    v_mfma_f32_32x32x16_bf16 v[96:111], a[72:75], a[12:15], v[96:111]
    s_waitcnt lgkmcnt(2)
    ds_read_b64_tr_b16 a[84:85], v9 offset:20480
    ds_read_b64_tr_b16 a[86:87], v9 offset:21504
    buffer_load_dwordx4 v23, s[16:19], s55 offen offset:3072 lds
    v_cvt_f32_u32_e64 v199, s26
    v_fma_f32 v198, v199, v192, v194
    v_mfma_f32_32x32x16_bf16 v[80:95], a[76:79], a[8:11], v[80:95]
    s_lshl_b32 s55, s52, 19
    s_lshl_b32 s83, s79, 10
    s_add_u32 s55, s55, s83
    s_lshl_b32 s83, s80, 7
    s_add_u32 m0, s53, 36864
    s_add_u32 s55, s55, s83
    buffer_load_dwordx4 v30, s[4:7], s55 offen lds
    v_mfma_f32_32x32x16_bf16 v[112:127], a[76:79], a[12:15], v[112:127]
    s_waitcnt lgkmcnt(2)
    buffer_load_dwordx4 v31, s[4:7], s55 offen offset:1024 lds
    v_fma_f32 v199, v199, v193, v195
    v_cndmask_b32 v200, v198, v196, s[24:25]
    v_fmamk_f32 v201, v192, 0x3f800000, v198
    v_mfma_f32_32x32x16_bf16 v[64:79], a[80:83], a[16:19], v[64:79]
    ds_read_b64_tr_b16 a[88:89], v8 offset:22528
    ds_read_b64_tr_b16 a[90:91], v8 offset:23552
    v_fmamk_f32 v202, v192, 0x40000000, v198
    v_fmamk_f32 v203, v192, 0x40400000, v198
    v_cos_f32_e64 v204, v200
    v_mfma_f32_32x32x16_bf16 v[96:111], a[80:83], a[20:23], v[96:111]
    s_waitcnt lgkmcnt(2)
    s_add_u32 m0, s53, 16384
    s_lshl_b32 s55, s88, 16
    s_add_u32 s55, s55, 32768
    ds_read_b64_tr_b16 a[92:93], v9 offset:22528
    ds_read_b64_tr_b16 a[94:95], v9 offset:23552
    buffer_load_dwordx4 v20, s[16:19], s55 offen lds
    v_mfma_f32_32x32x16_bf16 v[80:95], a[84:87], a[16:19], v[80:95]
    buffer_load_dwordx4 v21, s[16:19], s55 offen offset:1024 lds
    v_cos_f32_e64 v205, v201
    v_cos_f32 v206, v202
    v_mfma_f32_32x32x16_bf16 v[112:127], a[84:87], a[20:23], v[112:127]
    s_waitcnt lgkmcnt(2)
    buffer_load_dwordx4 v22, s[16:19], s55 offen offset:2048 lds
    v_cos_f32_e64 v207, v203
    v_mfma_f32_32x32x16_bf16 v[64:79], a[88:91], a[24:27], v[64:79]
    ds_read_b64_tr_b16 a[64:65], v8 offset:24576
    ds_read_b64_tr_b16 a[66:67], v8 offset:25600
    v_sin_f32_e64 v200, -v200
    v_mfma_f32_32x32x16_bf16 v[96:111], a[88:91], a[28:31], v[96:111]
    s_waitcnt lgkmcnt(2)
    ds_read_b64_tr_b16 a[68:69], v9 offset:24576
    ds_read_b64_tr_b16 a[70:71], v9 offset:25600
    v_sin_f32_e64 v201, -v201
    v_mfma_f32_32x32x16_bf16 v[80:95], a[92:95], a[24:27], v[80:95]
    buffer_load_dwordx4 v23, s[16:19], s55 offen offset:3072 lds
    v_sin_f32_e64 v202, -v202
    v_mfma_f32_32x32x16_bf16 v[112:127], a[92:95], a[28:31], v[112:127]
    s_waitcnt lgkmcnt(2)
    v_sin_f32_e64 v203, -v203
    v_cvt_pk_bf16_f32 v160, v204, v205
    v_mfma_f32_32x32x16_bf16 v[64:79], a[64:67], a[32:35], v[64:79]
    ds_read_b64_tr_b16 a[72:73], v8 offset:26624
    ds_read_b64_tr_b16 a[74:75], v8 offset:27648
    v_cvt_pk_bf16_f32 v161, v206, v207
    v_cvt_pk_bf16_f32 v162, v200, v201
    v_cvt_pk_bf16_f32 v163, v202, v203
    v_cndmask_b32 v208, v199, v197, s[24:25]
    v_mfma_f32_32x32x16_bf16 v[96:111], a[64:67], a[36:39], v[96:111]
    s_waitcnt lgkmcnt(2)
    ds_read_b64_tr_b16 a[76:77], v9 offset:26624
    ds_read_b64_tr_b16 a[78:79], v9 offset:27648
    s_waitcnt vmcnt(10)
    buffer_atomic_add v5, v4, s[28:31], s22 offen sc1
    v_fmamk_f32 v209, v193, 0x3f800000, v199
    v_mfma_f32_32x32x16_bf16 v[80:95], a[68:71], a[32:35], v[80:95]
    s_add_u32 m0, s53, 20480
    s_lshl_b32 s55, s89, 16
    buffer_load_dwordx4 v20, s[16:19], s55 offen lds
    v_fmamk_f32 v210, v193, 0x40000000, v199
    v_mfma_f32_32x32x16_bf16 v[112:127], a[68:71], a[36:39], v[112:127]
    s_waitcnt lgkmcnt(2)
    buffer_load_dwordx4 v21, s[16:19], s55 offen offset:1024 lds
    v_fmamk_f32 v211, v193, 0x40400000, v199
    v_cos_f32_e64 v212, v208
    v_mfma_f32_32x32x16_bf16 v[64:79], a[72:75], a[40:43], v[64:79]
    ds_read_b64_tr_b16 a[80:81], v8 offset:4096
    ds_read_b64_tr_b16 a[82:83], v8 offset:5120
    v_cos_f32_e64 v213, v209
    v_cos_f32 v214, v210
    v_mfma_f32_32x32x16_bf16 v[96:111], a[72:75], a[44:47], v[96:111]
    s_waitcnt lgkmcnt(2)
    ds_read_b64_tr_b16 a[84:85], v9 offset:4096
    ds_read_b64_tr_b16 a[86:87], v9 offset:5120
    buffer_load_dword v25, v24, s[28:31], s51 offen sc1
    v_mfma_f32_32x32x16_bf16 v[80:95], a[76:79], a[40:43], v[80:95]
    buffer_load_dwordx4 v22, s[16:19], s55 offen offset:2048 lds
    v_cos_f32 v215, v211
    v_sin_f32_e64 v208, -v208
    v_mfma_f32_32x32x16_bf16 v[112:127], a[76:79], a[44:47], v[112:127]
    s_waitcnt lgkmcnt(2)
    buffer_load_dwordx4 v23, s[16:19], s55 offen offset:3072 lds
    v_sin_f32_e64 v209, -v209
    v_mfma_f32_32x32x16_bf16 v[64:79], a[80:83], a[48:51], v[64:79]
    ds_read_b64_tr_b16 a[88:89], v8 offset:6144
    ds_read_b64_tr_b16 a[90:91], v8 offset:7168
    v_sin_f32_e64 v210, -v210
    v_sin_f32_e64 v211, -v211
    v_mfma_f32_32x32x16_bf16 v[96:111], a[80:83], a[52:55], v[96:111]
    s_waitcnt lgkmcnt(2)
    s_add_u32 m0, s53, 24576
    s_lshl_b32 s55, s89, 16
    s_add_u32 s55, s55, 32768
    ds_read_b64_tr_b16 a[92:93], v9 offset:6144
    ds_read_b64_tr_b16 a[94:95], v9 offset:7168
    buffer_load_dwordx4 v20, s[16:19], s55 offen lds
    v_mfma_f32_32x32x16_bf16 v[80:95], a[84:87], a[48:51], v[80:95]
    buffer_load_dwordx4 v21, s[16:19], s55 offen offset:1024 lds
    v_cvt_pk_bf16_f32 v164, v212, v213
    v_cvt_pk_bf16_f32 v165, v214, v215
    v_mfma_f32_32x32x16_bf16 v[112:127], a[84:87], a[52:55], v[112:127]
    s_waitcnt lgkmcnt(2)
    buffer_load_dwordx4 v22, s[16:19], s55 offen offset:2048 lds
    v_cvt_pk_bf16_f32 v166, v208, v209
    v_cvt_pk_bf16_f32 v167, v210, v211
    v_fmamk_f32 v200, v192, 0x41000000, v198
    v_mfma_f32_32x32x16_bf16 v[64:79], a[88:91], a[56:59], v[64:79]
    ds_read_b64_tr_b16 a[64:65], v8 offset:8192
    ds_read_b64_tr_b16 a[66:67], v8 offset:9216
    v_fmamk_f32 v201, v192, 0x41100000, v198
    v_fmamk_f32 v202, v192, 0x41200000, v198
    v_mfma_f32_32x32x16_bf16 v[96:111], a[88:91], a[60:63], v[96:111]
    s_waitcnt lgkmcnt(2)
    ds_read_b64_tr_b16 a[68:69], v9 offset:8192
    ds_read_b64_tr_b16 a[70:71], v9 offset:9216
    v_fmamk_f32 v203, v192, 0x41300000, v198
    v_cos_f32_e64 v204, v200
    v_mfma_f32_32x32x16_bf16 v[80:95], a[92:95], a[56:59], v[80:95]
    buffer_load_dwordx4 v23, s[16:19], s55 offen offset:3072 lds
    v_mfma_f32_32x32x16_bf16 v[112:127], a[92:95], a[60:63], v[112:127]
    s_waitcnt lgkmcnt(2)
    v_cos_f32 v205, v201
    v_cos_f32 v206, v202
    v_mfma_f32_32x32x16_bf16 v[64:79], a[64:67], a[196:199], v[64:79]
    s_add_u32 m0, s53, 4096
    s_lshl_b32 s55, s90, 16
    ds_read_b64_tr_b16 a[72:73], v8 offset:10240
    ds_read_b64_tr_b16 a[74:75], v8 offset:11264
    buffer_load_dwordx4 v20, s[16:19], s55 offen lds
    s_waitcnt vmcnt(7)
    v_cmp_gt_u32 vcc, 16, v25
    v_mfma_f32_32x32x16_bf16 v[96:111], a[64:67], a[200:203], v[96:111]
    s_waitcnt lgkmcnt(2)
    ds_read_b64_tr_b16 a[76:77], v9 offset:10240
    ds_read_b64_tr_b16 a[78:79], v9 offset:11264
    buffer_load_dwordx4 v21, s[16:19], s55 offen offset:1024 lds
    s_cbranch_vccnz L_slow_h2d_9
L_ret_h2d_9:
    v_cos_f32 v207, v203
    v_mfma_f32_32x32x16_bf16 v[80:95], a[68:71], a[196:199], v[80:95]
    buffer_load_dwordx4 v22, s[16:19], s55 offen offset:2048 lds
    v_sin_f32_e64 v200, -v200
    v_sin_f32_e64 v201, -v201
    v_mfma_f32_32x32x16_bf16 v[112:127], a[68:71], a[200:203], v[112:127]
    s_waitcnt lgkmcnt(2)
    buffer_load_dwordx4 v23, s[16:19], s55 offen offset:3072 lds
    v_sin_f32_e64 v202, -v202
    v_sin_f32_e64 v203, -v203
    v_mfma_f32_32x32x16_bf16 v[64:79], a[72:75], a[204:207], v[64:79]
    s_lshl_b32 s57, s87, 12
    s_add_u32 s57, s57, s91
    ds_read_b64_tr_b16 a[80:81], v8 offset:12288
    ds_read_b64_tr_b16 a[82:83], v8 offset:13312
    buffer_load_dwordx4 a[228:231], v16, s[28:31], s57 offen sc1
    v_min_u32 v24, 31, v1
    v_add_u32 v24, 160, v24
    v_mfma_f32_32x32x16_bf16 v[96:111], a[72:75], a[208:211], v[96:111]
    s_waitcnt lgkmcnt(2)
    ds_read_b64_tr_b16 a[84:85], v9 offset:12288
    ds_read_b64_tr_b16 a[86:87], v9 offset:13312
    buffer_load_dwordx4 a[232:235], v17, s[28:31], s57 offen sc1
    v_lshlrev_b32_e64 v24, 8, v24
    v_mfma_f32_32x32x16_bf16 v[80:95], a[76:79], a[204:207], v[80:95]
    buffer_load_dwordx4 a[236:239], v16, s[28:31], s57 offen offset:1024 sc1
    s_cmp_eq_u32 s52, 0
    s_cselect_b32 s23, 32, 0
    s_cselect_b32 s27, 0, 0x7f000000
    v_cvt_pk_bf16_f32 v168, v204, v205
    v_cvt_pk_bf16_f32 v169, v206, v207
    v_cvt_pk_bf16_f32 v170, v200, v201
    v_cvt_pk_bf16_f32 v171, v202, v203
    v_fmamk_f32 v208, v193, 0x41000000, v199
    v_mfma_f32_32x32x16_bf16 v[112:127], a[76:79], a[208:211], v[112:127]
    s_waitcnt lgkmcnt(2)
    buffer_load_dwordx4 a[240:243], v17, s[28:31], s57 offen offset:1024 sc1
    v_fmamk_f32 v209, v193, 0x41100000, v199
    v_fmamk_f32 v210, v193, 0x41200000, v199
    v_fmamk_f32 v211, v193, 0x41300000, v199
    v_cos_f32 v212, v208
    v_mfma_f32_32x32x16_bf16 v[64:79], a[80:83], a[212:215], v[64:79]
    ds_read_b64_tr_b16 a[88:89], v8 offset:14336
    ds_read_b64_tr_b16 a[90:91], v8 offset:15360
    buffer_load_dwordx4 a[244:247], v16, s[28:31], s57 offen offset:2048 sc1
    v_cos_f32 v213, v209
    v_mfma_f32_32x32x16_bf16 v[96:111], a[80:83], a[216:219], v[96:111]
    s_waitcnt lgkmcnt(2)
    ds_read_b64_tr_b16 a[92:93], v9 offset:14336
    ds_read_b64_tr_b16 a[94:95], v9 offset:15360
    buffer_load_dwordx4 a[248:251], v17, s[28:31], s57 offen offset:2048 sc1
    v_mfma_f32_32x32x16_bf16 v[80:95], a[84:87], a[212:215], v[80:95]
    buffer_load_dwordx4 a[252:255], v16, s[28:31], s57 offen offset:3072 sc1
    v_cos_f32_e64 v214, v210
    v_cos_f32 v215, v211
    v_mfma_f32_32x32x16_bf16 v[112:127], a[84:87], a[216:219], v[112:127]
    s_waitcnt lgkmcnt(2)
    buffer_load_dwordx4 a[176:179], v17, s[28:31], s57 offen offset:3072 sc1
    v_sin_f32_e64 v208, -v208
    v_mfma_f32_32x32x16_bf16 v[64:79], a[88:91], a[220:223], v[64:79]
    s_lshl_b32 s57, s88, 12
    s_add_u32 s57, s57, s91
    ds_read_b64_tr_b16 a[64:65], v8 offset:28672
    ds_read_b64_tr_b16 a[66:67], v8 offset:29696
    buffer_load_dwordx4 a[180:183], v16, s[28:31], s57 offen sc1
    v_mfma_f32_32x32x16_bf16 v[96:111], a[88:91], a[224:227], v[96:111]
    s_waitcnt lgkmcnt(2)
    ds_read_b64_tr_b16 a[68:69], v9 offset:28672
    ds_read_b64_tr_b16 a[70:71], v9 offset:29696
    buffer_load_dwordx4 a[184:187], v17, s[28:31], s57 offen sc1
    v_sin_f32_e64 v209, -v209
    v_mfma_f32_32x32x16_bf16 v[80:95], a[92:95], a[220:223], v[80:95]
    buffer_load_dwordx4 a[188:191], v16, s[28:31], s57 offen offset:1024 sc1
    v_sin_f32_e64 v210, -v210
    v_sin_f32_e64 v211, -v211
    v_mfma_f32_32x32x16_bf16 v[112:127], a[92:95], a[224:227], v[112:127]
    s_waitcnt vmcnt(9) lgkmcnt(2)
    buffer_load_dwordx4 a[192:195], v17, s[28:31], s57 offen offset:1024 sc1
    v_cvt_pk_bf16_f32 v172, v212, v213
    v_cvt_pk_bf16_f32 v173, v214, v215
    v_cvt_pk_bf16_f32 v174, v208, v209
    v_cvt_pk_bf16_f32 v175, v210, v211
    v_mfma_f32_32x32x16_bf16 v[64:79], a[64:67], a[228:231], v[64:79]
    ds_read_b64_tr_b16 a[72:73], v8 offset:30720
    ds_read_b64_tr_b16 a[74:75], v8 offset:31744
    s_add_u32 s26, s80, 3
    s_and_b32 s26, s26, 3
    s_cselect_b64 s[24:25], 0, -1
    s_lshl_b32 s26, s26, 4
    v_mfma_f32_32x32x16_bf16 v[96:111], a[64:67], a[232:235], v[96:111]
    s_waitcnt lgkmcnt(2)
    ds_read_b64_tr_b16 a[76:77], v9 offset:30720
    ds_read_b64_tr_b16 a[78:79], v9 offset:31744
    buffer_load_dwordx4 a[96:99], v16, s[28:31], s57 offen offset:2048 sc1
    v_mfma_f32_32x32x16_bf16 v[80:95], a[68:71], a[228:231], v[80:95]
    buffer_load_dwordx4 a[100:103], v17, s[28:31], s57 offen offset:2048 sc1
    v_cvt_f32_u32_e64 v199, s26
    v_fma_f32 v198, v199, v192, v194
    v_fma_f32 v199, v199, v193, v195
    v_mfma_f32_32x32x16_bf16 v[112:127], a[68:71], a[232:235], v[112:127]
    s_waitcnt vmcnt(10) lgkmcnt(2)
    buffer_load_dwordx4 a[104:107], v16, s[28:31], s57 offen offset:3072 sc1
    v_cndmask_b32 v200, v198, v196, s[24:25]
    v_fmamk_f32 v201, v192, 0x3f800000, v198
    v_mfma_f32_32x32x16_bf16 v[64:79], a[72:75], a[236:239], v[64:79]
    ds_read_b64_tr_b16 a[80:81], v8
    ds_read_b64_tr_b16 a[82:83], v8 offset:1024
    v_fmamk_f32 v202, v192, 0x40000000, v198
    v_fmamk_f32 v203, v192, 0x40400000, v198
    v_cos_f32 v204, v200
    v_mfma_f32_32x32x16_bf16 v[96:111], a[72:75], a[240:243], v[96:111]
    s_waitcnt lgkmcnt(2)
    ds_read_b64_tr_b16 a[84:85], v9
    ds_read_b64_tr_b16 a[86:87], v9 offset:1024
    buffer_load_dwordx4 a[108:111], v17, s[28:31], s57 offen offset:3072 sc1
    v_cos_f32_e64 v205, v201
    v_mfma_f32_32x32x16_bf16 v[80:95], a[76:79], a[236:239], v[80:95]
    s_lshl_b32 s57, s89, 12
    s_add_u32 s57, s57, s91
    buffer_load_dwordx4 a[112:115], v16, s[28:31], s57 offen sc1
    v_mfma_f32_32x32x16_bf16 v[112:127], a[76:79], a[240:243], v[112:127]
    s_waitcnt vmcnt(11) lgkmcnt(2)
    buffer_load_dwordx4 a[116:119], v17, s[28:31], s57 offen sc1
    v_cos_f32 v206, v202
    v_cos_f32_e64 v207, v203
    v_mfma_f32_32x32x16_bf16 v[64:79], a[80:83], a[244:247], v[64:79]
    ds_read_b64_tr_b16 a[88:89], v8 offset:2048
    ds_read_b64_tr_b16 a[90:91], v8 offset:3072
    v_sin_f32_e64 v200, -v200
    v_sin_f32_e64 v201, -v201
    v_mfma_f32_32x32x16_bf16 v[96:111], a[80:83], a[248:251], v[96:111]
    s_waitcnt lgkmcnt(2)
    ds_read_b64_tr_b16 a[92:93], v9 offset:2048
    ds_read_b64_tr_b16 a[94:95], v9 offset:3072
    buffer_load_dwordx4 a[120:123], v16, s[28:31], s57 offen offset:1024 sc1
    v_mfma_f32_32x32x16_bf16 v[80:95], a[84:87], a[244:247], v[80:95]
    buffer_load_dwordx4 a[124:127], v17, s[28:31], s57 offen offset:1024 sc1
    v_sin_f32_e64 v202, -v202
    v_mfma_f32_32x32x16_bf16 v[112:127], a[84:87], a[248:251], v[112:127]
    s_waitcnt vmcnt(12) lgkmcnt(2)
    buffer_load_dwordx4 a[128:131], v16, s[28:31], s57 offen offset:2048 sc1
    v_sin_f32_e64 v203, -v203
    v_cvt_pk_bf16_f32 v176, v204, v205
    v_mfma_f32_32x32x16_bf16 v[64:79], a[88:91], a[252:255], v[64:79]
    ds_read_b64_tr_b16 a[64:65], v8 offset:32768
    ds_read_b64_tr_b16 a[66:67], v8 offset:33792
    v_cvt_pk_bf16_f32 v177, v206, v207
    v_cvt_pk_bf16_f32 v178, v200, v201
    v_cvt_pk_bf16_f32 v179, v202, v203
    v_mfma_f32_32x32x16_bf16 v[96:111], a[88:91], a[176:179], v[96:111]
    s_waitcnt lgkmcnt(2)
    ds_read_b64_tr_b16 a[68:69], v9 offset:32768
    ds_read_b64_tr_b16 a[70:71], v9 offset:33792
    buffer_load_dword v25, v24, s[28:31], s27 offen sc1
    v_cndmask_b32 v208, v199, v197, s[24:25]
    v_mfma_f32_32x32x16_bf16 v[80:95], a[92:95], a[252:255], v[80:95]
    buffer_load_dwordx4 a[132:135], v17, s[28:31], s57 offen offset:2048 sc1
    v_fmamk_f32 v209, v193, 0x3f800000, v199
    v_fmamk_f32 v210, v193, 0x40000000, v199
    v_fmamk_f32 v211, v193, 0x40400000, v199
    v_mfma_f32_32x32x16_bf16 v[112:127], a[92:95], a[176:179], v[112:127]
    s_waitcnt vmcnt(13) lgkmcnt(2)
    buffer_load_dwordx4 a[136:139], v16, s[28:31], s57 offen offset:3072 sc1
    v_cos_f32_e64 v212, v208
    v_mfma_f32_32x32x16_bf16 v[64:79], a[64:67], a[180:183], v[64:79]
    ds_read_b64_tr_b16 a[72:73], v8 offset:34816
    ds_read_b64_tr_b16 a[74:75], v8 offset:35840
    buffer_load_dwordx4 a[140:143], v17, s[28:31], s57 offen offset:3072 sc1
    v_cos_f32 v213, v209
    v_mfma_f32_32x32x16_bf16 v[96:111], a[64:67], a[184:187], v[96:111]
    s_waitcnt lgkmcnt(2)
    s_lshl_b32 s57, s90, 12
    s_add_u32 s57, s57, s91
    ds_read_b64_tr_b16 a[76:77], v9 offset:34816
    ds_read_b64_tr_b16 a[78:79], v9 offset:35840
    buffer_load_dwordx4 a[144:147], v16, s[28:31], s57 offen sc1
    v_mfma_f32_32x32x16_bf16 v[80:95], a[68:71], a[180:183], v[80:95]
    buffer_load_dwordx4 a[148:151], v17, s[28:31], s57 offen sc1
    v_cos_f32_e64 v214, v210
    v_cos_f32 v215, v211
    v_mfma_f32_32x32x16_bf16 v[112:127], a[68:71], a[184:187], v[112:127]
    s_waitcnt vmcnt(15) lgkmcnt(2)
    buffer_load_dwordx4 a[152:155], v16, s[28:31], s57 offen offset:1024 sc1
    v_sin_f32_e64 v208, -v208
    v_sin_f32_e64 v209, -v209
    v_mfma_f32_32x32x16_bf16 v[64:79], a[72:75], a[188:191], v[64:79]
    ds_read_b64_tr_b16 a[80:81], v8 offset:16384
    ds_read_b64_tr_b16 a[82:83], v8 offset:17408
    v_sin_f32_e64 v210, -v210
    v_sin_f32_e64 v211, -v211
    v_mfma_f32_32x32x16_bf16 v[96:111], a[72:75], a[192:195], v[96:111]
    s_waitcnt lgkmcnt(2)
    ds_read_b64_tr_b16 a[84:85], v9 offset:16384
    ds_read_b64_tr_b16 a[86:87], v9 offset:17408
    buffer_load_dwordx4 a[156:159], v17, s[28:31], s57 offen offset:1024 sc1
    v_mfma_f32_32x32x16_bf16 v[80:95], a[76:79], a[188:191], v[80:95]
    buffer_load_dwordx4 a[160:163], v16, s[28:31], s57 offen offset:2048 sc1
    v_cvt_pk_bf16_f32 v180, v212, v213
    v_cvt_pk_bf16_f32 v181, v214, v215
    v_cvt_pk_bf16_f32 v182, v208, v209
    v_mfma_f32_32x32x16_bf16 v[112:127], a[76:79], a[192:195], v[112:127]
    s_waitcnt vmcnt(16) lgkmcnt(2)
    buffer_load_dwordx4 a[164:167], v17, s[28:31], s57 offen offset:2048 sc1
    v_cvt_pk_bf16_f32 v183, v210, v211
    v_fmamk_f32 v200, v192, 0x41000000, v198
    v_mfma_f32_32x32x16_bf16 v[64:79], a[80:83], a[96:99], v[64:79]
    ds_read_b64_tr_b16 a[88:89], v8 offset:18432
    ds_read_b64_tr_b16 a[90:91], v8 offset:19456
    s_waitcnt vmcnt(9)
    v_cmp_gt_u32 vcc, s23, v25
    v_mfma_f32_32x32x16_bf16 v[96:111], a[80:83], a[100:103], v[96:111]
    s_waitcnt lgkmcnt(2)
    ds_read_b64_tr_b16 a[92:93], v9 offset:18432
    ds_read_b64_tr_b16 a[94:95], v9 offset:19456
    buffer_load_dwordx4 a[168:171], v16, s[28:31], s57 offen offset:3072 sc1
    s_cbranch_vccnz L_slow_zd_10
L_ret_zd_10:
    v_fmamk_f32 v201, v192, 0x41100000, v198
    v_fmamk_f32 v202, v192, 0x41200000, v198
    v_fmamk_f32 v203, v192, 0x41300000, v198
    v_cos_f32_e64 v204, v200
    v_mfma_f32_32x32x16_bf16 v[80:95], a[84:87], a[96:99], v[80:95]
    buffer_load_dwordx4 a[172:175], v17, s[28:31], s57 offen offset:3072 sc1
    v_cos_f32_e64 v205, v201
    v_cos_f32 v206, v202
    v_mfma_f32_32x32x16_bf16 v[112:127], a[84:87], a[100:103], v[112:127]
    s_waitcnt lgkmcnt(2)
    s_add_u32 m0, s53, 8192
    s_lshl_b32 s55, s90, 16
    s_add_u32 s55, s55, 32768
    buffer_load_dwordx4 v20, s[16:19], s55 offen lds
    v_mfma_f32_32x32x16_bf16 v[64:79], a[88:91], a[104:107], v[64:79]
    s_barrier
    ds_read_b64_tr_b16 a[64:65], v8 offset:20480
    ds_read_b64_tr_b16 a[66:67], v8 offset:21504
    v_cos_f32_e64 v207, v203
    v_mfma_f32_32x32x16_bf16 v[96:111], a[88:91], a[108:111], v[96:111]
    s_waitcnt lgkmcnt(2)
    ds_read_b64_tr_b16 a[68:69], v9 offset:20480
    ds_read_b64_tr_b16 a[70:71], v9 offset:21504
    buffer_load_dwordx4 v21, s[16:19], s55 offen offset:1024 lds
    v_sin_f32_e64 v200, -v200
    v_mfma_f32_32x32x16_bf16 v[80:95], a[92:95], a[104:107], v[80:95]
    buffer_load_dwordx4 v22, s[16:19], s55 offen offset:2048 lds
    v_sin_f32_e64 v201, -v201
    v_sin_f32_e64 v202, -v202
    v_mfma_f32_32x32x16_bf16 v[112:127], a[92:95], a[108:111], v[112:127]
    s_waitcnt lgkmcnt(2)
    buffer_load_dwordx4 v23, s[16:19], s55 offen offset:3072 lds
    v_sin_f32_e64 v203, -v203
    v_mfma_f32_32x32x16_bf16 v[64:79], a[64:67], a[112:115], v[64:79]
    ds_read_b64_tr_b16 a[72:73], v8 offset:22528
    ds_read_b64_tr_b16 a[74:75], v8 offset:23552
    v_cvt_pk_bf16_f32 v184, v204, v205
    v_cvt_pk_bf16_f32 v185, v206, v207
    v_cvt_pk_bf16_f32 v186, v200, v201
    v_mfma_f32_32x32x16_bf16 v[96:111], a[64:67], a[116:119], v[96:111]
    s_waitcnt lgkmcnt(2)
    s_add_u32 m0, s53, 12288
    s_add_u32 s55, s80, 0
    s_and_b32 s55, s55, 3
    s_mul_i32 s55, s55, 135168
    s_add_u32 s55, s55, s93
    ds_read_b64_tr_b16 a[76:77], v9 offset:22528
    ds_read_b64_tr_b16 a[78:79], v9 offset:23552
    buffer_load_dwordx4 v12, s[28:31], s55 offen sc1 lds
    v_mfma_f32_32x32x16_bf16 v[80:95], a[68:71], a[112:115], v[80:95]
    v_cvt_pk_bf16_f32 v187, v202, v203
    v_fmamk_f32 v208, v193, 0x41000000, v199
    v_fmamk_f32 v209, v193, 0x41100000, v199
    v_fmamk_f32 v210, v193, 0x41200000, v199
    v_fmamk_f32 v211, v193, 0x41300000, v199
    v_mfma_f32_32x32x16_bf16 v[112:127], a[68:71], a[116:119], v[112:127]
    s_waitcnt lgkmcnt(2)
    buffer_load_dwordx4 v13, s[28:31], s55 offen offset:1024 sc1 lds
    v_cos_f32 v212, v208
    v_mfma_f32_32x32x16_bf16 v[64:79], a[72:75], a[120:123], v[64:79]
    ds_read_b64_tr_b16 a[80:81], v8 offset:24576
    ds_read_b64_tr_b16 a[82:83], v8 offset:25600
    v_cos_f32 v213, v209
    v_mfma_f32_32x32x16_bf16 v[96:111], a[72:75], a[124:127], v[96:111]
    s_waitcnt lgkmcnt(2)
    ds_read_b64_tr_b16 a[84:85], v9 offset:24576
    ds_read_b64_tr_b16 a[86:87], v9 offset:25600
    buffer_load_dwordx4 v14, s[28:31], s55 offen offset:2048 sc1 lds
    v_mfma_f32_32x32x16_bf16 v[80:95], a[76:79], a[120:123], v[80:95]
    v_cos_f32_e64 v214, v210
    v_cos_f32 v215, v211
    v_mfma_f32_32x32x16_bf16 v[112:127], a[76:79], a[124:127], v[112:127]
    s_waitcnt vmcnt(17) lgkmcnt(2)
    buffer_load_dwordx4 v15, s[28:31], s55 offen offset:3072 sc1 lds
    v_sin_f32_e64 v208, -v208
    v_mfma_f32_32x32x16_bf16 v[64:79], a[80:83], a[128:131], v[64:79]
    ds_read_b64_tr_b16 a[88:89], v8 offset:26624
    ds_read_b64_tr_b16 a[90:91], v8 offset:27648
    v_sin_f32_e64 v209, -v209
    v_sin_f32_e64 v210, -v210
    v_sin_f32_e64 v211, -v211
    v_cvt_pk_bf16_f32 v188, v212, v213
    v_mfma_f32_32x32x16_bf16 v[96:111], a[80:83], a[132:135], v[96:111]
    s_waitcnt lgkmcnt(2)
    s_add_u32 m0, s53, 28672
    s_add_u32 s55, s80, 1
    s_and_b32 s55, s55, 3
    s_mul_i32 s55, s55, 135168
    s_add_u32 s55, s55, s93
    ds_read_b64_tr_b16 a[92:93], v9 offset:26624
    ds_read_b64_tr_b16 a[94:95], v9 offset:27648
    buffer_load_dwordx4 v12, s[28:31], s55 offen sc1 lds
    v_mfma_f32_32x32x16_bf16 v[80:95], a[84:87], a[128:131], v[80:95]
    ds_read_b64_tr_b16 a[68:69], v9 offset:4096
    ds_read_b64_tr_b16 a[70:71], v9 offset:5120
    v_cvt_pk_bf16_f32 v189, v214, v215
    v_cvt_pk_bf16_f32 v190, v208, v209
    v_cvt_pk_bf16_f32 v191, v210, v211
    v_add_u32_e64 v33, s53, v2
    v_mfma_f32_32x32x16_bf16 v[112:127], a[84:87], a[132:135], v[112:127]
    s_waitcnt vmcnt(17) lgkmcnt(4)
    buffer_load_dwordx4 v13, s[28:31], s55 offen offset:1024 sc1 lds
    s_xor_b32 s56, s52, 1
    s_mul_i32 s56, s56, 40960
    v_add_u32_e64 v60, s56, v2
    v_mfma_f32_32x32x16_bf16 v[64:79], a[88:91], a[136:139], v[64:79]
    ds_read_b64_tr_b16 a[76:77], v9 offset:6144
    ds_read_b64_tr_b16 a[78:79], v9 offset:7168
    s_xor_b32 s56, s52, 2
    s_mul_i32 s56, s56, 40960
    v_add_u32 v61, s56, v2
    s_xor_b32 s56, s52, 3
    s_mul_i32 s56, s56, 40960
    v_add_u32 v62, s56, v2
    v_mfma_f32_32x32x16_bf16 v[96:111], a[88:91], a[140:143], v[96:111]
    s_waitcnt lgkmcnt(4)
    buffer_load_dwordx4 v14, s[28:31], s55 offen offset:2048 sc1 lds
    v_mfma_f32_32x32x16_bf16 v[80:95], a[92:95], a[136:139], v[80:95]
    s_waitcnt vmcnt(7)
    ds_read_b64_tr_b16 a[84:85], v9 offset:8192
    ds_read_b64_tr_b16 a[86:87], v9 offset:9216
    v_mfma_f32_32x32x16_bf16 v[112:127], a[92:95], a[140:143], v[112:127]
    s_waitcnt lgkmcnt(4)
    buffer_load_dwordx4 v15, s[28:31], s55 offen offset:3072 sc1 lds
    v_mfma_f32_32x32x16_bf16 v[80:95], a[68:71], a[144:147], v[80:95]
    s_waitcnt lgkmcnt(2)
    s_add_u32 m0, s53, 0
    s_add_u32 s55, s80, 2
    s_and_b32 s55, s55, 3
    s_mul_i32 s55, s55, 135168
    s_add_u32 s55, s55, s93
    ds_read_b64_tr_b16 a[92:93], v9 offset:10240
    ds_read_b64_tr_b16 a[94:95], v9 offset:11264
    buffer_load_dwordx4 v12, s[28:31], s55 offen sc1 lds
    v_mfma_f32_32x32x16_bf16 v[80:95], a[76:79], a[152:155], v[80:95]
    s_waitcnt lgkmcnt(2)
    ds_read_b64_tr_b16 a[64:65], v8 offset:4096
    ds_read_b64_tr_b16 a[66:67], v8 offset:5120
    v_mfma_f32_32x32x16_bf16 v[80:95], a[84:87], a[160:163], v[80:95]
    s_waitcnt lgkmcnt(2)
    ds_read_b64_tr_b16 a[72:73], v8 offset:6144
    ds_read_b64_tr_b16 a[74:75], v8 offset:7168
    buffer_load_dwordx4 v13, s[28:31], s55 offen offset:1024 sc1 lds
    v_mfma_f32_32x32x16_bf16 v[80:95], a[92:95], a[168:171], v[80:95]
    ds_read_b64_tr_b16 a[80:81], v8 offset:8192
    ds_read_b64_tr_b16 a[82:83], v8 offset:9216
    v_mfma_f32_32x32x16_bf16 v[112:127], a[68:71], a[148:151], v[112:127]
    ds_read_b64_tr_b16 a[88:89], v8 offset:10240
    ds_read_b64_tr_b16 a[90:91], v8 offset:11264
    buffer_load_dwordx4 v14, s[28:31], s55 offen offset:2048 sc1 lds
    v_mfma_f32_32x32x16_bf16 v[112:127], a[76:79], a[156:159], v[112:127]
    v_mfma_f32_32x32x16_bf16 v[112:127], a[84:87], a[164:167], v[112:127]
    s_nop 3
    ds_write_b128 v33, v[80:83] offset:16384
    buffer_load_dwordx4 v15, s[28:31], s55 offen offset:3072 sc1 lds
    v_mfma_f32_32x32x16_bf16 v[112:127], a[92:95], a[172:175], v[112:127]
    s_waitcnt lgkmcnt(7)
    ds_write_b128 v33, v[84:87] offset:17408
    v_mfma_f32_32x32x16_bf16 v[96:111], a[64:67], a[148:151], v[96:111]
    s_waitcnt lgkmcnt(6)
    s_add_u32 m0, s53, 32768
    s_add_u32 s55, s80, 3
    s_and_b32 s55, s55, 3
    s_mul_i32 s55, s55, 135168
    s_add_u32 s55, s55, s93
    ds_write_b128 v33, v[88:91] offset:18432
    buffer_load_dwordx4 v12, s[28:31], s55 offen sc1 lds
    v_mfma_f32_32x32x16_bf16 v[96:111], a[72:75], a[156:159], v[96:111]
    s_waitcnt lgkmcnt(5)
    ds_write_b128 v33, v[92:95] offset:19456
    v_mfma_f32_32x32x16_bf16 v[96:111], a[80:83], a[164:167], v[96:111]
    s_waitcnt lgkmcnt(4)
    ds_write_b128 v33, v[112:115] offset:24576
    buffer_load_dwordx4 v13, s[28:31], s55 offen offset:1024 sc1 lds
    v_mfma_f32_32x32x16_bf16 v[96:111], a[88:91], a[172:175], v[96:111]
    ds_write_b128 v33, v[116:119] offset:25600
    s_waitcnt vmcnt(10)
    ds_read_b64_tr_b16 a[0:1], v10 offset:12288
    ds_read_b64_tr_b16 a[2:3], v10 offset:12296
    v_mfma_f32_32x32x16_bf16 v[64:79], a[64:67], a[144:147], v[64:79]
    ds_write_b128 v33, v[120:123] offset:26624
    ds_read_b64_tr_b16 a[4:5], v11 offset:12288
    ds_read_b64_tr_b16 a[6:7], v11 offset:12296
    buffer_load_dwordx4 v14, s[28:31], s55 offen offset:2048 sc1 lds
    v_mfma_f32_32x32x16_bf16 v[64:79], a[72:75], a[152:155], v[64:79]
    ds_write_b128 v33, v[124:127] offset:27648
    v_mfma_f32_32x32x16_bf16 v[64:79], a[80:83], a[160:163], v[64:79]
    s_nop 0
    ds_write_b128 v33, v[96:99] offset:20480
    buffer_load_dwordx4 v15, s[28:31], s55 offen offset:3072 sc1 lds
    v_mfma_f32_32x32x16_bf16 v[64:79], a[88:91], a[168:171], v[64:79]
    s_waitcnt lgkmcnt(5)
    ds_write_b128 v33, v[100:103] offset:21504
    v_mfma_f32_32x32x16_bf16 v[192:207], v[128:131], a[0:3], 0
    ds_read_b64_tr_b16 a[8:9], v10 offset:14336
    ds_read_b64_tr_b16 a[10:11], v10 offset:14344
    ds_write_b128 v33, v[104:107] offset:22528
    v_mfma_f32_32x32x16_bf16 v[208:223], v[132:135], a[0:3], 0
    s_waitcnt lgkmcnt(6)
    ds_read_b64_tr_b16 a[12:13], v11 offset:14336
    ds_read_b64_tr_b16 a[14:15], v11 offset:14344
    ds_write_b128 v33, v[108:111] offset:23552
    v_mfma_f32_32x32x16_bf16 v[224:239], v[128:131], a[4:7], 0
    v_mfma_f32_32x32x16_bf16 v[240:255], v[132:135], a[4:7], 0
    s_waitcnt lgkmcnt(4)
    s_waitcnt lgkmcnt(0)
    s_barrier
    ds_read_b128 v[80:83], v60 offset:16384
    ds_read_b128 v[84:87], v60 offset:17408
    v_mfma_f32_32x32x16_bf16 v[192:207], v[136:139], a[8:11], v[192:207]
    s_waitcnt vmcnt(8)
    ds_read_b64_tr_b16 a[16:17], v10 offset:28672
    ds_read_b64_tr_b16 a[18:19], v10 offset:28680
    ds_read_b128 v[88:91], v60 offset:18432
    ds_read_b128 v[92:95], v60 offset:19456
    v_mfma_f32_32x32x16_bf16 v[208:223], v[140:143], a[8:11], v[208:223]
    ds_read_b64_tr_b16 a[20:21], v11 offset:28672
    ds_read_b64_tr_b16 a[22:23], v11 offset:28680
    ds_read_b128 v[96:99], v61 offset:20480
    ds_read_b128 v[100:103], v61 offset:21504
    v_mfma_f32_32x32x16_bf16 v[224:239], v[136:139], a[12:15], v[224:239]
    ds_read_b128 v[104:107], v61 offset:22528
    ds_read_b128 v[108:111], v61 offset:23552
    ds_read_b128 v[112:115], v62 offset:24576
    v_mfma_f32_32x32x16_bf16 v[240:255], v[140:143], a[12:15], v[240:255]
    s_waitcnt lgkmcnt(9)
    ds_read_b128 v[116:119], v62 offset:25600
    ds_read_b128 v[120:123], v62 offset:26624
    ds_read_b128 v[124:127], v62 offset:27648
    v_mfma_f32_32x32x16_bf16 v[192:207], v[144:147], a[16:19], v[192:207]
    ds_read_b64_tr_b16 a[24:25], v10 offset:30720
    ds_read_b64_tr_b16 a[26:27], v10 offset:30728
    s_waitcnt lgkmcnt(12)
    v_add_f32 v64, v64, v80
    v_add_f32 v65, v65, v81
    v_add_f32_e64 v66, v66, v82
    v_add_f32 v67, v67, v83
    v_mfma_f32_32x32x16_bf16 v[208:223], v[148:151], a[16:19], v[208:223]
    s_waitcnt lgkmcnt(10)
    ds_read_b64_tr_b16 a[28:29], v11 offset:30720
    ds_read_b64_tr_b16 a[30:31], v11 offset:30728
    ds_read_b128 v[36:39], v28
    ds_read_b128 v[40:43], v29
    v_add_f32 v68, v68, v84
    v_add_f32 v69, v69, v85
    v_add_f32 v70, v70, v86
    v_mfma_f32_32x32x16_bf16 v[224:239], v[144:147], a[20:23], v[224:239]
    s_waitcnt vmcnt(4)
    ds_read_b64_tr_b16 a[4:5], v11
    ds_read_b64_tr_b16 a[6:7], v11 offset:8
    v_add_f32 v71, v71, v87
    v_add_f32 v72, v72, v88
    v_add_f32 v73, v73, v89
    v_add_f32 v74, v74, v90
    v_mfma_f32_32x32x16_bf16 v[240:255], v[148:151], a[20:23], v[240:255]
    s_waitcnt lgkmcnt(6)
    v_add_f32 v75, v75, v91
    v_add_f32 v76, v76, v92
    v_add_f32 v77, v77, v93
    v_add_f32 v78, v78, v94
    v_add_f32 v79, v79, v95
    v_mfma_f32_32x32x16_bf16 v[192:207], v[152:155], a[24:27], v[192:207]
    ds_read_b64_tr_b16 a[12:13], v11 offset:2048
    ds_read_b64_tr_b16 a[14:15], v11 offset:2056
    v_add_f32 v64, v64, v96
    v_add_f32 v65, v65, v97
    v_add_f32 v66, v66, v98
    v_add_f32 v67, v67, v99
    v_mfma_f32_32x32x16_bf16 v[208:223], v[156:159], a[24:27], v[208:223]
    s_waitcnt lgkmcnt(6)
    v_add_f32 v68, v68, v100
    v_add_f32 v69, v69, v101
    v_add_f32 v70, v70, v102
    v_add_f32_e64 v71, v71, v103
    v_add_f32 v72, v72, v104
    v_mfma_f32_32x32x16_bf16 v[224:239], v[152:155], a[28:31], v[224:239]
    s_waitcnt vmcnt(0)
    ds_read_b64_tr_b16 a[20:21], v11 offset:32768
    ds_read_b64_tr_b16 a[22:23], v11 offset:32776
    v_add_f32 v73, v73, v105
    v_add_f32 v74, v74, v106
    v_add_f32 v75, v75, v107
    v_add_f32 v76, v76, v108
    v_mfma_f32_32x32x16_bf16 v[240:255], v[156:159], a[28:31], v[240:255]
    s_waitcnt lgkmcnt(4)
    v_add_f32 v77, v77, v109
    v_add_f32_e64 v78, v78, v110
    v_add_f32 v79, v79, v111
    v_mfma_f32_32x32x16_bf16 v[224:239], v[160:163], a[4:7], v[224:239]
    s_waitcnt lgkmcnt(2)
    ds_read_b64_tr_b16 a[28:29], v11 offset:34816
    ds_read_b64_tr_b16 a[30:31], v11 offset:34824
    v_add_f32 v64, v64, v112
    v_add_f32 v65, v65, v113
    v_add_f32_e64 v66, v66, v114
    v_add_f32 v67, v67, v115
    v_mfma_f32_32x32x16_bf16 v[224:239], v[168:171], a[12:15], v[224:239]
    s_waitcnt lgkmcnt(2)
    ds_read_b64_tr_b16 a[0:1], v10
    ds_read_b64_tr_b16 a[2:3], v10 offset:8
    v_add_f32 v68, v68, v116
    v_add_f32 v69, v69, v117
    v_add_f32_e64 v70, v70, v118
    v_add_f32 v71, v71, v119
    v_mfma_f32_32x32x16_bf16 v[224:239], v[176:179], a[20:23], v[224:239]
    s_waitcnt lgkmcnt(2)
    ds_read_b64_tr_b16 a[8:9], v10 offset:2048
    ds_read_b64_tr_b16 a[10:11], v10 offset:2056
    v_add_f32 v72, v72, v120
    v_add_f32 v73, v73, v121
    v_add_f32_e64 v74, v74, v122
    v_mfma_f32_32x32x16_bf16 v[224:239], v[184:187], a[28:31], v[224:239]
    ds_read_b64_tr_b16 a[16:17], v10 offset:32768
    ds_read_b64_tr_b16 a[18:19], v10 offset:32776
    v_add_f32 v75, v75, v123
    v_add_f32 v76, v76, v124
    v_add_f32 v77, v77, v125
    v_add_f32 v78, v78, v126
    v_mfma_f32_32x32x16_bf16 v[240:255], v[164:167], a[4:7], v[240:255]
    ds_read_b64_tr_b16 a[24:25], v10 offset:34816
    ds_read_b64_tr_b16 a[26:27], v10 offset:34824
    v_add_f32_e64 v79, v79, v127
    v_mul_f32 v44, 0xbfb8aa3b, v64
    v_mul_f32 v45, 0xbfb8aa3b, v65
    v_mul_f32 v46, 0xbfb8aa3b, v66
    v_mfma_f32_32x32x16_bf16 v[240:255], v[172:175], a[12:15], v[240:255]
    v_mul_f32 v47, 0xbfb8aa3b, v67
    v_mul_f32 v48, 0xbfb8aa3b, v68
    v_mul_f32 v49, 0xbfb8aa3b, v69
    v_mul_f32 v50, 0xbfb8aa3b, v70
    v_mul_f32 v51, 0xbfb8aa3b, v71
    v_mfma_f32_32x32x16_bf16 v[240:255], v[180:183], a[20:23], v[240:255]
    ds_write_b128 v33, v[224:227] offset:8192
    v_exp_f32 v44, v44
    v_exp_f32 v45, v45
    v_exp_f32 v46, v46
    v_mfma_f32_32x32x16_bf16 v[240:255], v[188:191], a[28:31], v[240:255]
    s_waitcnt lgkmcnt(7)
    ds_write_b128 v33, v[228:231] offset:9216
    v_exp_f32_e64 v47, v47
    v_exp_f32 v48, v48
    v_mfma_f32_32x32x16_bf16 v[208:223], v[164:167], a[0:3], v[208:223]
    s_waitcnt lgkmcnt(6)
    ds_write_b128 v33, v[232:235] offset:10240
    v_exp_f32_e64 v49, v49
    v_exp_f32 v50, v50
    v_mfma_f32_32x32x16_bf16 v[208:223], v[172:175], a[8:11], v[208:223]
    s_waitcnt lgkmcnt(5)
    ds_write_b128 v33, v[236:239] offset:11264
    v_exp_f32 v51, v51
    v_add_f32 v44, 1.0, v44
    v_add_f32 v45, 1.0, v45
    v_add_f32 v46, 1.0, v46
    v_add_f32 v47, 1.0, v47
    v_mfma_f32_32x32x16_bf16 v[208:223], v[180:183], a[16:19], v[208:223]
    s_waitcnt lgkmcnt(4)
    ds_write_b128 v33, v[240:243] offset:12288
    v_add_f32 v48, 1.0, v48
    v_add_f32 v49, 1.0, v49
    v_add_f32 v50, 1.0, v50
    v_add_f32 v51, 1.0, v51
    v_mfma_f32_32x32x16_bf16 v[208:223], v[188:191], a[24:27], v[208:223]
    ds_write_b128 v33, v[244:247] offset:13312
    v_rcp_f32 v44, v44
    v_rcp_f32 v45, v45
    v_rcp_f32_e64 v46, v46
    v_mfma_f32_32x32x16_bf16 v[192:207], v[160:163], a[0:3], v[192:207]
    ds_write_b128 v33, v[248:251] offset:14336
    v_rcp_f32 v47, v47
    v_rcp_f32 v48, v48
    v_mfma_f32_32x32x16_bf16 v[192:207], v[168:171], a[8:11], v[192:207]
    ds_write_b128 v33, v[252:255] offset:15360
    v_rcp_f32 v49, v49
    v_rcp_f32 v50, v50
    v_mfma_f32_32x32x16_bf16 v[192:207], v[176:179], a[16:19], v[192:207]
    ds_write_b128 v33, v[208:211] offset:4096
    v_rcp_f32 v51, v51
    v_mul_f32 v64, v64, v44
    v_mul_f32 v65, v65, v45
    v_mul_f32 v66, v66, v46
    v_mfma_f32_32x32x16_bf16 v[192:207], v[184:187], a[24:27], v[192:207]
    ds_write_b128 v33, v[212:215] offset:5120
    v_mul_f32 v67, v67, v47
    v_mul_f32 v68, v68, v48
    v_mul_f32 v69, v69, v49
    v_mul_f32 v70, v70, v50
    v_mul_f32_e64 v71, v71, v51
    v_mul_f32 v52, 0xbfb8aa3b, v72
    v_mul_f32 v53, 0xbfb8aa3b, v73
    v_mul_f32 v54, 0xbfb8aa3b, v74
    v_mul_f32 v55, 0xbfb8aa3b, v75
    v_mul_f32 v56, 0xbfb8aa3b, v76
    v_mul_f32 v57, 0xbfb8aa3b, v77
    v_mul_f32 v58, 0xbfb8aa3b, v78
    v_mul_f32 v59, 0xbfb8aa3b, v79
    v_exp_f32 v52, v52
    v_exp_f32 v53, v53
    v_exp_f32 v54, v54
    v_exp_f32 v55, v55
    v_exp_f32 v56, v56
    v_exp_f32 v57, v57
    v_exp_f32 v58, v58
    v_exp_f32 v59, v59
    v_add_f32 v52, 1.0, v52
    v_add_f32 v53, 1.0, v53
    v_add_f32 v54, 1.0, v54
    v_add_f32 v55, 1.0, v55
    v_add_f32 v56, 1.0, v56
    v_add_f32 v57, 1.0, v57
    v_add_f32 v58, 1.0, v58
    v_add_f32 v59, 1.0, v59
    v_rcp_f32 v52, v52
    v_rcp_f32 v53, v53
    ds_write_b128 v33, v[216:219] offset:6144
    ds_write_b128 v33, v[220:223] offset:7168
    v_rcp_f32 v54, v54
    v_rcp_f32 v55, v55
    v_rcp_f32 v56, v56
    v_rcp_f32 v57, v57
    v_rcp_f32 v58, v58
    v_rcp_f32 v59, v59
    v_mul_f32 v72, v72, v52
    v_mul_f32 v73, v73, v53
    v_mul_f32 v74, v74, v54
    v_mul_f32 v75, v75, v55
    v_mul_f32 v76, v76, v56
    v_mul_f32 v77, v77, v57
    v_mul_f32 v78, v78, v58
    v_mul_f32 v79, v79, v59
    v_lshlrev_b32 v44, 16, v36
    v_and_b32 v45, s82, v36
    v_lshlrev_b32 v46, 16, v37
    v_and_b32 v47, s82, v37
    v_lshlrev_b32 v48, 16, v38
    v_and_b32 v49, s82, v38
    v_lshlrev_b32 v50, 16, v39
    v_and_b32 v51, s82, v39
    v_lshlrev_b32 v52, 16, v40
    v_and_b32 v53, s82, v40
    v_lshlrev_b32 v54, 16, v41
    v_and_b32 v55, s82, v41
    v_lshlrev_b32 v56, 16, v42
    v_and_b32 v57, s82, v42
    v_lshlrev_b32 v58, 16, v43
    v_and_b32 v59, s82, v43
    s_waitcnt lgkmcnt(0)
    s_barrier
    ds_read_b128 v[128:131], v60 offset:4096
    ds_read_b128 v[144:147], v61 offset:8192
    ds_read_b128 v[160:163], v62 offset:12288
    ds_read_b128 v[132:135], v60 offset:5120
    ds_read_b128 v[148:151], v61 offset:9216
    ds_read_b128 v[164:167], v62 offset:13312
    ds_read_b128 v[136:139], v60 offset:6144
    ds_read_b128 v[152:155], v61 offset:10240
    ds_read_b128 v[168:171], v62 offset:14336
    ds_read_b128 v[140:143], v60 offset:7168
    ds_read_b128 v[156:159], v61 offset:11264
    ds_read_b128 v[172:175], v62 offset:15360
    s_waitcnt lgkmcnt(10)
    v_pk_add_f32 v[128:129], v[128:129], v[144:145]
    s_waitcnt lgkmcnt(9)
    v_pk_add_f32 v[192:193], v[192:193], v[160:161]
    v_pk_add_f32 v[130:131], v[130:131], v[146:147]
    v_pk_add_f32 v[194:195], v[194:195], v[162:163]
    s_waitcnt lgkmcnt(7)
    v_pk_add_f32 v[132:133], v[132:133], v[148:149]
    s_waitcnt lgkmcnt(6)
    v_pk_add_f32 v[196:197], v[196:197], v[164:165]
    v_pk_add_f32 v[134:135], v[134:135], v[150:151]
    v_pk_add_f32 v[198:199], v[198:199], v[166:167]
    v_pk_add_f32 v[192:193], v[192:193], v[128:129]
    v_pk_add_f32 v[194:195], v[194:195], v[130:131]
    v_pk_add_f32 v[196:197], v[196:197], v[132:133]
    v_pk_add_f32 v[198:199], v[198:199], v[134:135]
    v_pk_fma_f32 v[44:45], v[64:65], v[192:193], v[44:45]
    v_pk_fma_f32 v[46:47], v[66:67], v[194:195], v[46:47]
    v_pk_fma_f32 v[48:49], v[68:69], v[196:197], v[48:49]
    v_pk_fma_f32 v[50:51], v[70:71], v[198:199], v[50:51]
    v_cvt_pk_bf16_f32 v36, v44, v45
    v_cvt_pk_bf16_f32 v37, v46, v47
    v_cvt_pk_bf16_f32 v38, v48, v49
    v_cvt_pk_bf16_f32 v39, v50, v51
    buffer_store_dwordx4 v[36:39], v32, s[32:35], 0 offen
    s_waitcnt lgkmcnt(4)
    v_pk_add_f32 v[136:137], v[136:137], v[152:153]
    s_waitcnt lgkmcnt(3)
    v_pk_add_f32 v[200:201], v[200:201], v[168:169]
    v_pk_add_f32 v[138:139], v[138:139], v[154:155]
    v_pk_add_f32 v[202:203], v[202:203], v[170:171]
    s_waitcnt lgkmcnt(1)
    v_pk_add_f32 v[140:141], v[140:141], v[156:157]
    s_waitcnt lgkmcnt(0)
    v_pk_add_f32 v[204:205], v[204:205], v[172:173]
    v_pk_add_f32 v[142:143], v[142:143], v[158:159]
    v_pk_add_f32 v[206:207], v[206:207], v[174:175]
    v_pk_add_f32 v[200:201], v[200:201], v[136:137]
    v_pk_add_f32 v[202:203], v[202:203], v[138:139]
    v_pk_add_f32 v[204:205], v[204:205], v[140:141]
    v_pk_add_f32 v[206:207], v[206:207], v[142:143]
    v_pk_fma_f32 v[52:53], v[72:73], v[200:201], v[52:53]
    v_pk_fma_f32 v[54:55], v[74:75], v[202:203], v[54:55]
    v_pk_fma_f32 v[56:57], v[76:77], v[204:205], v[56:57]
    v_pk_fma_f32 v[58:59], v[78:79], v[206:207], v[58:59]
    v_cvt_pk_bf16_f32 v40, v52, v53
    v_cvt_pk_bf16_f32 v41, v54, v55
    v_cvt_pk_bf16_f32 v42, v56, v57
    v_cvt_pk_bf16_f32 v43, v58, v59
    buffer_store_dwordx4 v[40:43], v32, s[32:35], 0 offen offset:32
    s_endpgm
L_slow_gatef_1:
    s_mov_b32 s83, 0

L_spin_gatef_1:
    s_sleep 4
    buffer_load_dword v25, v24, s[36:39], 0 offen sc1
    s_add_u32 s83, s83, 1
    s_waitcnt vmcnt(0)
    v_cmp_gt_u32 vcc, 1, v25
    s_cmp_gt_u32 s83, 262144
    s_cbranch_scc1 L_ret_gatef_1
    s_cbranch_vccnz L_spin_gatef_1
    s_branch L_ret_gatef_1
L_slow_awf_2:
    s_mov_b32 s83, 0

L_spin_awf_2:
    s_sleep 4
    buffer_load_dword v25, v24, s[28:31], 0 offen sc1
    s_add_u32 s83, s83, 1
    s_waitcnt vmcnt(0)
    v_cmp_gt_u32 vcc, 16, v25
    s_cmp_gt_u32 s83, 262144
    s_cbranch_scc1 L_ret_awf_2
    s_cbranch_vccnz L_spin_awf_2
    s_branch L_ret_awf_2
L_slow_h1f_3:
    s_mov_b32 s83, 0

    s_waitcnt vmcnt(0)
    buffer_atomic_add v5, v4, s[28:31], s22 offen sc1
    s_mov_b32 s22, 0x7f000000
    s_branch L_first_h1f_3
L_spin_h1f_3:
    s_sleep 4
L_first_h1f_3:
    buffer_load_dword v25, v24, s[28:31], s51 offen sc1
    s_add_u32 s83, s83, 1
    s_waitcnt vmcnt(0)
    v_cmp_gt_u32 vcc, 12, v25
    s_cmp_gt_u32 s83, 262144
    s_cbranch_scc1 L_go_h1f_3
    s_cbranch_vccnz L_spin_h1f_3
L_go_h1f_3:
    s_lshl_b32 s57, s84, 12
    s_add_u32 s57, s57, s91
    buffer_load_dwordx4 a[0:3], v16, s[28:31], s57 offen sc1
    buffer_load_dwordx4 a[4:7], v17, s[28:31], s57 offen sc1
    buffer_load_dwordx4 a[8:11], v16, s[28:31], s57 offen offset:1024 sc1
    buffer_load_dwordx4 a[12:15], v17, s[28:31], s57 offen offset:1024 sc1
    buffer_load_dwordx4 a[16:19], v16, s[28:31], s57 offen offset:2048 sc1
    buffer_load_dwordx4 a[20:23], v17, s[28:31], s57 offen offset:2048 sc1
    buffer_load_dwordx4 a[24:27], v16, s[28:31], s57 offen offset:3072 sc1
    buffer_load_dwordx4 a[28:31], v17, s[28:31], s57 offen offset:3072 sc1
    s_lshl_b32 s57, s85, 12
    s_add_u32 s57, s57, s91
    buffer_load_dwordx4 a[32:35], v16, s[28:31], s57 offen sc1
    buffer_load_dwordx4 a[36:39], v17, s[28:31], s57 offen sc1
    buffer_load_dwordx4 a[40:43], v16, s[28:31], s57 offen offset:1024 sc1
    buffer_load_dwordx4 a[44:47], v17, s[28:31], s57 offen offset:1024 sc1
    buffer_load_dwordx4 a[48:51], v16, s[28:31], s57 offen offset:2048 sc1
    buffer_load_dwordx4 a[52:55], v17, s[28:31], s57 offen offset:2048 sc1
    buffer_load_dwordx4 a[56:59], v16, s[28:31], s57 offen offset:3072 sc1
    buffer_load_dwordx4 a[60:63], v17, s[28:31], s57 offen offset:3072 sc1
    s_lshl_b32 s57, s86, 12
    s_add_u32 s57, s57, s91
    buffer_load_dwordx4 a[196:199], v16, s[28:31], s57 offen sc1
    buffer_load_dwordx4 a[200:203], v17, s[28:31], s57 offen sc1
    buffer_load_dwordx4 a[204:207], v16, s[28:31], s57 offen offset:1024 sc1
    buffer_load_dwordx4 a[208:211], v17, s[28:31], s57 offen offset:1024 sc1
    buffer_load_dwordx4 a[212:215], v16, s[28:31], s57 offen offset:2048 sc1
    buffer_load_dwordx4 a[216:219], v17, s[28:31], s57 offen offset:2048 sc1
    buffer_load_dwordx4 a[220:223], v16, s[28:31], s57 offen offset:3072 sc1
    buffer_load_dwordx4 a[224:227], v17, s[28:31], s57 offen offset:3072 sc1
    s_waitcnt vmcnt(0)
    s_branch L_ret_h1f_3
L_slow_h2f_4:
    s_mov_b32 s83, 0

L_spin_h2f_4:
    s_sleep 4
    buffer_load_dword v25, v24, s[28:31], s51 offen sc1
    s_add_u32 s83, s83, 1
    s_waitcnt vmcnt(0)
    v_cmp_gt_u32 vcc, 16, v25
    s_cmp_gt_u32 s83, 262144
    s_cbranch_scc1 L_ret_h2f_4
    s_cbranch_vccnz L_spin_h2f_4
    s_branch L_ret_h2f_4
L_slow_zf_5:
    s_mov_b32 s83, 0

L_spin_zf_5:
    s_sleep 8
    buffer_load_dword v25, v24, s[28:31], s27 offen sc1
    s_add_u32 s83, s83, 1
    s_waitcnt vmcnt(0)
    v_cmp_gt_u32 vcc, s23, v25
    s_cmp_gt_u32 s83, 262144
    s_cbranch_scc1 L_ret_zf_5
    s_cbranch_vccnz L_spin_zf_5
    s_branch L_ret_zf_5
L_slow_gated_6:
    s_mov_b32 s83, 0

L_spin_gated_6:
    s_sleep 4
    buffer_load_dword v25, v24, s[36:39], 0 offen sc1
    s_add_u32 s83, s83, 1
    s_waitcnt vmcnt(0)
    v_cmp_gt_u32 vcc, 1, v25
    s_cmp_gt_u32 s83, 262144
    s_cbranch_scc1 L_ret_gated_6
    s_cbranch_vccnz L_spin_gated_6
    s_branch L_ret_gated_6
L_slow_awd_7:
    s_mov_b32 s83, 0

L_spin_awd_7:
    s_sleep 4
    buffer_load_dword v25, v24, s[28:31], 0 offen sc1
    s_add_u32 s83, s83, 1
    s_waitcnt vmcnt(0)
    v_cmp_gt_u32 vcc, 16, v25
    s_cmp_gt_u32 s83, 262144
    s_cbranch_scc1 L_ret_awd_7
    s_cbranch_vccnz L_spin_awd_7
    s_branch L_ret_awd_7
L_slow_h1d_8:
    s_mov_b32 s83, 0

    s_waitcnt vmcnt(0)
    buffer_atomic_add v5, v4, s[28:31], s22 offen sc1
    s_mov_b32 s22, 0x7f000000
    s_branch L_first_h1d_8
L_spin_h1d_8:
    s_sleep 4
L_first_h1d_8:
    buffer_load_dword v25, v24, s[28:31], s51 offen sc1
    s_add_u32 s83, s83, 1
    s_waitcnt vmcnt(0)
    v_cmp_gt_u32 vcc, 12, v25
    s_cmp_gt_u32 s83, 262144
    s_cbranch_scc1 L_go_h1d_8
    s_cbranch_vccnz L_spin_h1d_8
L_go_h1d_8:
    s_lshl_b32 s57, s84, 12
    s_add_u32 s57, s57, s91
    buffer_load_dwordx4 a[0:3], v16, s[28:31], s57 offen sc1
    buffer_load_dwordx4 a[4:7], v17, s[28:31], s57 offen sc1
    buffer_load_dwordx4 a[8:11], v16, s[28:31], s57 offen offset:1024 sc1
    buffer_load_dwordx4 a[12:15], v17, s[28:31], s57 offen offset:1024 sc1
    buffer_load_dwordx4 a[16:19], v16, s[28:31], s57 offen offset:2048 sc1
    buffer_load_dwordx4 a[20:23], v17, s[28:31], s57 offen offset:2048 sc1
    buffer_load_dwordx4 a[24:27], v16, s[28:31], s57 offen offset:3072 sc1
    buffer_load_dwordx4 a[28:31], v17, s[28:31], s57 offen offset:3072 sc1
    s_lshl_b32 s57, s85, 12
    s_add_u32 s57, s57, s91
    buffer_load_dwordx4 a[32:35], v16, s[28:31], s57 offen sc1
    buffer_load_dwordx4 a[36:39], v17, s[28:31], s57 offen sc1
    buffer_load_dwordx4 a[40:43], v16, s[28:31], s57 offen offset:1024 sc1
    buffer_load_dwordx4 a[44:47], v17, s[28:31], s57 offen offset:1024 sc1
    buffer_load_dwordx4 a[48:51], v16, s[28:31], s57 offen offset:2048 sc1
    buffer_load_dwordx4 a[52:55], v17, s[28:31], s57 offen offset:2048 sc1
    buffer_load_dwordx4 a[56:59], v16, s[28:31], s57 offen offset:3072 sc1
    buffer_load_dwordx4 a[60:63], v17, s[28:31], s57 offen offset:3072 sc1
    s_lshl_b32 s57, s86, 12
    s_add_u32 s57, s57, s91
    buffer_load_dwordx4 a[196:199], v16, s[28:31], s57 offen sc1
    buffer_load_dwordx4 a[200:203], v17, s[28:31], s57 offen sc1
    buffer_load_dwordx4 a[204:207], v16, s[28:31], s57 offen offset:1024 sc1
    buffer_load_dwordx4 a[208:211], v17, s[28:31], s57 offen offset:1024 sc1
    buffer_load_dwordx4 a[212:215], v16, s[28:31], s57 offen offset:2048 sc1
    buffer_load_dwordx4 a[216:219], v17, s[28:31], s57 offen offset:2048 sc1
    buffer_load_dwordx4 a[220:223], v16, s[28:31], s57 offen offset:3072 sc1
    buffer_load_dwordx4 a[224:227], v17, s[28:31], s57 offen offset:3072 sc1
    s_waitcnt vmcnt(0)
    s_branch L_ret_h1d_8
L_slow_h2d_9:
    s_mov_b32 s83, 0

L_spin_h2d_9:
    s_sleep 4
    buffer_load_dword v25, v24, s[28:31], s51 offen sc1
    s_add_u32 s83, s83, 1
    s_waitcnt vmcnt(0)
    v_cmp_gt_u32 vcc, 16, v25
    s_cmp_gt_u32 s83, 262144
    s_cbranch_scc1 L_ret_h2d_9
    s_cbranch_vccnz L_spin_h2d_9
    s_branch L_ret_h2d_9
L_slow_zd_10:
    s_mov_b32 s83, 0

L_spin_zd_10:
    s_sleep 8
    buffer_load_dword v25, v24, s[28:31], s27 offen sc1
    s_add_u32 s83, s83, 1
    s_waitcnt vmcnt(0)
    v_cmp_gt_u32 vcc, s23, v25
    s_cmp_gt_u32 s83, 262144
    s_cbranch_scc1 L_ret_zd_10
    s_cbranch_vccnz L_spin_zd_10
    s_branch L_ret_zd_10
L_end:
    s_endpgm
L_code_end:
.section .rodata,"a"
.p2align 6
.amdhsa_kernel recurrent_scan__spectral_gfnet__geglu_ffn__prompt_kernel
  .amdhsa_next_free_vgpr 512
  .amdhsa_next_free_sgpr 102
  .amdhsa_accum_offset 256
  .amdhsa_group_segment_fixed_size 0
  .amdhsa_kernarg_size 80
  .amdhsa_user_sgpr_count 2
  .amdhsa_user_sgpr_kernarg_segment_ptr 1
  .amdhsa_system_sgpr_workgroup_id_x 1
.end_amdhsa_kernel
.set C0, 0x3f80
.set C1, 0x3f80
.set C2, 0x3f80
.set C3, 0x3f80
.set C4, 0x3f80
.set C5, 0x3f80
.set C6, 0x3f7f
.set C7, 0x3f7f
.set C8, 0x3f7f
.set C9, 0x3f7e
.set C10, 0x3f7e
.set C11, 0x3f7e
.set C12, 0x3f7d
.set C13, 0x3f7d
.set C14, 0x3f7c
.set C15, 0x3f7c
.set C16, 0x3f7b
.set C17, 0x3f7a
.set C18, 0x3f7a
.set C19, 0x3f79
.set C20, 0x3f78
.set C21, 0x3f78
.set C22, 0x3f77
.set C23, 0x3f76
.set C24, 0x3f75
.set C25, 0x3f74
.set C26, 0x3f73
.set C27, 0x3f72
.set C28, 0x3f71
.set C29, 0x3f70
.set C30, 0x3f6f
.set C31, 0x3f6e
.set C32, 0x3f6d
.set C33, 0x3f6b
.set C34, 0x3f6a
.set C35, 0x3f69
.set C36, 0x3f67
.set C37, 0x3f66
.set C38, 0x3f65
.set C39, 0x3f63
.set C40, 0x3f62
.set C41, 0x3f60
.set C42, 0x3f5f
.set C43, 0x3f5d
.set C44, 0x3f5c
.set C45, 0x3f5a
.set C46, 0x3f58
.set C47, 0x3f57
.set C48, 0x3f55
.set C49, 0x3f53
.set C50, 0x3f51
.set C51, 0x3f4f
.set C52, 0x3f4e
.set C53, 0x3f4c
.set C54, 0x3f4a
.set C55, 0x3f48
.set C56, 0x3f46
.set C57, 0x3f44
.set C58, 0x3f42
.set C59, 0x3f40
.set C60, 0x3f3e
.set C61, 0x3f3c
.set C62, 0x3f39
.set C63, 0x3f37
.set C64, 0x3f35
.set C65, 0x3f33
.set C66, 0x3f31
.set C67, 0x3f2e
.set C68, 0x3f2c
.set C69, 0x3f2a
.set C70, 0x3f27
.set C71, 0x3f25
.set C72, 0x3f22
.set C73, 0x3f20
.set C74, 0x3f1d
.set C75, 0x3f1b
.set C76, 0x3f18
.set C77, 0x3f16
.set C78, 0x3f13
.set C79, 0x3f11
.set C80, 0x3f0e
.set C81, 0x3f0c
.set C82, 0x3f09
.set C83, 0x3f06
.set C84, 0x3f04
.set C85, 0x3f01
.set C86, 0x3efc
.set C87, 0x3ef7
.set C88, 0x3ef1
.set C89, 0x3eec
.set C90, 0x3ee6
.set C91, 0x3ee1
.set C92, 0x3edb
.set C93, 0x3ed5
.set C94, 0x3ecf
.set C95, 0x3eca
.set C96, 0x3ec4
.set C97, 0x3ebe
.set C98, 0x3eb8
.set C99, 0x3eb2
.set C100, 0x3eac
.set C101, 0x3ea7
.set C102, 0x3ea1
.set C103, 0x3e9b
.set C104, 0x3e95
.set C105, 0x3e8f
.set C106, 0x3e89
.set C107, 0x3e82
.set C108, 0x3e79
.set C109, 0x3e6d
.set C110, 0x3e60
.set C111, 0x3e54
.set C112, 0x3e48
.set C113, 0x3e3b
.set C114, 0x3e2f
.set C115, 0x3e23
.set C116, 0x3e16
.set C117, 0x3e0a
.set C118, 0x3dfb
.set C119, 0x3de2
.set C120, 0x3dc9
.set C121, 0x3db0
.set C122, 0x3d97
.set C123, 0x3d7b
.set C124, 0x3d49
.set C125, 0x3d17
.set C126, 0x3cc9
.set C127, 0x3c49
.set C128, 0x0000
.set C129, 0xbc49
.set C130, 0xbcc9
.set C131, 0xbd17
.set C132, 0xbd49
.set C133, 0xbd7b
.set C134, 0xbd97
.set C135, 0xbdb0
.set C136, 0xbdc9
.set C137, 0xbde2
.set C138, 0xbdfb
.set C139, 0xbe0a
.set C140, 0xbe16
.set C141, 0xbe23
.set C142, 0xbe2f
.set C143, 0xbe3b
.set C144, 0xbe48
.set C145, 0xbe54
.set C146, 0xbe60
.set C147, 0xbe6d
.set C148, 0xbe79
.set C149, 0xbe82
.set C150, 0xbe89
.set C151, 0xbe8f
.set C152, 0xbe95
.set C153, 0xbe9b
.set C154, 0xbea1
.set C155, 0xbea7
.set C156, 0xbeac
.set C157, 0xbeb2
.set C158, 0xbeb8
.set C159, 0xbebe
.set C160, 0xbec4
.set C161, 0xbeca
.set C162, 0xbecf
.set C163, 0xbed5
.set C164, 0xbedb
.set C165, 0xbee1
.set C166, 0xbee6
.set C167, 0xbeec
.set C168, 0xbef1
.set C169, 0xbef7
.set C170, 0xbefc
.set C171, 0xbf01
.set C172, 0xbf04
.set C173, 0xbf06
.set C174, 0xbf09
.set C175, 0xbf0c
.set C176, 0xbf0e
.set C177, 0xbf11
.set C178, 0xbf13
.set C179, 0xbf16
.set C180, 0xbf18
.set C181, 0xbf1b
.set C182, 0xbf1d
.set C183, 0xbf20
.set C184, 0xbf22
.set C185, 0xbf25
.set C186, 0xbf27
.set C187, 0xbf2a
.set C188, 0xbf2c
.set C189, 0xbf2e
.set C190, 0xbf31
.set C191, 0xbf33
.set C192, 0xbf35
.set C193, 0xbf37
.set C194, 0xbf39
.set C195, 0xbf3c
.set C196, 0xbf3e
.set C197, 0xbf40
.set C198, 0xbf42
.set C199, 0xbf44
.set C200, 0xbf46
.set C201, 0xbf48
.set C202, 0xbf4a
.set C203, 0xbf4c
.set C204, 0xbf4e
.set C205, 0xbf4f
.set C206, 0xbf51
.set C207, 0xbf53
.set C208, 0xbf55
.set C209, 0xbf57
.set C210, 0xbf58
.set C211, 0xbf5a
.set C212, 0xbf5c
.set C213, 0xbf5d
.set C214, 0xbf5f
.set C215, 0xbf60
.set C216, 0xbf62
.set C217, 0xbf63
.set C218, 0xbf65
.set C219, 0xbf66
.set C220, 0xbf67
.set C221, 0xbf69
.set C222, 0xbf6a
.set C223, 0xbf6b
.set C224, 0xbf6d
.set C225, 0xbf6e
.set C226, 0xbf6f
.set C227, 0xbf70
.set C228, 0xbf71
.set C229, 0xbf72
.set C230, 0xbf73
.set C231, 0xbf74
.set C232, 0xbf75
.set C233, 0xbf76
.set C234, 0xbf77
.set C235, 0xbf78
.set C236, 0xbf78
.set C237, 0xbf79
.set C238, 0xbf7a
.set C239, 0xbf7a
.set C240, 0xbf7b
.set C241, 0xbf7c
.set C242, 0xbf7c
.set C243, 0xbf7d
.set C244, 0xbf7d
.set C245, 0xbf7e
.set C246, 0xbf7e
.set C247, 0xbf7e
.set C248, 0xbf7f
.set C249, 0xbf7f
.set C250, 0xbf7f
.set C251, 0xbf80
.set C252, 0xbf80
.set C253, 0xbf80
.set C254, 0xbf80
.set C255, 0xbf80
.set C256, 0xbf80
.set C257, 0xbf80
.set C258, 0xbf80
.set C259, 0xbf80
.set C260, 0xbf80
.set C261, 0xbf80
.set C262, 0xbf7f
.set C263, 0xbf7f
.set C264, 0xbf7f
.set C265, 0xbf7e
.set C266, 0xbf7e
.set C267, 0xbf7e
.set C268, 0xbf7d
.set C269, 0xbf7d
.set C270, 0xbf7c
.set C271, 0xbf7c
.set C272, 0xbf7b
.set C273, 0xbf7a
.set C274, 0xbf7a
.set C275, 0xbf79
.set C276, 0xbf78
.set C277, 0xbf78
.set C278, 0xbf77
.set C279, 0xbf76
.set C280, 0xbf75
.set C281, 0xbf74
.set C282, 0xbf73
.set C283, 0xbf72
.set C284, 0xbf71
.set C285, 0xbf70
.set C286, 0xbf6f
.set C287, 0xbf6e
.set C288, 0xbf6d
.set C289, 0xbf6b
.set C290, 0xbf6a
.set C291, 0xbf69
.set C292, 0xbf67
.set C293, 0xbf66
.set C294, 0xbf65
.set C295, 0xbf63
.set C296, 0xbf62
.set C297, 0xbf60
.set C298, 0xbf5f
.set C299, 0xbf5d
.set C300, 0xbf5c
.set C301, 0xbf5a
.set C302, 0xbf58
.set C303, 0xbf57
.set C304, 0xbf55
.set C305, 0xbf53
.set C306, 0xbf51
.set C307, 0xbf4f
.set C308, 0xbf4e
.set C309, 0xbf4c
.set C310, 0xbf4a
.set C311, 0xbf48
.set C312, 0xbf46
.set C313, 0xbf44
.set C314, 0xbf42
.set C315, 0xbf40
.set C316, 0xbf3e
.set C317, 0xbf3c
.set C318, 0xbf39
.set C319, 0xbf37
.set C320, 0xbf35
.set C321, 0xbf33
.set C322, 0xbf31
.set C323, 0xbf2e
.set C324, 0xbf2c
.set C325, 0xbf2a
.set C326, 0xbf27
.set C327, 0xbf25
.set C328, 0xbf22
.set C329, 0xbf20
.set C330, 0xbf1d
.set C331, 0xbf1b
.set C332, 0xbf18
.set C333, 0xbf16
.set C334, 0xbf13
.set C335, 0xbf11
.set C336, 0xbf0e
.set C337, 0xbf0c
.set C338, 0xbf09
.set C339, 0xbf06
.set C340, 0xbf04
.set C341, 0xbf01
.set C342, 0xbefc
.set C343, 0xbef7
.set C344, 0xbef1
.set C345, 0xbeec
.set C346, 0xbee6
.set C347, 0xbee1
.set C348, 0xbedb
.set C349, 0xbed5
.set C350, 0xbecf
.set C351, 0xbeca
.set C352, 0xbec4
.set C353, 0xbebe
.set C354, 0xbeb8
.set C355, 0xbeb2
.set C356, 0xbeac
.set C357, 0xbea7
.set C358, 0xbea1
.set C359, 0xbe9b
.set C360, 0xbe95
.set C361, 0xbe8f
.set C362, 0xbe89
.set C363, 0xbe82
.set C364, 0xbe79
.set C365, 0xbe6d
.set C366, 0xbe60
.set C367, 0xbe54
.set C368, 0xbe48
.set C369, 0xbe3b
.set C370, 0xbe2f
.set C371, 0xbe23
.set C372, 0xbe16
.set C373, 0xbe0a
.set C374, 0xbdfb
.set C375, 0xbde2
.set C376, 0xbdc9
.set C377, 0xbdb0
.set C378, 0xbd97
.set C379, 0xbd7b
.set C380, 0xbd49
.set C381, 0xbd17
.set C382, 0xbcc9
.set C383, 0xbc49
.set C384, 0x0000
.set C385, 0x3c49
.set C386, 0x3cc9
.set C387, 0x3d17
.set C388, 0x3d49
.set C389, 0x3d7b
.set C390, 0x3d97
.set C391, 0x3db0
.set C392, 0x3dc9
.set C393, 0x3de2
.set C394, 0x3dfb
.set C395, 0x3e0a
.set C396, 0x3e16
.set C397, 0x3e23
.set C398, 0x3e2f
.set C399, 0x3e3b
.set C400, 0x3e48
.set C401, 0x3e54
.set C402, 0x3e60
.set C403, 0x3e6d
.set C404, 0x3e79
.set C405, 0x3e82
.set C406, 0x3e89
.set C407, 0x3e8f
.set C408, 0x3e95
.set C409, 0x3e9b
.set C410, 0x3ea1
.set C411, 0x3ea7
.set C412, 0x3eac
.set C413, 0x3eb2
.set C414, 0x3eb8
.set C415, 0x3ebe
.set C416, 0x3ec4
.set C417, 0x3eca
.set C418, 0x3ecf
.set C419, 0x3ed5
.set C420, 0x3edb
.set C421, 0x3ee1
.set C422, 0x3ee6
.set C423, 0x3eec
.set C424, 0x3ef1
.set C425, 0x3ef7
.set C426, 0x3efc
.set C427, 0x3f01
.set C428, 0x3f04
.set C429, 0x3f06
.set C430, 0x3f09
.set C431, 0x3f0c
.set C432, 0x3f0e
.set C433, 0x3f11
.set C434, 0x3f13
.set C435, 0x3f16
.set C436, 0x3f18
.set C437, 0x3f1b
.set C438, 0x3f1d
.set C439, 0x3f20
.set C440, 0x3f22
.set C441, 0x3f25
.set C442, 0x3f27
.set C443, 0x3f2a
.set C444, 0x3f2c
.set C445, 0x3f2e
.set C446, 0x3f31
.set C447, 0x3f33
.set C448, 0x3f35
.set C449, 0x3f37
.set C450, 0x3f39
.set C451, 0x3f3c
.set C452, 0x3f3e
.set C453, 0x3f40
.set C454, 0x3f42
.set C455, 0x3f44
.set C456, 0x3f46
.set C457, 0x3f48
.set C458, 0x3f4a
.set C459, 0x3f4c
.set C460, 0x3f4e
.set C461, 0x3f4f
.set C462, 0x3f51
.set C463, 0x3f53
.set C464, 0x3f55
.set C465, 0x3f57
.set C466, 0x3f58
.set C467, 0x3f5a
.set C468, 0x3f5c
.set C469, 0x3f5d
.set C470, 0x3f5f
.set C471, 0x3f60
.set C472, 0x3f62
.set C473, 0x3f63
.set C474, 0x3f65
.set C475, 0x3f66
.set C476, 0x3f67
.set C477, 0x3f69
.set C478, 0x3f6a
.set C479, 0x3f6b
.set C480, 0x3f6d
.set C481, 0x3f6e
.set C482, 0x3f6f
.set C483, 0x3f70
.set C484, 0x3f71
.set C485, 0x3f72
.set C486, 0x3f73
.set C487, 0x3f74
.set C488, 0x3f75
.set C489, 0x3f76
.set C490, 0x3f77
.set C491, 0x3f78
.set C492, 0x3f78
.set C493, 0x3f79
.set C494, 0x3f7a
.set C495, 0x3f7a
.set C496, 0x3f7b
.set C497, 0x3f7c
.set C498, 0x3f7c
.set C499, 0x3f7d
.set C500, 0x3f7d
.set C501, 0x3f7e
.set C502, 0x3f7e
.set C503, 0x3f7e
.set C504, 0x3f7f
.set C505, 0x3f7f
.set C506, 0x3f7f
.set C507, 0x3f80
.set C508, 0x3f80
.set C509, 0x3f80
.set C510, 0x3f80
.set C511, 0x3f80
.p2align 8
.type dft_tab,@object
dft_tab:
.altmacro
.macro E2 i, j
.long C\i + (C\j << 16)
.endm
.macro E1 j
.long 0x3f00 + ((dd & 1) << 15) + (C\j << 16)
.endm
.set bb, 0
.rept 4
.set dd, 0
.rept 512
.set cc, bb
.rept 32
.if cc == 0
E1 %(dd)
.else
E2 %((dd*cc)&511), %((dd*(cc+1))&511)
.endif
.set cc, cc+2
.endr
.set cc, bb
.rept 32
E2 %((dd*cc+128)&511), %((dd*(cc+1)+128)&511)
.set cc, cc+2
.endr
.set dd, dd+1
.endr
.set bb, bb+64
.endr
.noaltmacro
.long 0x3f803f80, 0x3f803f80, 0x3f803f80, 0x3f803f80
.long 0x3f7b3f80, 0x3f553f6d, 0xbf7bbf80, 0xbf55bf6d
.long 0x3f6d3f80, 0x3ec43f35, 0x3f6d3f80, 0x3ec43f35
.long 0x3f553f80, 0xbe483ec4, 0xbf55bf80, 0x3e48bec4
.long 0x3f353f80, 0xbf350000, 0x3f353f80, 0xbf350000
.long 0x3f0e3f80, 0xbf7bbec4, 0xbf0ebf80, 0x3f7b3ec4
.long 0x3ec43f80, 0xbf6dbf35, 0x3ec43f80, 0xbf6dbf35
.long 0x3e483f80, 0xbf0ebf6d, 0xbe48bf80, 0x3f0e3f6d
.long 0x00003f80, 0x0000bf80, 0x00003f80, 0x0000bf80
.long 0xbe483f80, 0x3f0ebf6d, 0x3e48bf80, 0xbf0e3f6d
.long 0xbec43f80, 0x3f6dbf35, 0xbec43f80, 0x3f6dbf35
.long 0xbf0e3f80, 0x3f7bbec4, 0x3f0ebf80, 0xbf7b3ec4
.long 0xbf353f80, 0x3f350000, 0xbf353f80, 0x3f350000
.long 0xbf553f80, 0x3e483ec4, 0x3f55bf80, 0xbe48bec4
.long 0xbf6d3f80, 0xbec43f35, 0xbf6d3f80, 0xbec43f35
.long 0xbf7b3f80, 0xbf553f6d, 0x3f7bbf80, 0x3f55bf6d
.long 0x3f803f80, 0x3f803f80, 0x3f803f80, 0x3f803f80
.long 0x3f0e3f35, 0x3e483ec4, 0xbf0ebf35, 0xbe48bec4
.long 0xbec40000, 0xbf6dbf35, 0xbec40000, 0xbf6dbf35
.long 0xbf7bbf35, 0xbf0ebf6d, 0x3f7b3f35, 0x3f0e3f6d
.long 0xbf35bf80, 0x3f350000, 0xbf35bf80, 0x3f350000
.long 0x3e48bf35, 0x3f553f6d, 0xbe483f35, 0xbf55bf6d
.long 0x3f6d0000, 0xbec43f35, 0x3f6d0000, 0xbec43f35
.long 0x3f553f35, 0xbf7bbec4, 0xbf55bf35, 0x3f7b3ec4
.long 0x00003f80, 0x0000bf80, 0x00003f80, 0x0000bf80
.long 0xbf553f35, 0x3f7bbec4, 0x3f55bf35, 0xbf7b3ec4
.long 0xbf6d0000, 0x3ec43f35, 0xbf6d0000, 0x3ec43f35
.long 0xbe48bf35, 0xbf553f6d, 0x3e483f35, 0x3f55bf6d
.long 0x3f35bf80, 0xbf350000, 0x3f35bf80, 0xbf350000
.long 0x3f7bbf35, 0x3f0ebf6d, 0xbf7b3f35, 0xbf0e3f6d
.long 0x3ec40000, 0x3f6dbf35, 0x3ec40000, 0x3f6dbf35
.long 0xbf0e3f35, 0xbe483ec4, 0x3f0ebf35, 0x3e48bec4
.long 0x3f803f80, 0x3f803f80, 0x3f803f80, 0x3f803f80
.long 0xbe480000, 0xbf0ebec4, 0x3e480000, 0x3f0e3ec4
.long 0xbf6dbf80, 0xbec4bf35, 0xbf6dbf80, 0xbec4bf35
.long 0x3f0e0000, 0x3f7b3f6d, 0xbf0e0000, 0xbf7bbf6d
.long 0x3f353f80, 0xbf350000, 0x3f353f80, 0xbf350000
.long 0xbf550000, 0xbe48bf6d, 0x3f550000, 0x3e483f6d
.long 0xbec4bf80, 0x3f6d3f35, 0xbec4bf80, 0x3f6d3f35
.long 0x3f7b0000, 0xbf553ec4, 0xbf7b0000, 0x3f55bec4
.long 0x00003f80, 0x0000bf80, 0x00003f80, 0x0000bf80
.long 0xbf7b0000, 0x3f553ec4, 0x3f7b0000, 0xbf55bec4
.long 0x3ec4bf80, 0xbf6d3f35, 0x3ec4bf80, 0xbf6d3f35
.long 0x3f550000, 0x3e48bf6d, 0xbf550000, 0xbe483f6d
.long 0xbf353f80, 0x3f350000, 0xbf353f80, 0x3f350000
.long 0xbf0e0000, 0xbf7b3f6d, 0x3f0e0000, 0x3f7bbf6d
.long 0x3f6dbf80, 0x3ec4bf35, 0x3f6dbf80, 0x3ec4bf35
.long 0x3e480000, 0x3f0ebec4, 0xbe480000, 0xbf0e3ec4
.long 0x3f803f80, 0x3f803f80, 0x3f803f80, 0x3f803f80
.long 0xbf55bf35, 0xbf7bbf6d, 0x3f553f35, 0x3f7b3f6d
.long 0x3ec40000, 0x3f6d3f35, 0x3ec40000, 0x3f6d3f35
.long 0x3e483f35, 0xbf55bec4, 0xbe48bf35, 0x3f553ec4
.long 0xbf35bf80, 0x3f350000, 0xbf35bf80, 0x3f350000
.long 0x3f7b3f35, 0xbf0e3ec4, 0xbf7bbf35, 0x3f0ebec4
.long 0xbf6d0000, 0x3ec4bf35, 0xbf6d0000, 0x3ec4bf35
.long 0x3f0ebf35, 0xbe483f6d, 0xbf0e3f35, 0x3e48bf6d
.long 0x00003f80, 0x0000bf80, 0x00003f80, 0x0000bf80
.long 0xbf0ebf35, 0x3e483f6d, 0x3f0e3f35, 0xbe48bf6d
.long 0x3f6d0000, 0xbec4bf35, 0x3f6d0000, 0xbec4bf35
.long 0xbf7b3f35, 0x3f0e3ec4, 0x3f7bbf35, 0xbf0ebec4
.long 0x3f35bf80, 0xbf350000, 0x3f35bf80, 0xbf350000
.long 0xbe483f35, 0x3f55bec4, 0x3e48bf35, 0xbf553ec4
.long 0xbec40000, 0xbf6d3f35, 0xbec40000, 0xbf6d3f35
.long 0x3f55bf35, 0x3f7bbf6d, 0xbf553f35, 0xbf7b3f6d
.long 0xbf803f80, 0xbf803f80, 0xbf803f80, 0xbf803f80
.long 0xbf7b3f80, 0xbf553f6d, 0x3f7bbf80, 0x3f55bf6d
.long 0xbf6d3f80, 0xbec43f35, 0xbf6d3f80, 0xbec43f35
.long 0xbf553f80, 0x3e483ec4, 0x3f55bf80, 0xbe48bec4
.long 0xbf353f80, 0x3f350000, 0xbf353f80, 0x3f350000
.long 0xbf0e3f80, 0x3f7bbec4, 0x3f0ebf80, 0xbf7b3ec4
.long 0xbec43f80, 0x3f6dbf35, 0xbec43f80, 0x3f6dbf35
.long 0xbe483f80, 0x3f0ebf6d, 0x3e48bf80, 0xbf0e3f6d
.long 0x00003f80, 0x0000bf80, 0x00003f80, 0x0000bf80
.long 0x3e483f80, 0xbf0ebf6d, 0xbe48bf80, 0x3f0e3f6d
.long 0x3ec43f80, 0xbf6dbf35, 0x3ec43f80, 0xbf6dbf35
.long 0x3f0e3f80, 0xbf7bbec4, 0xbf0ebf80, 0x3f7b3ec4
.long 0x3f353f80, 0xbf350000, 0x3f353f80, 0xbf350000
.long 0x3f553f80, 0xbe483ec4, 0xbf55bf80, 0x3e48bec4
.long 0x3f6d3f80, 0x3ec43f35, 0x3f6d3f80, 0x3ec43f35
.long 0x3f7b3f80, 0x3f553f6d, 0xbf7bbf80, 0xbf55bf6d
.long 0xbf803f80, 0xbf803f80, 0xbf803f80, 0xbf803f80
.long 0xbf0e3f35, 0xbe483ec4, 0x3f0ebf35, 0x3e48bec4
.long 0x3ec40000, 0x3f6dbf35, 0x3ec40000, 0x3f6dbf35
.long 0x3f7bbf35, 0x3f0ebf6d, 0xbf7b3f35, 0xbf0e3f6d
.long 0x3f35bf80, 0xbf350000, 0x3f35bf80, 0xbf350000
.long 0xbe48bf35, 0xbf553f6d, 0x3e483f35, 0x3f55bf6d
.long 0xbf6d0000, 0x3ec43f35, 0xbf6d0000, 0x3ec43f35
.long 0xbf553f35, 0x3f7bbec4, 0x3f55bf35, 0xbf7b3ec4
.long 0x00003f80, 0x0000bf80, 0x00003f80, 0x0000bf80
.long 0x3f553f35, 0xbf7bbec4, 0xbf55bf35, 0x3f7b3ec4
.long 0x3f6d0000, 0xbec43f35, 0x3f6d0000, 0xbec43f35
.long 0x3e48bf35, 0x3f553f6d, 0xbe483f35, 0xbf55bf6d
.long 0xbf35bf80, 0x3f350000, 0xbf35bf80, 0x3f350000
.long 0xbf7bbf35, 0xbf0ebf6d, 0x3f7b3f35, 0x3f0e3f6d
.long 0xbec40000, 0xbf6dbf35, 0xbec40000, 0xbf6dbf35
.long 0x3f0e3f35, 0x3e483ec4, 0xbf0ebf35, 0xbe48bec4
.long 0xbf803f80, 0xbf803f80, 0xbf803f80, 0xbf803f80
.long 0x3e480000, 0x3f0ebec4, 0xbe480000, 0xbf0e3ec4
.long 0x3f6dbf80, 0x3ec4bf35, 0x3f6dbf80, 0x3ec4bf35
.long 0xbf0e0000, 0xbf7b3f6d, 0x3f0e0000, 0x3f7bbf6d
.long 0xbf353f80, 0x3f350000, 0xbf353f80, 0x3f350000
.long 0x3f550000, 0x3e48bf6d, 0xbf550000, 0xbe483f6d
.long 0x3ec4bf80, 0xbf6d3f35, 0x3ec4bf80, 0xbf6d3f35
.long 0xbf7b0000, 0x3f553ec4, 0x3f7b0000, 0xbf55bec4
.long 0x00003f80, 0x0000bf80, 0x00003f80, 0x0000bf80
.long 0x3f7b0000, 0xbf553ec4, 0xbf7b0000, 0x3f55bec4
.long 0xbec4bf80, 0x3f6d3f35, 0xbec4bf80, 0x3f6d3f35
.long 0xbf550000, 0xbe48bf6d, 0x3f550000, 0x3e483f6d
.long 0x3f353f80, 0xbf350000, 0x3f353f80, 0xbf350000
.long 0x3f0e0000, 0x3f7b3f6d, 0xbf0e0000, 0xbf7bbf6d
.long 0xbf6dbf80, 0xbec4bf35, 0xbf6dbf80, 0xbec4bf35
.long 0xbe480000, 0xbf0ebec4, 0x3e480000, 0x3f0e3ec4
.long 0xbf803f80, 0xbf803f80, 0xbf803f80, 0xbf803f80
.long 0x3f55bf35, 0x3f7bbf6d, 0xbf553f35, 0xbf7b3f6d
.long 0xbec40000, 0xbf6d3f35, 0xbec40000, 0xbf6d3f35
.long 0xbe483f35, 0x3f55bec4, 0x3e48bf35, 0xbf553ec4
.long 0x3f35bf80, 0xbf350000, 0x3f35bf80, 0xbf350000
.long 0xbf7b3f35, 0x3f0e3ec4, 0x3f7bbf35, 0xbf0ebec4
.long 0x3f6d0000, 0xbec4bf35, 0x3f6d0000, 0xbec4bf35
.long 0xbf0ebf35, 0x3e483f6d, 0x3f0e3f35, 0xbe48bf6d
.long 0x00003f80, 0x0000bf80, 0x00003f80, 0x0000bf80
.long 0x3f0ebf35, 0xbe483f6d, 0xbf0e3f35, 0x3e48bf6d
.long 0xbf6d0000, 0x3ec4bf35, 0xbf6d0000, 0x3ec4bf35
.long 0x3f7b3f35, 0xbf0e3ec4, 0xbf7bbf35, 0x3f0ebec4
.long 0xbf35bf80, 0x3f350000, 0xbf35bf80, 0x3f350000
.long 0x3e483f35, 0xbf55bec4, 0xbe48bf35, 0x3f553ec4
.long 0x3ec40000, 0x3f6d3f35, 0x3ec40000, 0x3f6d3f35
.long 0xbf55bf35, 0xbf7bbf6d, 0x3f553f35, 0x3f7b3f6d
.long 0x00000000, 0x00000000, 0x00000000, 0x00000000
.long 0x3e480000, 0x3f0e3ec4, 0xbe480000, 0xbf0ebec4
.long 0x3ec40000, 0x3f6d3f35, 0x3ec40000, 0x3f6d3f35
.long 0x3f0e0000, 0x3f7b3f6d, 0xbf0e0000, 0xbf7bbf6d
.long 0x3f350000, 0x3f353f80, 0x3f350000, 0x3f353f80
.long 0x3f550000, 0x3e483f6d, 0xbf550000, 0xbe48bf6d
.long 0x3f6d0000, 0xbec43f35, 0x3f6d0000, 0xbec43f35
.long 0x3f7b0000, 0xbf553ec4, 0xbf7b0000, 0x3f55bec4
.long 0x3f800000, 0xbf800000, 0x3f800000, 0xbf800000
.long 0x3f7b0000, 0xbf55bec4, 0xbf7b0000, 0x3f553ec4
.long 0x3f6d0000, 0xbec4bf35, 0x3f6d0000, 0xbec4bf35
.long 0x3f550000, 0x3e48bf6d, 0xbf550000, 0xbe483f6d
.long 0x3f350000, 0x3f35bf80, 0x3f350000, 0x3f35bf80
.long 0x3f0e0000, 0x3f7bbf6d, 0xbf0e0000, 0xbf7b3f6d
.long 0x3ec40000, 0x3f6dbf35, 0x3ec40000, 0x3f6dbf35
.long 0x3e480000, 0x3f0ebec4, 0xbe480000, 0xbf0e3ec4
.long 0x00000000, 0x00000000, 0x00000000, 0x00000000
.long 0x3f553f35, 0x3f7b3f6d, 0xbf55bf35, 0xbf7bbf6d
.long 0x3f6d3f80, 0x3ec43f35, 0x3f6d3f80, 0x3ec43f35
.long 0x3e483f35, 0xbf55bec4, 0xbe48bf35, 0x3f553ec4
.long 0xbf350000, 0xbf35bf80, 0xbf350000, 0xbf35bf80
.long 0xbf7bbf35, 0x3f0ebec4, 0x3f7b3f35, 0xbf0e3ec4
.long 0xbec4bf80, 0x3f6d3f35, 0xbec4bf80, 0x3f6d3f35
.long 0x3f0ebf35, 0xbe483f6d, 0xbf0e3f35, 0x3e48bf6d
.long 0x3f800000, 0xbf800000, 0x3f800000, 0xbf800000
.long 0x3f0e3f35, 0xbe48bf6d, 0xbf0ebf35, 0x3e483f6d
.long 0xbec43f80, 0x3f6dbf35, 0xbec43f80, 0x3f6dbf35
.long 0xbf7b3f35, 0x3f0e3ec4, 0x3f7bbf35, 0xbf0ebec4
.long 0xbf350000, 0xbf353f80, 0xbf350000, 0xbf353f80
.long 0x3e48bf35, 0xbf553ec4, 0xbe483f35, 0x3f55bec4
.long 0x3f6dbf80, 0x3ec4bf35, 0x3f6dbf80, 0x3ec4bf35
.long 0x3f55bf35, 0x3f7bbf6d, 0xbf553f35, 0xbf7b3f6d
.long 0x00000000, 0x00000000, 0x00000000, 0x00000000
.long 0x3f7b3f80, 0x3f553f6d, 0xbf7bbf80, 0xbf55bf6d
.long 0xbec40000, 0xbf6dbf35, 0xbec40000, 0xbf6dbf35
.long 0xbf55bf80, 0x3e48bec4, 0x3f553f80, 0xbe483ec4
.long 0x3f350000, 0x3f353f80, 0x3f350000, 0x3f353f80
.long 0x3f0e3f80, 0xbf7bbec4, 0xbf0ebf80, 0x3f7b3ec4
.long 0xbf6d0000, 0x3ec4bf35, 0xbf6d0000, 0x3ec4bf35
.long 0xbe48bf80, 0x3f0e3f6d, 0x3e483f80, 0xbf0ebf6d
.long 0x3f800000, 0xbf800000, 0x3f800000, 0xbf800000
.long 0xbe483f80, 0x3f0ebf6d, 0x3e48bf80, 0xbf0e3f6d
.long 0xbf6d0000, 0x3ec43f35, 0xbf6d0000, 0x3ec43f35
.long 0x3f0ebf80, 0xbf7b3ec4, 0xbf0e3f80, 0x3f7bbec4
.long 0x3f350000, 0x3f35bf80, 0x3f350000, 0x3f35bf80
.long 0xbf553f80, 0x3e483ec4, 0x3f55bf80, 0xbe48bec4
.long 0xbec40000, 0xbf6d3f35, 0xbec40000, 0xbf6d3f35
.long 0x3f7bbf80, 0x3f55bf6d, 0xbf7b3f80, 0xbf553f6d
.long 0x00000000, 0x00000000, 0x00000000, 0x00000000
.long 0x3f0e3f35, 0x3e483ec4, 0xbf0ebf35, 0xbe48bec4
.long 0xbf6dbf80, 0xbec4bf35, 0xbf6dbf80, 0xbec4bf35
.long 0x3f7b3f35, 0x3f0e3f6d, 0xbf7bbf35, 0xbf0ebf6d
.long 0xbf350000, 0xbf35bf80, 0xbf350000, 0xbf35bf80
.long 0x3e48bf35, 0x3f553f6d, 0xbe483f35, 0xbf55bf6d
.long 0x3ec43f80, 0xbf6dbf35, 0x3ec43f80, 0xbf6dbf35
.long 0xbf55bf35, 0x3f7b3ec4, 0x3f553f35, 0xbf7bbec4
.long 0x3f800000, 0xbf800000, 0x3f800000, 0xbf800000
.long 0xbf553f35, 0x3f7bbec4, 0x3f55bf35, 0xbf7b3ec4
.long 0x3ec4bf80, 0xbf6d3f35, 0x3ec4bf80, 0xbf6d3f35
.long 0x3e483f35, 0x3f55bf6d, 0xbe48bf35, 0xbf553f6d
.long 0xbf350000, 0xbf353f80, 0xbf350000, 0xbf353f80
.long 0x3f7bbf35, 0x3f0ebf6d, 0xbf7b3f35, 0xbf0e3f6d
.long 0xbf6d3f80, 0xbec43f35, 0xbf6d3f80, 0xbec43f35
.long 0x3f0ebf35, 0x3e48bec4, 0xbf0e3f35, 0xbe483ec4
.long 0x00000000, 0x00000000, 0x00000000, 0x00000000
.long 0xbe480000, 0xbf0e3ec4, 0x3e480000, 0x3f0ebec4
.long 0xbec40000, 0xbf6d3f35, 0xbec40000, 0xbf6d3f35
.long 0xbf0e0000, 0xbf7b3f6d, 0x3f0e0000, 0x3f7bbf6d
.long 0xbf350000, 0xbf353f80, 0xbf350000, 0xbf353f80
.long 0xbf550000, 0xbe483f6d, 0x3f550000, 0x3e48bf6d
.long 0xbf6d0000, 0x3ec43f35, 0xbf6d0000, 0x3ec43f35
.long 0xbf7b0000, 0x3f553ec4, 0x3f7b0000, 0xbf55bec4
.long 0xbf800000, 0x3f800000, 0xbf800000, 0x3f800000
.long 0xbf7b0000, 0x3f55bec4, 0x3f7b0000, 0xbf553ec4
.long 0xbf6d0000, 0x3ec4bf35, 0xbf6d0000, 0x3ec4bf35
.long 0xbf550000, 0xbe48bf6d, 0x3f550000, 0x3e483f6d
.long 0xbf350000, 0xbf35bf80, 0xbf350000, 0xbf35bf80
.long 0xbf0e0000, 0xbf7bbf6d, 0x3f0e0000, 0x3f7b3f6d
.long 0xbec40000, 0xbf6dbf35, 0xbec40000, 0xbf6dbf35
.long 0xbe480000, 0xbf0ebec4, 0x3e480000, 0x3f0e3ec4
.long 0x00000000, 0x00000000, 0x00000000, 0x00000000
.long 0xbf553f35, 0xbf7b3f6d, 0x3f55bf35, 0x3f7bbf6d
.long 0xbf6d3f80, 0xbec43f35, 0xbf6d3f80, 0xbec43f35
.long 0xbe483f35, 0x3f55bec4, 0x3e48bf35, 0xbf553ec4
.long 0x3f350000, 0x3f35bf80, 0x3f350000, 0x3f35bf80
.long 0x3f7bbf35, 0xbf0ebec4, 0xbf7b3f35, 0x3f0e3ec4
.long 0x3ec4bf80, 0xbf6d3f35, 0x3ec4bf80, 0xbf6d3f35
.long 0xbf0ebf35, 0x3e483f6d, 0x3f0e3f35, 0xbe48bf6d
.long 0xbf800000, 0x3f800000, 0xbf800000, 0x3f800000
.long 0xbf0e3f35, 0x3e48bf6d, 0x3f0ebf35, 0xbe483f6d
.long 0x3ec43f80, 0xbf6dbf35, 0x3ec43f80, 0xbf6dbf35
.long 0x3f7b3f35, 0xbf0e3ec4, 0xbf7bbf35, 0x3f0ebec4
.long 0x3f350000, 0x3f353f80, 0x3f350000, 0x3f353f80
.long 0xbe48bf35, 0x3f553ec4, 0x3e483f35, 0xbf55bec4
.long 0xbf6dbf80, 0xbec4bf35, 0xbf6dbf80, 0xbec4bf35
.long 0xbf55bf35, 0xbf7bbf6d, 0x3f553f35, 0x3f7b3f6d
.long 0x00000000, 0x00000000, 0x00000000, 0x00000000
.long 0xbf7b3f80, 0xbf553f6d, 0x3f7bbf80, 0x3f55bf6d
.long 0x3ec40000, 0x3f6dbf35, 0x3ec40000, 0x3f6dbf35
.long 0x3f55bf80, 0xbe48bec4, 0xbf553f80, 0x3e483ec4
.long 0xbf350000, 0xbf353f80, 0xbf350000, 0xbf353f80
.long 0xbf0e3f80, 0x3f7bbec4, 0x3f0ebf80, 0xbf7b3ec4
.long 0x3f6d0000, 0xbec4bf35, 0x3f6d0000, 0xbec4bf35
.long 0x3e48bf80, 0xbf0e3f6d, 0xbe483f80, 0x3f0ebf6d
.long 0xbf800000, 0x3f800000, 0xbf800000, 0x3f800000
.long 0x3e483f80, 0xbf0ebf6d, 0xbe48bf80, 0x3f0e3f6d
.long 0x3f6d0000, 0xbec43f35, 0x3f6d0000, 0xbec43f35
.long 0xbf0ebf80, 0x3f7b3ec4, 0x3f0e3f80, 0xbf7bbec4
.long 0xbf350000, 0xbf35bf80, 0xbf350000, 0xbf35bf80
.long 0x3f553f80, 0xbe483ec4, 0xbf55bf80, 0x3e48bec4
.long 0x3ec40000, 0x3f6d3f35, 0x3ec40000, 0x3f6d3f35
.long 0xbf7bbf80, 0xbf55bf6d, 0x3f7b3f80, 0x3f553f6d
.long 0x00000000, 0x00000000, 0x00000000, 0x00000000
.long 0xbf0e3f35, 0xbe483ec4, 0x3f0ebf35, 0x3e48bec4
.long 0x3f6dbf80, 0x3ec4bf35, 0x3f6dbf80, 0x3ec4bf35
.long 0xbf7b3f35, 0xbf0e3f6d, 0x3f7bbf35, 0x3f0ebf6d
.long 0x3f350000, 0x3f35bf80, 0x3f350000, 0x3f35bf80
.long 0xbe48bf35, 0xbf553f6d, 0x3e483f35, 0x3f55bf6d
.long 0xbec43f80, 0x3f6dbf35, 0xbec43f80, 0x3f6dbf35
.long 0x3f55bf35, 0xbf7b3ec4, 0xbf553f35, 0x3f7bbec4
.long 0xbf800000, 0x3f800000, 0xbf800000, 0x3f800000
.long 0x3f553f35, 0xbf7bbec4, 0xbf55bf35, 0x3f7b3ec4
.long 0xbec4bf80, 0x3f6d3f35, 0xbec4bf80, 0x3f6d3f35
.long 0xbe483f35, 0xbf55bf6d, 0x3e48bf35, 0x3f553f6d
.long 0x3f350000, 0x3f353f80, 0x3f350000, 0x3f353f80
.long 0xbf7bbf35, 0xbf0ebf6d, 0x3f7b3f35, 0x3f0e3f6d
.long 0x3f6d3f80, 0x3ec43f35, 0x3f6d3f80, 0x3ec43f35
.long 0xbf0ebf35, 0xbe48bec4, 0x3f0e3f35, 0x3e483ec4
.long 0x00000000, 0x00000000, 0x00000000, 0x00000000
.long 0xbe480000, 0xbf0ebec4, 0x3e480000, 0x3f0e3ec4
.long 0xbec40000, 0xbf6dbf35, 0xbec40000, 0xbf6dbf35
.long 0xbf0e0000, 0xbf7bbf6d, 0x3f0e0000, 0x3f7b3f6d
.long 0xbf350000, 0xbf35bf80, 0xbf350000, 0xbf35bf80
.long 0xbf550000, 0xbe48bf6d, 0x3f550000, 0x3e483f6d
.long 0xbf6d0000, 0x3ec4bf35, 0xbf6d0000, 0x3ec4bf35
.long 0xbf7b0000, 0x3f55bec4, 0x3f7b0000, 0xbf553ec4
.long 0xbf800000, 0x3f800000, 0xbf800000, 0x3f800000
.long 0xbf7b0000, 0x3f553ec4, 0x3f7b0000, 0xbf55bec4
.long 0xbf6d0000, 0x3ec43f35, 0xbf6d0000, 0x3ec43f35
.long 0xbf550000, 0xbe483f6d, 0x3f550000, 0x3e48bf6d
.long 0xbf350000, 0xbf353f80, 0xbf350000, 0xbf353f80
.long 0xbf0e0000, 0xbf7b3f6d, 0x3f0e0000, 0x3f7bbf6d
.long 0xbec40000, 0xbf6d3f35, 0xbec40000, 0xbf6d3f35
.long 0xbe480000, 0xbf0e3ec4, 0x3e480000, 0x3f0ebec4
.long 0x00000000, 0x00000000, 0x00000000, 0x00000000
.long 0xbf55bf35, 0xbf7bbf6d, 0x3f553f35, 0x3f7b3f6d
.long 0xbf6dbf80, 0xbec4bf35, 0xbf6dbf80, 0xbec4bf35
.long 0xbe48bf35, 0x3f553ec4, 0x3e483f35, 0xbf55bec4
.long 0x3f350000, 0x3f353f80, 0x3f350000, 0x3f353f80
.long 0x3f7b3f35, 0xbf0e3ec4, 0xbf7bbf35, 0x3f0ebec4
.long 0x3ec43f80, 0xbf6dbf35, 0x3ec43f80, 0xbf6dbf35
.long 0xbf0e3f35, 0x3e48bf6d, 0x3f0ebf35, 0xbe483f6d
.long 0xbf800000, 0x3f800000, 0xbf800000, 0x3f800000
.long 0xbf0ebf35, 0x3e483f6d, 0x3f0e3f35, 0xbe48bf6d
.long 0x3ec4bf80, 0xbf6d3f35, 0x3ec4bf80, 0xbf6d3f35
.long 0x3f7bbf35, 0xbf0ebec4, 0xbf7b3f35, 0x3f0e3ec4
.long 0x3f350000, 0x3f35bf80, 0x3f350000, 0x3f35bf80
.long 0xbe483f35, 0x3f55bec4, 0x3e48bf35, 0xbf553ec4
.long 0xbf6d3f80, 0xbec43f35, 0xbf6d3f80, 0xbec43f35
.long 0xbf553f35, 0xbf7b3f6d, 0x3f55bf35, 0x3f7bbf6d
.long 0x00000000, 0x00000000, 0x00000000, 0x00000000
.long 0xbf7bbf80, 0xbf55bf6d, 0x3f7b3f80, 0x3f553f6d
.long 0x3ec40000, 0x3f6d3f35, 0x3ec40000, 0x3f6d3f35
.long 0x3f553f80, 0xbe483ec4, 0xbf55bf80, 0x3e48bec4
.long 0xbf350000, 0xbf35bf80, 0xbf350000, 0xbf35bf80
.long 0xbf0ebf80, 0x3f7b3ec4, 0x3f0e3f80, 0xbf7bbec4
.long 0x3f6d0000, 0xbec43f35, 0x3f6d0000, 0xbec43f35
.long 0x3e483f80, 0xbf0ebf6d, 0xbe48bf80, 0x3f0e3f6d
.long 0xbf800000, 0x3f800000, 0xbf800000, 0x3f800000
.long 0x3e48bf80, 0xbf0e3f6d, 0xbe483f80, 0x3f0ebf6d
.long 0x3f6d0000, 0xbec4bf35, 0x3f6d0000, 0xbec4bf35
.long 0xbf0e3f80, 0x3f7bbec4, 0x3f0ebf80, 0xbf7b3ec4
.long 0xbf350000, 0xbf353f80, 0xbf350000, 0xbf353f80
.long 0x3f55bf80, 0xbe48bec4, 0xbf553f80, 0x3e483ec4
.long 0x3ec40000, 0x3f6dbf35, 0x3ec40000, 0x3f6dbf35
.long 0xbf7b3f80, 0xbf553f6d, 0x3f7bbf80, 0x3f55bf6d
.long 0x00000000, 0x00000000, 0x00000000, 0x00000000
.long 0xbf0ebf35, 0xbe48bec4, 0x3f0e3f35, 0x3e483ec4
.long 0x3f6d3f80, 0x3ec43f35, 0x3f6d3f80, 0x3ec43f35
.long 0xbf7bbf35, 0xbf0ebf6d, 0x3f7b3f35, 0x3f0e3f6d
.long 0x3f350000, 0x3f353f80, 0x3f350000, 0x3f353f80
.long 0xbe483f35, 0xbf55bf6d, 0x3e48bf35, 0x3f553f6d
.long 0xbec4bf80, 0x3f6d3f35, 0xbec4bf80, 0x3f6d3f35
.long 0x3f553f35, 0xbf7bbec4, 0xbf55bf35, 0x3f7b3ec4
.long 0xbf800000, 0x3f800000, 0xbf800000, 0x3f800000
.long 0x3f55bf35, 0xbf7b3ec4, 0xbf553f35, 0x3f7bbec4
.long 0xbec43f80, 0x3f6dbf35, 0xbec43f80, 0x3f6dbf35
.long 0xbe48bf35, 0xbf553f6d, 0x3e483f35, 0x3f55bf6d
.long 0x3f350000, 0x3f35bf80, 0x3f350000, 0x3f35bf80
.long 0xbf7b3f35, 0xbf0e3f6d, 0x3f7bbf35, 0x3f0ebf6d
.long 0x3f6dbf80, 0x3ec4bf35, 0x3f6dbf80, 0x3ec4bf35
.long 0xbf0e3f35, 0xbe483ec4, 0x3f0ebf35, 0x3e48bec4
.long 0x00000000, 0x00000000, 0x00000000, 0x00000000
.long 0x3e480000, 0x3f0ebec4, 0xbe480000, 0xbf0e3ec4
.long 0x3ec40000, 0x3f6dbf35, 0x3ec40000, 0x3f6dbf35
.long 0x3f0e0000, 0x3f7bbf6d, 0xbf0e0000, 0xbf7b3f6d
.long 0x3f350000, 0x3f35bf80, 0x3f350000, 0x3f35bf80
.long 0x3f550000, 0x3e48bf6d, 0xbf550000, 0xbe483f6d
.long 0x3f6d0000, 0xbec4bf35, 0x3f6d0000, 0xbec4bf35
.long 0x3f7b0000, 0xbf55bec4, 0xbf7b0000, 0x3f553ec4
.long 0x3f800000, 0xbf800000, 0x3f800000, 0xbf800000
.long 0x3f7b0000, 0xbf553ec4, 0xbf7b0000, 0x3f55bec4
.long 0x3f6d0000, 0xbec43f35, 0x3f6d0000, 0xbec43f35
.long 0x3f550000, 0x3e483f6d, 0xbf550000, 0xbe48bf6d
.long 0x3f350000, 0x3f353f80, 0x3f350000, 0x3f353f80
.long 0x3f0e0000, 0x3f7b3f6d, 0xbf0e0000, 0xbf7bbf6d
.long 0x3ec40000, 0x3f6d3f35, 0x3ec40000, 0x3f6d3f35
.long 0x3e480000, 0x3f0e3ec4, 0xbe480000, 0xbf0ebec4
.long 0x00000000, 0x00000000, 0x00000000, 0x00000000
.long 0x3f55bf35, 0x3f7bbf6d, 0xbf553f35, 0xbf7b3f6d
.long 0x3f6dbf80, 0x3ec4bf35, 0x3f6dbf80, 0x3ec4bf35
.long 0x3e48bf35, 0xbf553ec4, 0xbe483f35, 0x3f55bec4
.long 0xbf350000, 0xbf353f80, 0xbf350000, 0xbf353f80
.long 0xbf7b3f35, 0x3f0e3ec4, 0x3f7bbf35, 0xbf0ebec4
.long 0xbec43f80, 0x3f6dbf35, 0xbec43f80, 0x3f6dbf35
.long 0x3f0e3f35, 0xbe48bf6d, 0xbf0ebf35, 0x3e483f6d
.long 0x3f800000, 0xbf800000, 0x3f800000, 0xbf800000
.long 0x3f0ebf35, 0xbe483f6d, 0xbf0e3f35, 0x3e48bf6d
.long 0xbec4bf80, 0x3f6d3f35, 0xbec4bf80, 0x3f6d3f35
.long 0xbf7bbf35, 0x3f0ebec4, 0x3f7b3f35, 0xbf0e3ec4
.long 0xbf350000, 0xbf35bf80, 0xbf350000, 0xbf35bf80
.long 0x3e483f35, 0xbf55bec4, 0xbe48bf35, 0x3f553ec4
.long 0x3f6d3f80, 0x3ec43f35, 0x3f6d3f80, 0x3ec43f35
.long 0x3f553f35, 0x3f7b3f6d, 0xbf55bf35, 0xbf7bbf6d
.long 0x00000000, 0x00000000, 0x00000000, 0x00000000
.long 0x3f7bbf80, 0x3f55bf6d, 0xbf7b3f80, 0xbf553f6d
.long 0xbec40000, 0xbf6d3f35, 0xbec40000, 0xbf6d3f35
.long 0xbf553f80, 0x3e483ec4, 0x3f55bf80, 0xbe48bec4
.long 0x3f350000, 0x3f35bf80, 0x3f350000, 0x3f35bf80
.long 0x3f0ebf80, 0xbf7b3ec4, 0xbf0e3f80, 0x3f7bbec4
.long 0xbf6d0000, 0x3ec43f35, 0xbf6d0000, 0x3ec43f35
.long 0xbe483f80, 0x3f0ebf6d, 0x3e48bf80, 0xbf0e3f6d
.long 0x3f800000, 0xbf800000, 0x3f800000, 0xbf800000
.long 0xbe48bf80, 0x3f0e3f6d, 0x3e483f80, 0xbf0ebf6d
.long 0xbf6d0000, 0x3ec4bf35, 0xbf6d0000, 0x3ec4bf35
.long 0x3f0e3f80, 0xbf7bbec4, 0xbf0ebf80, 0x3f7b3ec4
.long 0x3f350000, 0x3f353f80, 0x3f350000, 0x3f353f80
.long 0xbf55bf80, 0x3e48bec4, 0x3f553f80, 0xbe483ec4
.long 0xbec40000, 0xbf6dbf35, 0xbec40000, 0xbf6dbf35
.long 0x3f7b3f80, 0x3f553f6d, 0xbf7bbf80, 0xbf55bf6d
.long 0x00000000, 0x00000000, 0x00000000, 0x00000000
.long 0x3f0ebf35, 0x3e48bec4, 0xbf0e3f35, 0xbe483ec4
.long 0xbf6d3f80, 0xbec43f35, 0xbf6d3f80, 0xbec43f35
.long 0x3f7bbf35, 0x3f0ebf6d, 0xbf7b3f35, 0xbf0e3f6d
.long 0xbf350000, 0xbf353f80, 0xbf350000, 0xbf353f80
.long 0x3e483f35, 0x3f55bf6d, 0xbe48bf35, 0xbf553f6d
.long 0x3ec4bf80, 0xbf6d3f35, 0x3ec4bf80, 0xbf6d3f35
.long 0xbf553f35, 0x3f7bbec4, 0x3f55bf35, 0xbf7b3ec4
.long 0x3f800000, 0xbf800000, 0x3f800000, 0xbf800000
.long 0xbf55bf35, 0x3f7b3ec4, 0x3f553f35, 0xbf7bbec4
.long 0x3ec43f80, 0xbf6dbf35, 0x3ec43f80, 0xbf6dbf35
.long 0x3e48bf35, 0x3f553f6d, 0xbe483f35, 0xbf55bf6d
.long 0xbf350000, 0xbf35bf80, 0xbf350000, 0xbf35bf80
.long 0x3f7b3f35, 0x3f0e3f6d, 0xbf7bbf35, 0xbf0ebf6d
.long 0xbf6dbf80, 0xbec4bf35, 0xbf6dbf80, 0xbec4bf35
.long 0x3f0e3f35, 0x3e483ec4, 0xbf0ebf35, 0xbe48bec4
.size dft_tab, 530432
```
